```python
import torch

def _softmax(x, axis=-1):
    return torch.softmax(x, dim=axis)
def _gelu(x):
    return torch.nn.functional.gelu(x, approximate="tanh")
def _silu(x):
    return torch.nn.functional.silu(x)
def _sigmoid(x):
    return torch.sigmoid(x)
def _layernorm(x, axis=-1, eps=1e-5):
    m = x.mean(dim=axis, keepdim=True)
    v = x.var(dim=axis, keepdim=True, unbiased=False)
    return (x - m) / torch.sqrt(v + eps)
def _scatter_add(tgt, idx, src, axis=0):
    return tgt.clone().index_add_(axis, idx, src)
def _segment_sum(src, seg, n):
    out = torch.zeros((n,) + src.shape[1:], dtype=src.dtype)
    return out.index_add_(0, seg, src)
def _pad(x, pw):
    flat = tuple(v for pair in reversed(pw) for v in pair)
    return torch.nn.functional.pad(x, flat)

kernel_name = 'gated_mix__grouped_kv_mqa__sliding_block__prompt'

def setup_inputs():

    _w = (lambda a: (lambda t: t.to(torch.bfloat16) if t.is_floating_point() else t)(torch.as_tensor(a)))
    def _A_setup():
        B, S, D, H = 1, 2048, 1024, 32
        Dh = D // H
        return {
            "x": _w((lambda *s: torch.randn(*s, dtype=torch.bfloat16) * 0.05)(B, S, D)),
            "wq": _w((lambda *s: torch.randn(*s, dtype=torch.bfloat16) * 0.8)(D, H * Dh)),
            "wk": _w((lambda *s: torch.randn(*s, dtype=torch.bfloat16) * 0.8)(D, Dh)),
            "wv": _w((lambda *s: torch.randn(*s, dtype=torch.bfloat16) * 0.2)(D, Dh)),
            "wo": _w((lambda *s: torch.randn(*s, dtype=torch.bfloat16) * 0.2)(H * Dh, D)),
        }
    _A_in = _A_setup()

    def _B_setup():
        B, S, D = 1, 2048, 1024
        return {
            "x": _w((lambda *s: torch.randn(*s, dtype=torch.bfloat16) * 0.05)(B, S, D)),
            "wqkv": _w((lambda *s: torch.randn(*s, dtype=torch.bfloat16) * 0.8)(D, 3 * D)),
            "wo": _w((lambda *s: torch.randn(*s, dtype=torch.bfloat16) * 0.05)(D, D)),
        }
    _B_in = _B_setup()

    return {
        "A_x": _A_in["x"],
        "A_wq": _A_in["wq"],
        "A_wk": _A_in["wk"],
        "A_wv": _A_in["wv"],
        "A_wo": _A_in["wo"],
        "B_x": _B_in["x"],
        "B_wqkv": _B_in["wqkv"],
        "B_wo": _B_in["wo"],
        "gate_w": _w((lambda *s: torch.randn(*s, dtype=torch.bfloat16) * 0.05)(1024) * 16.0),
    }

def reference(A_x, A_wq, A_wk, A_wv, A_wo, B_x, B_wqkv, B_wo, gate_w):
    def _A_ref(x, wq, wk, wv, wo):
        B, S, D = x.shape
        H = 32
        Dh = D // H
        q = (lambda x, *d: x.permute(*d))((x @ wq).reshape(B, S, H, Dh), 0, 2, 1, 3)
        k = x @ wk
        v = x @ wv
        scores = torch.einsum("bhqd,bkd->bhqk", q, k) * (Dh ** -0.5)
        p = _softmax(scores, axis=-1)
        o = torch.einsum("bhqk,bkd->bhqd", p, v)
        return (lambda x, *d: x.permute(*d))(o, 0, 2, 1, 3).reshape(B, S, H * Dh) @ wo

    def _B_ref(x, wqkv, wo):
        B, S, D = x.shape
        H = 32; Dh = D // H; W = 256
        qkv = (lambda x, *d: x.permute(*d))((x @ wqkv).reshape(B, S, 3, H, Dh), 2, 0, 3, 1, 4)
        q, k, v = qkv[0], qkv[1], qkv[2]
        scores = torch.einsum("bhqd,bhkd->bhqk", q, k) * (Dh ** -0.5)
        idx = torch.arange(S)
        mask = (idx[:, None] - idx[None, :] >= 0) & (idx[:, None] - idx[None, :] < W)
        scores = torch.where(mask[None, None], scores, -1e9)
        p = _softmax(scores, axis=-1)
        o = torch.einsum("bhqk,bhkd->bhqd", p, v)
        return (lambda x, *d: x.permute(*d))(o, 0, 2, 1, 3).reshape(B, S, D) @ wo

    x = A_x
    g = _sigmoid((x * gate_w).sum(-1, keepdims=True))
    a = _A_ref(x, A_wq, A_wk, A_wv, A_wo)
    b = _B_ref(x, B_wqkv, B_wo)
    return g * a + (1 - g) * b
```

```asm
; @launch grid=(256,1,1) block=(512,1,1) lds=163840
.amdgcn_target "amdgcn-amd-amdhsa--gfx950"
.text
.globl gated_mix__grouped_kv_mqa__sliding_block__prompt_kernel
.p2align 8
.type gated_mix__grouped_kv_mqa__sliding_block__prompt_kernel,@function
gated_mix__grouped_kv_mqa__sliding_block__prompt_kernel:
    s_cmp_ge_u32 s2, 256
    s_cbranch_scc1 K_end
    s_load_dwordx2 s[4:5], s[0:1], 0
    s_load_dwordx2 s[8:9], s[0:1], 8
    s_load_dwordx2 s[100:101], s[0:1], 48
    s_load_dwordx2 s[20:21], s[0:1], 88
    s_load_dwordx4 s[96:99], s[0:1], 16
    s_load_dwordx2 s[16:17], s[0:1], 64
    s_load_dwordx2 s[24:25], s[0:1], 32
    s_load_dwordx2 s[28:29], s[0:1], 56
    s_load_dwordx2 s[32:33], s[0:1], 72
    v_lshrrev_b32 v5, 6, v0
    v_and_b32 v1, 63, v0
    v_readfirstlane_b32 s38, v5
    s_getpc_b64 s[42:43]
    s_cmp_lg_u32 s38, 0
    s_cbranch_scc1 K_nocpf
    s_lshr_b32 s40, s2, 3
    s_lshl_b32 s40, s40, 12
    v_lshrrev_b32 v6, 5, v1
    v_mul_u32_u24 v6, s40, v6
    v_lshl_add_u32 v6, v1, 7, v6
    v_min_u32 v6, K_codeend-gated_mix__grouped_kv_mqa__sliding_block__prompt_kernel-256, v6
    global_load_dword v255, v6, s[42:43]
K_nocpf:
    s_bfe_u32 s40, s2, 0x10002
    s_bfe_u32 s41, s2, 0x30003
    s_lshl3_add_u32 s36, s40, s41
    s_bfe_u32 s40, s2, 0x20000
    s_xor_b32 s40, s40, 1
    s_lshr_b32 s41, s2, 6
    s_lshl2_add_u32 s37, s40, s41
    v_and_b32 v2, 15, v0
    v_lshrrev_b32 v3, 4, v1
    v_lshlrev_b32 v4, 4, v1
    s_lshr_b32 s44, s38, 2
    s_and_b32 s40, s38, 3
    s_mov_b32 s6, 0x400000
    s_mov_b32 s7, 0x20000
    s_mov_b32 s11, 0x20000
    s_movk_i32 s62, 6144
    s_mov_b32 s10, 0x600000
    s_sub_u32 s63, s40, 1
    s_lshl_b32 s63, s63, 4
    s_cmp_eq_u32 s40, 0
    s_cselect_b32 s62, 2048, s62
    s_cselect_b32 s10, 0x200000, s10
    s_cselect_b32 s63, 1, s63
    s_xor_b32 s63, s63, s37
    s_lshl_b32 s63, s63, 7
    s_cmp_eq_u32 s44, 0
    s_cbranch_scc0 K_loader
    v_lshrrev_b32 v5, 2, v1
    v_min_u32 v5, 4, v5
    v_and_b32 v6, 3, v1
    v_lshl_add_u32 v5, v5, 6, v6
    s_and_b32 s41, s36, 15
    s_lshl_b32 s41, s41, 2
    v_add_u32 v5, s41, v5
    v_mul_lo_u32 v20, v5, s62
    v_and_b32 v6, 7, v1
    v_min_u32 v6, 7, v6
    v_lshlrev_b32 v6, 7, v6
    v_lshrrev_b32 v5, 3, v1
    v_lshl_add_u32 v21, v5, 11, v6
    s_lshl_b32 s41, s36, 4
    s_add_u32 s41, s41, s37
    s_lshl_b32 s41, s41, 14
    v_lshlrev_b32 v22, 7, v2
    s_lshr_b32 s42, s2, 3
    s_lshl_b32 s42, s42, 11
    s_mov_b32 s14, 0x10000
    s_mov_b32 s15, 0x20000
    s_mov_b32 s18, 0x800
    s_mov_b32 s19, 0x20000
    s_waitcnt lgkmcnt(0)
    s_cmp_eq_u32 s38, 0
    s_cselect_b32 s8, s8, s100
    s_cselect_b32 s9, s9, s101
    s_cbranch_scc0 K_pf1
    buffer_load_dword v255, v21, s[4:7], s41 offen
K_pf1:
    buffer_load_dword v255, v20, s[8:11], s63 offen
    s_bitcmp1_b32 s37, 3
    s_cselect_b32 s12, s98, s96
    s_cselect_b32 s13, s99, s97
    s_cmp_eq_u32 s38, 2
    s_cbranch_scc0 K_pf3
K_pf3:
    s_and_b32 s41, s37, 0
    s_add_u32 s41, s41, s38
    s_cmp_eq_u32 s41, 1
    s_cbranch_scc0 K_pf2
    buffer_load_dword v255, v22, s[12:15], s42 offen
    buffer_load_dword v255, v22, s[16:19], 0 offen
K_pf2:
    v_mov_b32 v8, 0
    v_mov_b32 v9, 0
    v_mov_b32 v10, 0
    v_mov_b32 v11, 0
    v_mov_b32 v12, 0
    v_mov_b32 v13, 0
    s_branch K_common
K_loader:
    s_lshl_b32 s41, s36, 2
    s_add_u32 s41, s41, s40
    s_lshl_b32 s41, s41, 16
    v_lshrrev_b32 v5, 3, v1
    v_and_b32 v7, 7, v1
    v_xor_b32 v8, v7, v3
    v_lshlrev_b32 v8, 4, v8
    v_lshl_add_u32 v8, v5, 11, v8
    v_add_u32 v8, s41, v8
    v_xor_b32 v9, 0x4040, v8
    v_xor_b32 v10, 0x8060, v8
    v_xor_b32 v11, 0xc020, v8
    s_lshl_b32 s48, s62, 4
    v_and_b32 v6, 1, v3
    v_lshlrev_b32 v6, 1, v6
    v_xor_b32 v6, v6, v7
    v_lshlrev_b32 v6, 4, v6
    v_mad_u32_u24 v12, v5, s62, v6
    v_add_u32 v12, s63, v12
    s_lshl_b32 s41, s62, 3
    v_xor_b32 v13, 64, v12
    v_add_u32 v13, s41, v13
    s_lshl_b32 s51, s40, 12
    s_lshl_b32 s52, s40, 13
    s_add_u32 s52, s52, 16384
    s_sub_u32 s50, 0, s48
    s_waitcnt lgkmcnt(0)
    s_mov_b32 s61, s40
    s_cmp_eq_u32 s40, 0
    s_cselect_b32 s8, s8, s100
    s_cselect_b32 s9, s9, s101
    s_add_u32 m0, s51, 0
    s_movk_i32 s49, 0
    buffer_load_dwordx4 v8, s[4:7], s49 offen  lds
    s_add_u32 m0, s52, 0
    s_add_u32 s50, s50, s48
    buffer_load_dwordx4 v12, s[8:11], s50 offen  lds
    s_add_u32 m0, s52, 1024
    s_nop 0
    buffer_load_dwordx4 v13, s[8:11], s50 offen  lds
K_common:
    s_getpc_b64 s[42:43]
K_pcref:
    s_mul_i32 s40, s38, 768
    s_sub_u32 s42, s42, K_pcref-gated_mix__grouped_kv_mqa__sliding_block__prompt_kernel
    s_subb_u32 s43, s43, 0
    s_add_u32 s40, s40, ((K_pcref-gated_mix__grouped_kv_mqa__sliding_block__prompt_kernel)&0xfffff80)+128
    s_load_dwordx2 s[54:55], s[42:43], s40 offset:60
    s_load_dwordx2 s[54:55], s[42:43], s40 offset:188
    s_load_dwordx2 s[54:55], s[42:43], s40 offset:316
    s_load_dwordx2 s[54:55], s[42:43], s40 offset:444
    s_load_dwordx2 s[54:55], s[42:43], s40 offset:572
    s_load_dwordx2 s[54:55], s[42:43], s40 offset:700
    s_mov_b64 s[56:57], s[42:43]
    s_mov_b32 s41, 17375232
    s_load_dword s39, s[20:21], s41
    v_mov_b32 v244, 0
    v_mov_b32 v245, 0
    v_mov_b32 v246, 0
    v_mov_b32 v247, 0
    s_mov_b32 s18, 0x800
    s_mov_b32 s19, 0x20000
    s_mov_b32 s22, 0x2000000
    s_mov_b32 s23, 0x20000
    s_mov_b32 s26, 0x200000
    s_mov_b32 s27, 0x20000
    s_mov_b32 s30, 0x200000
    s_mov_b32 s31, 0x20000
    s_mov_b32 s34, 0x400000
    s_mov_b32 s35, 0x20000
    s_mov_b32 s47, 0xf149f2ca
    s_mov_b32 s3, 0
    s_and_b32 s40, s38, 3
    s_lshl2_add_u32 s45, s36, s40
    s_lshl1_add_u32 s46, s37, s44
    s_and_b32 s41, s2, 3
    s_bfe_u32 s42, s2, 0x20003
    s_lshl2_add_u32 s64, s41, s42
    s_and_b32 s41, s2, 4
    s_lshr_b32 s42, s2, 5
    s_lshl1_add_u32 s65, s41, s42
    s_lshl2_add_u32 s66, s64, s40
    s_lshl_b32 s67, s38, 11
    v_mov_b32 v224, 0xdddddddd
    v_and_b32 v7, 7, v1
    v_mov_b32 v6, 0x3f803f80
    v_cmp_eq_u32 vcc, 0, v7
    v_cmp_eq_u32 s[42:43], 4, v7
    v_lshlrev_b32 v243, 2, v2
    v_cndmask_b32 v220, 0, v6, vcc
    v_cndmask_b32 v221, 0, v6, vcc
    v_cndmask_b32 v222, 0, v6, s[42:43]
    v_cndmask_b32 v223, 0, v6, s[42:43]
    v_and_b32 v6, 1, v3
    v_lshrrev_b32 v5, 1, v3
    v_lshlrev_b32 v225, 4, v2
    v_lshl_add_u32 v225, v6, 10, v225
    v_lshl_add_u32 v225, v5, 8, v225
    v_lshlrev_b32 v5, 4, v5
    v_lshl_add_u32 v5, v6, 2, v5
    v_lshrrev_b32 v250, 2, v2
    v_add_u32 v5, v5, v250
    v_lshlrev_b32 v6, 6, v6
    v_lshrrev_b32 v250, 3, v2
    v_lshl_or_b32 v6, v250, 5, v6
    v_and_b32 v250, 3, v2
    v_lshl_or_b32 v6, v250, 3, v6
    v_lshl_add_u32 v228, v5, 7, v6
    s_lshl_b32 s41, s44, 12
    v_add_u32 v228, s41, v228
    v_xor_b32 v229, 32, v228
    v_xor_b32 v230, 64, v228
    v_xor_b32 v231, 0x60, v228
    v_lshrrev_b32 v5, 3, v1
    s_lshl_b32 s41, s38, 4
    v_add_u32 v5, s41, v5
    v_lshlrev_b32 v6, 1, v3
    v_xor_b32 v6, v6, v7
    v_lshlrev_b32 v6, 4, v6
    s_lshl_b32 s41, s65, 7
    v_add_u32 v6, s41, v6
    v_lshl_add_u32 v226, v5, 11, v6
    v_add_u32 v227, 0x4000, v226
    s_lshl_b32 s41, s44, 13
    s_add_u32 s41, s41, 98304
    v_add_u32 v241, s41, v4
    s_lshl1_add_u32 s41, s40, s44
    s_lshl_b32 s41, s41, 12
    s_add_u32 s41, s41, 8192
    v_add_u32 v242, s41, v4
    s_lshl_b32 s41, s38, 12
    v_add_u32 v250, s41, v4
    v_and_b32 v249, 31, v1
    v_lshlrev_b32 v249, 2, v249
    s_cmp_eq_u32 s44, 0
    s_cbranch_scc1 K_compute
    s_bitcmp1_b32 s37, 3
    s_cselect_b32 s12, s98, s96
    s_cselect_b32 s13, s99, s97
    s_mov_b32 s14, 0x10000
    s_mov_b32 s15, 0x20000
    s_and_b32 s43, s37, 3
    s_lshl2_add_u32 s40, s36, s43
    s_lshl_b32 s40, s40, 16
    s_lshl_b32 s41, s61, 7
    v_bfe_u32 v5, v2, 1, 2
    v_and_b32 v6, 1, v2
    v_lshlrev_b32 v15, 4, v3
    v_lshl_add_u32 v15, v5, 9, v15
    v_lshl_add_u32 v15, v6, 6, v15
    v_add_u32 v15, s41, v15
    v_lshrrev_b32 v5, 3, v1
    v_and_b32 v6, 7, v1
    v_lshlrev_b32 v6, 7, v6
    v_lshl_add_u32 v182, v5, 11, v6
    s_lshl_b32 s42, s61, 14
    s_add_u32 s42, s42, s40
    v_add_u32 v183, s42, v182
    s_lshr_b32 s42, s37, 3
    s_lshl2_add_u32 s42, s42, s61
    s_lshl_b32 s42, s42, 13
    s_add_u32 s42, s42, s40
    v_add_u32 v182, s42, v182
    v_and_b32 v14, 0x3fff, v8
    s_add_u32 s40, s40, s41
    v_add_u32 v14, s40, v14
    v_xor_b32 v19, 0x4040, v14
    v_lshrrev_b32 v5, 1, v2
    v_xor_b32 v5, v5, v3
    v_lshlrev_b32 v5, 4, v5
    v_lshl_add_u32 v5, v2, 7, v5
    s_add_u32 s60, s51, 147456
    v_add_u32 v180, s60, v5
    v_add_u32 v180, 2048, v180
    v_xor_b32 v181, 64, v180
    s_lshl_b32 s43, s43, 12
    v_add_u32 v188, s43, v5
    v_xor_b32 v189, 0x860, v188
    v_xor_b32 v190, 64, v188
    v_xor_b32 v191, 64, v189
    v_lshrrev_b32 v5, 2, v2
    v_lshl_add_u32 v5, v3, 3, v5
    v_and_b32 v6, 3, v2
    v_lshlrev_b32 v6, 3, v6
    v_lshl_add_u32 v16, v5, 6, v6
    v_add_u32 v16, s60, v16
    s_sub_i32 s40, s61, 1
    s_max_i32 s40, s40, 0
    s_mul_i32 s40, s40, 2304
    s_add_u32 s40, s40, 147456
    v_add_u32 v196, s40, v4
    v_lshl_add_u32 v197, v1, 2, s40
    s_mul_i32 s40, s61, 6912
    s_add_u32 s40, s40, 147456
    v_add_u32 v198, s40, v4
    v_lshl_add_u32 v199, v1, 2, s40
    v_mfma_f32_32x32x16_bf16 v[148:163], v[244:247], v[244:247], 0
    v_mfma_f32_16x16x32_bf16 v[164:167], v[244:247], v[244:247], 0
    v_mfma_f32_16x16x32_bf16 v[168:171], v[244:247], v[244:247], 0
    v_and_b32 v5, 15, v1
    v_lshrrev_b32 v6, 4, v1
    v_mul_u32_u24 v6, 256, v6
    s_and_b32 s40, s36, 15
    s_lshr_b32 s40, s40, 2
    s_lshl_b32 s40, s40, 4
    v_add3_u32 v5, v5, v6, s40
    v_mul_lo_u32 v17, v5, s62
    v_add_u32 v17, s63, v17
    v_xor_b32 v200, 0x200, v17
    s_setprio 3
    s_add_u32 m0, s51, 1024
    s_movk_i32 s49, 0
    buffer_load_dwordx4 v9, s[4:7], s49 offen  lds
    s_add_u32 m0, s52, 2048
    s_add_u32 s50, s50, s48
    buffer_load_dwordx4 v12, s[8:11], s50 offen  lds
    s_add_u32 m0, s52, 3072
    s_nop 0
    buffer_load_dwordx4 v13, s[8:11], s50 offen  lds
    s_add_u32 m0, s51, 2048
    s_movk_i32 s49, 0
    buffer_load_dwordx4 v10, s[4:7], s49 offen  lds
    s_add_u32 m0, s52, 4096
    s_add_u32 s50, s50, s48
    buffer_load_dwordx4 v12, s[8:11], s50 offen  lds
    s_add_u32 m0, s52, 5120
    s_nop 0
    buffer_load_dwordx4 v13, s[8:11], s50 offen  lds
    s_add_u32 m0, s51, 3072
    s_movk_i32 s49, 0
    buffer_load_dwordx4 v11, s[4:7], s49 offen  lds
    s_add_u32 m0, s52, 6144
    s_add_u32 s50, s50, s48
    buffer_load_dwordx4 v12, s[8:11], s50 offen  lds
    s_add_u32 m0, s52, 7168
    s_nop 0
    buffer_load_dwordx4 v13, s[8:11], s50 offen  lds
    s_add_u32 m0, s51, 49152
    s_movk_i32 s49, 128
    buffer_load_dwordx4 v8, s[4:7], s49 offen  lds
    s_add_u32 m0, s52, 49152
    s_add_u32 s50, s50, s48
    buffer_load_dwordx4 v12, s[8:11], s50 offen  lds
    s_add_u32 m0, s52, 50176
    s_nop 0
    buffer_load_dwordx4 v13, s[8:11], s50 offen  lds
    s_add_u32 m0, s51, 50176
    s_movk_i32 s49, 128
    buffer_load_dwordx4 v9, s[4:7], s49 offen  lds
    s_add_u32 m0, s52, 51200
    s_add_u32 s50, s50, s48
    buffer_load_dwordx4 v12, s[8:11], s50 offen  lds
    s_add_u32 m0, s52, 52224
    s_nop 0
    buffer_load_dwordx4 v13, s[8:11], s50 offen  lds
    s_add_u32 m0, s51, 51200
    s_movk_i32 s49, 128
    buffer_load_dwordx4 v10, s[4:7], s49 offen  lds
    s_add_u32 m0, s52, 53248
    s_add_u32 s50, s50, s48
    buffer_load_dwordx4 v12, s[8:11], s50 offen  lds
    s_waitcnt lgkmcnt(0)
    s_mul_i32 s39, s39, 0x9E3779B1
    s_add_u32 s39, s39, 0x7F4A7C15
    v_mov_b32 v240, s39
    s_waitcnt vmcnt(8)
    s_and_b32 s40, s36, 3
    s_and_b32 s41, s37, 4
    s_cmp_eq_u32 s41, 4
    s_cbranch_scc1 K_sd
    s_cmp_eq_u32 s40, 1
    s_cbranch_scc1 K_ph0_1
    s_cmp_eq_u32 s40, 2
    s_cbranch_scc1 K_ph0_2
    s_cmp_eq_u32 s40, 3
    s_cbranch_scc1 K_ph0_3
    s_branch K_ph0_0
K_compute:
    s_lshr_b32 s40, s2, 3
    s_lshl2_add_u32 s40, s40, s38
    s_mul_i32 s40, s40, 512
    s_add_u32 s40, s40, 4096
    s_min_u32 s40, s40, ((K_codeend-gated_mix__grouped_kv_mqa__sliding_block__prompt_kernel)&0xfffff80)-512
    s_load_dwordx2 s[54:55], s[56:57], s40 offset:60
    s_load_dwordx2 s[54:55], s[56:57], s40 offset:188
    s_load_dwordx2 s[54:55], s[56:57], s40 offset:316
    s_load_dwordx2 s[54:55], s[56:57], s40 offset:444
    v_mfma_f32_32x32x16_bf16 v[92:107], v[244:247], v[244:247], 0
    v_mfma_f32_32x32x16_bf16 v[108:123], v[244:247], v[244:247], 0
    v_mfma_f32_32x32x16_bf16 v[124:139], v[244:247], v[244:247], 0
    v_mfma_f32_32x32x16_bf16 v[140:155], v[244:247], v[244:247], 0
    v_mfma_f32_32x32x16_bf16 v[156:171], v[244:247], v[244:247], 0
    v_mfma_f32_32x32x16_bf16 v[172:187], v[244:247], v[244:247], 0
    v_mfma_f32_32x32x16_bf16 v[188:203], v[244:247], v[244:247], 0
    v_mfma_f32_32x32x16_bf16 v[204:219], v[244:247], v[244:247], 0
    v_mov_b32 v22, v2
    v_add_u32 v23, 16, v2
    s_cmp_lt_u32 s38, 3
    s_cbranch_scc1 K_nov
    v_and_b32 v22, 12, v2
    v_add_u32 v22, v22, v2
    v_add_u32 v23, 4, v22
K_nov:
    v_bfe_u32 v20, v22, 1, 3
    v_bfe_u32 v21, v22, 4, 1
    v_mul_u32_u24 v21, 6, v21
    v_xor_b32 v20, v20, v21
    v_xor_b32 v20, v20, v3
    v_lshlrev_b32 v20, 4, v20
    v_lshl_add_u32 v8, v22, 7, v20
    v_bfe_u32 v20, v23, 1, 3
    v_bfe_u32 v21, v23, 4, 1
    v_mul_u32_u24 v21, 6, v21
    v_xor_b32 v20, v20, v21
    v_xor_b32 v20, v20, v3
    v_lshlrev_b32 v20, 4, v20
    v_lshl_add_u32 v9, v23, 7, v20
    v_xor_b32 v10, 64, v8
    v_xor_b32 v11, 64, v9
    v_lshrrev_b32 v5, 2, v2
    v_lshl_add_u32 v20, v3, 3, v5
    v_and_b32 v6, 3, v2
    v_lshlrev_b32 v6, 3, v6
    v_lshrrev_b32 v21, 3, v2
    v_lshl_or_b32 v21, v21, 5, v6
    v_and_b32 v6, 1, v3
    v_lshl_or_b32 v21, v6, 6, v21
    v_lshl_add_u32 v12, v20, 7, v21
    s_lshl_b32 s41, s38, 13
    s_add_u32 s41, s41, 16384
    v_add_u32 v12, s41, v12
    v_xor_b32 v13, 32, v12
    v_xor_b32 v14, 64, v12
    v_xor_b32 v15, 0x60, v12
    s_mov_b32 s48, 0
    s_mov_b32 s49, 0
    s_mov_b32 s51, 49152
    s_waitcnt lgkmcnt(0)
    s_mul_i32 s39, s39, 0x9E3779B1
    s_add_u32 s39, s39, 0x7F4A7C15
    v_mov_b32 v240, s39
    s_barrier
    ds_read_b128 v[20:23], v8 offset:0
    ds_read_b128 v[24:27], v10 offset:0
    ds_read_b64_tr_b16 v[68:69], v12 offset:0
    ds_read_b64_tr_b16 v[70:71], v12 offset:512
    ds_read_b64_tr_b16 v[72:73], v12 offset:4096
    ds_read_b64_tr_b16 v[74:75], v12 offset:4608
    ds_read_b64_tr_b16 v[80:81], v13 offset:4096
    ds_read_b64_tr_b16 v[82:83], v13 offset:4608
    ds_read_b64_tr_b16 v[76:77], v13 offset:0
    ds_read_b64_tr_b16 v[78:79], v13 offset:512
    ds_read_b64_tr_b16 v[52:53], v14 offset:0
    ds_read_b64_tr_b16 v[54:55], v14 offset:512
    ds_read_b64_tr_b16 v[56:57], v14 offset:4096
    ds_read_b64_tr_b16 v[58:59], v14 offset:4608
    ds_read_b64_tr_b16 v[64:65], v15 offset:4096
    ds_read_b64_tr_b16 v[66:67], v15 offset:4608
    ds_read_b64_tr_b16 v[60:61], v15 offset:0
    ds_read_b64_tr_b16 v[62:63], v15 offset:512
    ds_read_b128 v[28:31], v9 offset:0
    ds_read_b128 v[32:35], v11 offset:0
    s_cmp_eq_u32 s38, 3
    s_cbranch_scc1 K_vloop
    s_mov_b32 s50, 49152
    s_waitcnt lgkmcnt(0)
.p2align 6
K_nloop_top:
    v_mfma_f32_16x16x32_bf16 v[92:95], v[68:71], v[20:23], v[92:95]
    ds_read_b128 v[36:39], v8 offset:4096
    v_mfma_f32_16x16x32_bf16 v[92:95], v[72:75], v[24:27], v[92:95]
    ds_read_b128 v[40:43], v10 offset:4096
    v_mfma_f32_16x16x32_bf16 v[96:99], v[80:83], v[24:27], v[96:99]
    ds_read_b128 v[44:47], v9 offset:4096
    v_mfma_f32_16x16x32_bf16 v[96:99], v[76:79], v[20:23], v[96:99]
    s_waitcnt lgkmcnt(7)
    v_mfma_f32_16x16x32_bf16 v[100:103], v[52:55], v[20:23], v[100:103]
    ds_read_b128 v[48:51], v11 offset:4096
    v_mfma_f32_16x16x32_bf16 v[100:103], v[56:59], v[24:27], v[100:103]
    s_waitcnt lgkmcnt(6)
    v_mfma_f32_16x16x32_bf16 v[104:107], v[64:67], v[24:27], v[104:107]
    s_waitcnt lgkmcnt(4)
    v_mfma_f32_16x16x32_bf16 v[104:107], v[60:63], v[20:23], v[104:107]
    v_mfma_f32_16x16x32_bf16 v[120:123], v[60:63], v[28:31], v[120:123]
    ds_read_b128 v[20:23], v8 offset:8192
    v_mfma_f32_16x16x32_bf16 v[120:123], v[64:67], v[32:35], v[120:123]
    ds_read_b128 v[24:27], v10 offset:8192
    v_mfma_f32_16x16x32_bf16 v[116:119], v[56:59], v[32:35], v[116:119]
    v_add_u32 v12, s50, v12
    v_mfma_f32_16x16x32_bf16 v[116:119], v[52:55], v[28:31], v[116:119]
    v_add_u32 v13, s50, v13
    v_mfma_f32_16x16x32_bf16 v[112:115], v[76:79], v[28:31], v[112:115]
    v_add_u32 v14, s50, v14
    v_mfma_f32_16x16x32_bf16 v[112:115], v[80:83], v[32:35], v[112:115]
    v_add_u32 v15, s50, v15
    v_mfma_f32_16x16x32_bf16 v[108:111], v[72:75], v[32:35], v[108:111]
    v_mfma_f32_16x16x32_bf16 v[108:111], v[68:71], v[28:31], v[108:111]
    s_waitcnt lgkmcnt(2)
    v_mfma_f32_16x16x32_bf16 v[124:127], v[68:71], v[36:39], v[124:127]
    ds_read_b128 v[28:31], v9 offset:8192
    v_mfma_f32_16x16x32_bf16 v[124:127], v[72:75], v[40:43], v[124:127]
    ds_read_b128 v[32:35], v11 offset:8192
    v_mfma_f32_16x16x32_bf16 v[128:131], v[80:83], v[40:43], v[128:131]
    v_mfma_f32_16x16x32_bf16 v[128:131], v[76:79], v[36:39], v[128:131]
    v_mfma_f32_16x16x32_bf16 v[132:135], v[52:55], v[36:39], v[132:135]
    v_mfma_f32_16x16x32_bf16 v[132:135], v[56:59], v[40:43], v[132:135]
    v_mfma_f32_16x16x32_bf16 v[136:139], v[64:67], v[40:43], v[136:139]
    v_mfma_f32_16x16x32_bf16 v[136:139], v[60:63], v[36:39], v[136:139]
    v_mfma_f32_16x16x32_bf16 v[152:155], v[60:63], v[44:47], v[152:155]
    ds_read_b128 v[36:39], v8 offset:12288
    v_mfma_f32_16x16x32_bf16 v[152:155], v[64:67], v[48:51], v[152:155]
    ds_read_b128 v[40:43], v10 offset:12288
    v_mfma_f32_16x16x32_bf16 v[148:151], v[56:59], v[48:51], v[148:151]
    v_mfma_f32_16x16x32_bf16 v[148:151], v[52:55], v[44:47], v[148:151]
    v_mfma_f32_16x16x32_bf16 v[144:147], v[76:79], v[44:47], v[144:147]
    v_mfma_f32_16x16x32_bf16 v[144:147], v[80:83], v[48:51], v[144:147]
    v_mfma_f32_16x16x32_bf16 v[140:143], v[72:75], v[48:51], v[140:143]
    v_mfma_f32_16x16x32_bf16 v[140:143], v[68:71], v[44:47], v[140:143]
    s_waitcnt lgkmcnt(2)
    v_mfma_f32_16x16x32_bf16 v[156:159], v[68:71], v[20:23], v[156:159]
    ds_read_b128 v[44:47], v9 offset:12288
    v_mfma_f32_16x16x32_bf16 v[156:159], v[72:75], v[24:27], v[156:159]
    ds_read_b128 v[48:51], v11 offset:12288
    v_mfma_f32_16x16x32_bf16 v[160:163], v[80:83], v[24:27], v[160:163]
    v_add_u32 v8, s50, v8
    v_mfma_f32_16x16x32_bf16 v[160:163], v[76:79], v[20:23], v[160:163]
    v_add_u32 v9, s50, v9
    v_mfma_f32_16x16x32_bf16 v[164:167], v[52:55], v[20:23], v[164:167]
    v_add_u32 v10, s50, v10
    v_mfma_f32_16x16x32_bf16 v[164:167], v[56:59], v[24:27], v[164:167]
    v_add_u32 v11, s50, v11
    v_mfma_f32_16x16x32_bf16 v[168:171], v[64:67], v[24:27], v[168:171]
    v_mfma_f32_16x16x32_bf16 v[168:171], v[60:63], v[20:23], v[168:171]
    s_waitcnt lgkmcnt(0)
    s_barrier
    v_mfma_f32_16x16x32_bf16 v[184:187], v[60:63], v[28:31], v[184:187]
    ds_read_b128 v[20:23], v8 offset:0
    v_mfma_f32_16x16x32_bf16 v[184:187], v[64:67], v[32:35], v[184:187]
    ds_read_b128 v[24:27], v10 offset:0
    v_mfma_f32_16x16x32_bf16 v[180:183], v[56:59], v[32:35], v[180:183]
    ds_read_b64_tr_b16 v[84:85], v12 offset:0
    v_mfma_f32_16x16x32_bf16 v[180:183], v[52:55], v[28:31], v[180:183]
    ds_read_b64_tr_b16 v[86:87], v12 offset:512
    v_mfma_f32_16x16x32_bf16 v[176:179], v[76:79], v[28:31], v[176:179]
    ds_read_b64_tr_b16 v[88:89], v12 offset:4096
    v_mfma_f32_16x16x32_bf16 v[176:179], v[80:83], v[32:35], v[176:179]
    ds_read_b64_tr_b16 v[90:91], v12 offset:4608
    v_mfma_f32_16x16x32_bf16 v[172:175], v[72:75], v[32:35], v[172:175]
    s_add_u32 s49, s49, 1
    v_mfma_f32_16x16x32_bf16 v[172:175], v[68:71], v[28:31], v[172:175]
    s_cmp_eq_u32 s49, 2
    v_mfma_f32_16x16x32_bf16 v[188:191], v[68:71], v[36:39], v[188:191]
    ds_read_b128 v[28:31], v9 offset:0
    v_mfma_f32_16x16x32_bf16 v[188:191], v[72:75], v[40:43], v[188:191]
    ds_read_b128 v[32:35], v11 offset:0
    v_mfma_f32_16x16x32_bf16 v[192:195], v[80:83], v[40:43], v[192:195]
    ds_read_b64_tr_b16 v[236:237], v13 offset:4096
    v_mfma_f32_16x16x32_bf16 v[192:195], v[76:79], v[36:39], v[192:195]
    ds_read_b64_tr_b16 v[238:239], v13 offset:4608
    v_mfma_f32_16x16x32_bf16 v[196:199], v[52:55], v[36:39], v[196:199]
    ds_read_b64_tr_b16 v[232:233], v13 offset:0
    v_mfma_f32_16x16x32_bf16 v[196:199], v[56:59], v[40:43], v[196:199]
    ds_read_b64_tr_b16 v[234:235], v13 offset:512
    v_mfma_f32_16x16x32_bf16 v[200:203], v[64:67], v[40:43], v[200:203]
    s_cselect_b32 s49, -1, s49
    v_mfma_f32_16x16x32_bf16 v[200:203], v[60:63], v[36:39], v[200:203]
    s_cselect_b32 s50, 4294868992, s51
    v_mfma_f32_16x16x32_bf16 v[212:215], v[52:55], v[44:47], v[212:215]
    ds_read_b64_tr_b16 v[52:53], v14 offset:0
    v_mfma_f32_16x16x32_bf16 v[212:215], v[56:59], v[48:51], v[212:215]
    ds_read_b64_tr_b16 v[54:55], v14 offset:512
    v_mfma_f32_16x16x32_bf16 v[216:219], v[64:67], v[48:51], v[216:219]
    ds_read_b64_tr_b16 v[56:57], v14 offset:4096
    v_mfma_f32_16x16x32_bf16 v[216:219], v[60:63], v[44:47], v[216:219]
    ds_read_b64_tr_b16 v[58:59], v14 offset:4608
    v_mfma_f32_16x16x32_bf16 v[208:211], v[76:79], v[44:47], v[208:211]
    ds_read_b64_tr_b16 v[64:65], v15 offset:4096
    s_waitcnt lgkmcnt(5)
    v_mfma_f32_16x16x32_bf16 v[208:211], v[80:83], v[48:51], v[208:211]
    ds_read_b64_tr_b16 v[66:67], v15 offset:4608
    v_mfma_f32_16x16x32_bf16 v[204:207], v[72:75], v[48:51], v[204:207]
    ds_read_b64_tr_b16 v[60:61], v15 offset:0
    v_mfma_f32_16x16x32_bf16 v[204:207], v[68:71], v[44:47], v[204:207]
    ds_read_b64_tr_b16 v[62:63], v15 offset:512
    v_mfma_f32_16x16x32_bf16 v[92:95], v[84:87], v[20:23], v[92:95]
    ds_read_b128 v[36:39], v8 offset:4096
    v_mfma_f32_16x16x32_bf16 v[92:95], v[88:91], v[24:27], v[92:95]
    ds_read_b128 v[40:43], v10 offset:4096
    v_mfma_f32_16x16x32_bf16 v[96:99], v[236:239], v[24:27], v[96:99]
    ds_read_b128 v[44:47], v9 offset:4096
    v_mfma_f32_16x16x32_bf16 v[96:99], v[232:235], v[20:23], v[96:99]
    s_waitcnt lgkmcnt(7)
    v_mfma_f32_16x16x32_bf16 v[100:103], v[52:55], v[20:23], v[100:103]
    ds_read_b128 v[48:51], v11 offset:4096
    v_mfma_f32_16x16x32_bf16 v[100:103], v[56:59], v[24:27], v[100:103]
    s_waitcnt lgkmcnt(6)
    v_mfma_f32_16x16x32_bf16 v[104:107], v[64:67], v[24:27], v[104:107]
    s_waitcnt lgkmcnt(4)
    v_mfma_f32_16x16x32_bf16 v[104:107], v[60:63], v[20:23], v[104:107]
    v_mfma_f32_16x16x32_bf16 v[120:123], v[60:63], v[28:31], v[120:123]
    ds_read_b128 v[20:23], v8 offset:8192
    v_mfma_f32_16x16x32_bf16 v[120:123], v[64:67], v[32:35], v[120:123]
    ds_read_b128 v[24:27], v10 offset:8192
    v_mfma_f32_16x16x32_bf16 v[116:119], v[56:59], v[32:35], v[116:119]
    v_add_u32 v12, s50, v12
    v_mfma_f32_16x16x32_bf16 v[116:119], v[52:55], v[28:31], v[116:119]
    v_add_u32 v13, s50, v13
    v_mfma_f32_16x16x32_bf16 v[112:115], v[232:235], v[28:31], v[112:115]
    v_add_u32 v14, s50, v14
    v_mfma_f32_16x16x32_bf16 v[112:115], v[236:239], v[32:35], v[112:115]
    v_add_u32 v15, s50, v15
    v_mfma_f32_16x16x32_bf16 v[108:111], v[88:91], v[32:35], v[108:111]
    v_mfma_f32_16x16x32_bf16 v[108:111], v[84:87], v[28:31], v[108:111]
    s_waitcnt lgkmcnt(2)
    v_mfma_f32_16x16x32_bf16 v[124:127], v[84:87], v[36:39], v[124:127]
    ds_read_b128 v[28:31], v9 offset:8192
    v_mfma_f32_16x16x32_bf16 v[124:127], v[88:91], v[40:43], v[124:127]
    ds_read_b128 v[32:35], v11 offset:8192
    v_mfma_f32_16x16x32_bf16 v[128:131], v[236:239], v[40:43], v[128:131]
    s_add_u32 s48, s48, 1
    v_mfma_f32_16x16x32_bf16 v[128:131], v[232:235], v[36:39], v[128:131]
    v_mfma_f32_16x16x32_bf16 v[132:135], v[52:55], v[36:39], v[132:135]
    v_mfma_f32_16x16x32_bf16 v[132:135], v[56:59], v[40:43], v[132:135]
    v_mfma_f32_16x16x32_bf16 v[136:139], v[64:67], v[40:43], v[136:139]
    v_mfma_f32_16x16x32_bf16 v[136:139], v[60:63], v[36:39], v[136:139]
    v_mfma_f32_16x16x32_bf16 v[152:155], v[60:63], v[44:47], v[152:155]
    ds_read_b128 v[36:39], v8 offset:12288
    v_mfma_f32_16x16x32_bf16 v[152:155], v[64:67], v[48:51], v[152:155]
    ds_read_b128 v[40:43], v10 offset:12288
    v_mfma_f32_16x16x32_bf16 v[148:151], v[56:59], v[48:51], v[148:151]
    v_mfma_f32_16x16x32_bf16 v[148:151], v[52:55], v[44:47], v[148:151]
    v_mfma_f32_16x16x32_bf16 v[144:147], v[232:235], v[44:47], v[144:147]
    v_mfma_f32_16x16x32_bf16 v[144:147], v[236:239], v[48:51], v[144:147]
    v_mfma_f32_16x16x32_bf16 v[140:143], v[88:91], v[48:51], v[140:143]
    v_mfma_f32_16x16x32_bf16 v[140:143], v[84:87], v[44:47], v[140:143]
    s_waitcnt lgkmcnt(2)
    v_mfma_f32_16x16x32_bf16 v[156:159], v[84:87], v[20:23], v[156:159]
    ds_read_b128 v[44:47], v9 offset:12288
    v_mfma_f32_16x16x32_bf16 v[156:159], v[88:91], v[24:27], v[156:159]
    ds_read_b128 v[48:51], v11 offset:12288
    v_mfma_f32_16x16x32_bf16 v[160:163], v[236:239], v[24:27], v[160:163]
    v_add_u32 v8, s50, v8
    v_mfma_f32_16x16x32_bf16 v[160:163], v[232:235], v[20:23], v[160:163]
    v_add_u32 v9, s50, v9
    v_mfma_f32_16x16x32_bf16 v[164:167], v[52:55], v[20:23], v[164:167]
    v_add_u32 v10, s50, v10
    v_mfma_f32_16x16x32_bf16 v[164:167], v[56:59], v[24:27], v[164:167]
    v_add_u32 v11, s50, v11
    v_mfma_f32_16x16x32_bf16 v[168:171], v[64:67], v[24:27], v[168:171]
    s_cmp_eq_u32 s48, 8
    v_mfma_f32_16x16x32_bf16 v[168:171], v[60:63], v[20:23], v[168:171]
    s_waitcnt lgkmcnt(0)
    s_cbranch_scc1 K_nloop_nb
    s_barrier
K_nloop_nb:
    v_mfma_f32_16x16x32_bf16 v[184:187], v[60:63], v[28:31], v[184:187]
    ds_read_b128 v[20:23], v8 offset:0
    v_mfma_f32_16x16x32_bf16 v[184:187], v[64:67], v[32:35], v[184:187]
    ds_read_b128 v[24:27], v10 offset:0
    v_mfma_f32_16x16x32_bf16 v[180:183], v[56:59], v[32:35], v[180:183]
    ds_read_b64_tr_b16 v[68:69], v12 offset:0
    v_mfma_f32_16x16x32_bf16 v[180:183], v[52:55], v[28:31], v[180:183]
    ds_read_b64_tr_b16 v[70:71], v12 offset:512
    v_mfma_f32_16x16x32_bf16 v[176:179], v[232:235], v[28:31], v[176:179]
    ds_read_b64_tr_b16 v[72:73], v12 offset:4096
    v_mfma_f32_16x16x32_bf16 v[176:179], v[236:239], v[32:35], v[176:179]
    ds_read_b64_tr_b16 v[74:75], v12 offset:4608
    v_mfma_f32_16x16x32_bf16 v[172:175], v[88:91], v[32:35], v[172:175]
    s_add_u32 s49, s49, 1
    v_mfma_f32_16x16x32_bf16 v[172:175], v[84:87], v[28:31], v[172:175]
    s_cmp_eq_u32 s49, 2
    v_mfma_f32_16x16x32_bf16 v[188:191], v[84:87], v[36:39], v[188:191]
    ds_read_b128 v[28:31], v9 offset:0
    v_mfma_f32_16x16x32_bf16 v[188:191], v[88:91], v[40:43], v[188:191]
    ds_read_b128 v[32:35], v11 offset:0
    v_mfma_f32_16x16x32_bf16 v[192:195], v[236:239], v[40:43], v[192:195]
    ds_read_b64_tr_b16 v[80:81], v13 offset:4096
    v_mfma_f32_16x16x32_bf16 v[192:195], v[232:235], v[36:39], v[192:195]
    ds_read_b64_tr_b16 v[82:83], v13 offset:4608
    v_mfma_f32_16x16x32_bf16 v[196:199], v[52:55], v[36:39], v[196:199]
    ds_read_b64_tr_b16 v[76:77], v13 offset:0
    v_mfma_f32_16x16x32_bf16 v[196:199], v[56:59], v[40:43], v[196:199]
    ds_read_b64_tr_b16 v[78:79], v13 offset:512
    v_mfma_f32_16x16x32_bf16 v[200:203], v[64:67], v[40:43], v[200:203]
    s_cselect_b32 s49, -1, s49
    v_mfma_f32_16x16x32_bf16 v[200:203], v[60:63], v[36:39], v[200:203]
    s_cselect_b32 s50, 4294868992, s51
    v_mfma_f32_16x16x32_bf16 v[212:215], v[52:55], v[44:47], v[212:215]
    ds_read_b64_tr_b16 v[52:53], v14 offset:0
    v_mfma_f32_16x16x32_bf16 v[212:215], v[56:59], v[48:51], v[212:215]
    ds_read_b64_tr_b16 v[54:55], v14 offset:512
    v_mfma_f32_16x16x32_bf16 v[216:219], v[64:67], v[48:51], v[216:219]
    s_cmp_lt_u32 s48, 8
    ds_read_b64_tr_b16 v[56:57], v14 offset:4096
    v_mfma_f32_16x16x32_bf16 v[216:219], v[60:63], v[44:47], v[216:219]
    ds_read_b64_tr_b16 v[58:59], v14 offset:4608
    v_mfma_f32_16x16x32_bf16 v[208:211], v[232:235], v[44:47], v[208:211]
    ds_read_b64_tr_b16 v[64:65], v15 offset:4096
    s_waitcnt lgkmcnt(5)
    v_mfma_f32_16x16x32_bf16 v[208:211], v[236:239], v[48:51], v[208:211]
    ds_read_b64_tr_b16 v[66:67], v15 offset:4608
    v_mfma_f32_16x16x32_bf16 v[204:207], v[88:91], v[48:51], v[204:207]
    ds_read_b64_tr_b16 v[60:61], v15 offset:0
    v_mfma_f32_16x16x32_bf16 v[204:207], v[84:87], v[44:47], v[204:207]
    ds_read_b64_tr_b16 v[62:63], v15 offset:512
    s_cbranch_scc1 K_nloop_top
    s_branch K_epi
K_vloop:
    s_mov_b32 s50, 49152
    s_waitcnt lgkmcnt(0)
.p2align 6
K_vloop_top:
    v_mfma_f32_16x16x32_bf16 v[92:95], v[20:23], v[68:71], v[92:95]
    ds_read_b128 v[36:39], v8 offset:4096
    v_mfma_f32_16x16x32_bf16 v[92:95], v[24:27], v[72:75], v[92:95]
    ds_read_b128 v[40:43], v10 offset:4096
    v_mfma_f32_16x16x32_bf16 v[108:111], v[24:27], v[80:83], v[108:111]
    ds_read_b128 v[44:47], v9 offset:4096
    v_mfma_f32_16x16x32_bf16 v[108:111], v[20:23], v[76:79], v[108:111]
    s_waitcnt lgkmcnt(7)
    v_mfma_f32_16x16x32_bf16 v[100:103], v[20:23], v[52:55], v[100:103]
    ds_read_b128 v[48:51], v11 offset:4096
    v_mfma_f32_16x16x32_bf16 v[100:103], v[24:27], v[56:59], v[100:103]
    s_waitcnt lgkmcnt(6)
    v_mfma_f32_16x16x32_bf16 v[116:119], v[24:27], v[64:67], v[116:119]
    s_waitcnt lgkmcnt(4)
    v_mfma_f32_16x16x32_bf16 v[116:119], v[20:23], v[60:63], v[116:119]
    v_mfma_f32_16x16x32_bf16 v[120:123], v[28:31], v[60:63], v[120:123]
    ds_read_b128 v[20:23], v8 offset:8192
    v_mfma_f32_16x16x32_bf16 v[120:123], v[32:35], v[64:67], v[120:123]
    ds_read_b128 v[24:27], v10 offset:8192
    v_mfma_f32_16x16x32_bf16 v[104:107], v[32:35], v[56:59], v[104:107]
    v_add_u32 v12, s50, v12
    v_mfma_f32_16x16x32_bf16 v[104:107], v[28:31], v[52:55], v[104:107]
    v_add_u32 v13, s50, v13
    v_mfma_f32_16x16x32_bf16 v[112:115], v[28:31], v[76:79], v[112:115]
    v_add_u32 v14, s50, v14
    v_mfma_f32_16x16x32_bf16 v[112:115], v[32:35], v[80:83], v[112:115]
    v_add_u32 v15, s50, v15
    v_mfma_f32_16x16x32_bf16 v[96:99], v[32:35], v[72:75], v[96:99]
    v_mfma_f32_16x16x32_bf16 v[96:99], v[28:31], v[68:71], v[96:99]
    s_waitcnt lgkmcnt(2)
    v_mfma_f32_16x16x32_bf16 v[124:127], v[36:39], v[68:71], v[124:127]
    ds_read_b128 v[28:31], v9 offset:8192
    v_mfma_f32_16x16x32_bf16 v[124:127], v[40:43], v[72:75], v[124:127]
    ds_read_b128 v[32:35], v11 offset:8192
    v_mfma_f32_16x16x32_bf16 v[140:143], v[40:43], v[80:83], v[140:143]
    v_mfma_f32_16x16x32_bf16 v[140:143], v[36:39], v[76:79], v[140:143]
    v_mfma_f32_16x16x32_bf16 v[132:135], v[36:39], v[52:55], v[132:135]
    v_mfma_f32_16x16x32_bf16 v[132:135], v[40:43], v[56:59], v[132:135]
    v_mfma_f32_16x16x32_bf16 v[148:151], v[40:43], v[64:67], v[148:151]
    v_mfma_f32_16x16x32_bf16 v[148:151], v[36:39], v[60:63], v[148:151]
    v_mfma_f32_16x16x32_bf16 v[152:155], v[44:47], v[60:63], v[152:155]
    ds_read_b128 v[36:39], v8 offset:12288
    v_mfma_f32_16x16x32_bf16 v[152:155], v[48:51], v[64:67], v[152:155]
    ds_read_b128 v[40:43], v10 offset:12288
    v_mfma_f32_16x16x32_bf16 v[136:139], v[48:51], v[56:59], v[136:139]
    v_mfma_f32_16x16x32_bf16 v[136:139], v[44:47], v[52:55], v[136:139]
    v_mfma_f32_16x16x32_bf16 v[144:147], v[44:47], v[76:79], v[144:147]
    v_mfma_f32_16x16x32_bf16 v[144:147], v[48:51], v[80:83], v[144:147]
    v_mfma_f32_16x16x32_bf16 v[128:131], v[48:51], v[72:75], v[128:131]
    v_mfma_f32_16x16x32_bf16 v[128:131], v[44:47], v[68:71], v[128:131]
    s_waitcnt lgkmcnt(2)
    v_mfma_f32_16x16x32_bf16 v[156:159], v[20:23], v[68:71], v[156:159]
    ds_read_b128 v[44:47], v9 offset:12288
    v_mfma_f32_16x16x32_bf16 v[156:159], v[24:27], v[72:75], v[156:159]
    ds_read_b128 v[48:51], v11 offset:12288
    v_mfma_f32_16x16x32_bf16 v[172:175], v[24:27], v[80:83], v[172:175]
    v_add_u32 v8, s50, v8
    v_mfma_f32_16x16x32_bf16 v[172:175], v[20:23], v[76:79], v[172:175]
    v_add_u32 v9, s50, v9
    v_mfma_f32_16x16x32_bf16 v[164:167], v[20:23], v[52:55], v[164:167]
    v_add_u32 v10, s50, v10
    v_mfma_f32_16x16x32_bf16 v[164:167], v[24:27], v[56:59], v[164:167]
    v_add_u32 v11, s50, v11
    v_mfma_f32_16x16x32_bf16 v[180:183], v[24:27], v[64:67], v[180:183]
    v_mfma_f32_16x16x32_bf16 v[180:183], v[20:23], v[60:63], v[180:183]
    s_waitcnt lgkmcnt(0)
    s_barrier
    v_mfma_f32_16x16x32_bf16 v[184:187], v[28:31], v[60:63], v[184:187]
    ds_read_b128 v[20:23], v8 offset:0
    v_mfma_f32_16x16x32_bf16 v[184:187], v[32:35], v[64:67], v[184:187]
    ds_read_b128 v[24:27], v10 offset:0
    v_mfma_f32_16x16x32_bf16 v[168:171], v[32:35], v[56:59], v[168:171]
    ds_read_b64_tr_b16 v[84:85], v12 offset:0
    v_mfma_f32_16x16x32_bf16 v[168:171], v[28:31], v[52:55], v[168:171]
    ds_read_b64_tr_b16 v[86:87], v12 offset:512
    v_mfma_f32_16x16x32_bf16 v[176:179], v[28:31], v[76:79], v[176:179]
    ds_read_b64_tr_b16 v[88:89], v12 offset:4096
    v_mfma_f32_16x16x32_bf16 v[176:179], v[32:35], v[80:83], v[176:179]
    ds_read_b64_tr_b16 v[90:91], v12 offset:4608
    v_mfma_f32_16x16x32_bf16 v[160:163], v[32:35], v[72:75], v[160:163]
    s_add_u32 s49, s49, 1
    v_mfma_f32_16x16x32_bf16 v[160:163], v[28:31], v[68:71], v[160:163]
    s_cmp_eq_u32 s49, 2
    v_mfma_f32_16x16x32_bf16 v[188:191], v[36:39], v[68:71], v[188:191]
    ds_read_b128 v[28:31], v9 offset:0
    v_mfma_f32_16x16x32_bf16 v[188:191], v[40:43], v[72:75], v[188:191]
    ds_read_b128 v[32:35], v11 offset:0
    v_mfma_f32_16x16x32_bf16 v[204:207], v[40:43], v[80:83], v[204:207]
    ds_read_b64_tr_b16 v[236:237], v13 offset:4096
    v_mfma_f32_16x16x32_bf16 v[204:207], v[36:39], v[76:79], v[204:207]
    ds_read_b64_tr_b16 v[238:239], v13 offset:4608
    v_mfma_f32_16x16x32_bf16 v[196:199], v[36:39], v[52:55], v[196:199]
    ds_read_b64_tr_b16 v[232:233], v13 offset:0
    v_mfma_f32_16x16x32_bf16 v[196:199], v[40:43], v[56:59], v[196:199]
    ds_read_b64_tr_b16 v[234:235], v13 offset:512
    v_mfma_f32_16x16x32_bf16 v[212:215], v[40:43], v[64:67], v[212:215]
    s_cselect_b32 s49, -1, s49
    v_mfma_f32_16x16x32_bf16 v[212:215], v[36:39], v[60:63], v[212:215]
    s_cselect_b32 s50, 4294868992, s51
    v_mfma_f32_16x16x32_bf16 v[200:203], v[44:47], v[52:55], v[200:203]
    ds_read_b64_tr_b16 v[52:53], v14 offset:0
    v_mfma_f32_16x16x32_bf16 v[200:203], v[48:51], v[56:59], v[200:203]
    ds_read_b64_tr_b16 v[54:55], v14 offset:512
    v_mfma_f32_16x16x32_bf16 v[216:219], v[48:51], v[64:67], v[216:219]
    ds_read_b64_tr_b16 v[56:57], v14 offset:4096
    v_mfma_f32_16x16x32_bf16 v[216:219], v[44:47], v[60:63], v[216:219]
    ds_read_b64_tr_b16 v[58:59], v14 offset:4608
    v_mfma_f32_16x16x32_bf16 v[208:211], v[44:47], v[76:79], v[208:211]
    ds_read_b64_tr_b16 v[64:65], v15 offset:4096
    s_waitcnt lgkmcnt(5)
    v_mfma_f32_16x16x32_bf16 v[208:211], v[48:51], v[80:83], v[208:211]
    ds_read_b64_tr_b16 v[66:67], v15 offset:4608
    v_mfma_f32_16x16x32_bf16 v[192:195], v[48:51], v[72:75], v[192:195]
    ds_read_b64_tr_b16 v[60:61], v15 offset:0
    v_mfma_f32_16x16x32_bf16 v[192:195], v[44:47], v[68:71], v[192:195]
    ds_read_b64_tr_b16 v[62:63], v15 offset:512
    v_mfma_f32_16x16x32_bf16 v[92:95], v[20:23], v[84:87], v[92:95]
    ds_read_b128 v[36:39], v8 offset:4096
    v_mfma_f32_16x16x32_bf16 v[92:95], v[24:27], v[88:91], v[92:95]
    ds_read_b128 v[40:43], v10 offset:4096
    v_mfma_f32_16x16x32_bf16 v[108:111], v[24:27], v[236:239], v[108:111]
    ds_read_b128 v[44:47], v9 offset:4096
    v_mfma_f32_16x16x32_bf16 v[108:111], v[20:23], v[232:235], v[108:111]
    s_waitcnt lgkmcnt(7)
    v_mfma_f32_16x16x32_bf16 v[100:103], v[20:23], v[52:55], v[100:103]
    ds_read_b128 v[48:51], v11 offset:4096
    v_mfma_f32_16x16x32_bf16 v[100:103], v[24:27], v[56:59], v[100:103]
    s_waitcnt lgkmcnt(6)
    v_mfma_f32_16x16x32_bf16 v[116:119], v[24:27], v[64:67], v[116:119]
    s_waitcnt lgkmcnt(4)
    v_mfma_f32_16x16x32_bf16 v[116:119], v[20:23], v[60:63], v[116:119]
    v_mfma_f32_16x16x32_bf16 v[120:123], v[28:31], v[60:63], v[120:123]
    ds_read_b128 v[20:23], v8 offset:8192
    v_mfma_f32_16x16x32_bf16 v[120:123], v[32:35], v[64:67], v[120:123]
    ds_read_b128 v[24:27], v10 offset:8192
    v_mfma_f32_16x16x32_bf16 v[104:107], v[32:35], v[56:59], v[104:107]
    v_add_u32 v12, s50, v12
    v_mfma_f32_16x16x32_bf16 v[104:107], v[28:31], v[52:55], v[104:107]
    v_add_u32 v13, s50, v13
    v_mfma_f32_16x16x32_bf16 v[112:115], v[28:31], v[232:235], v[112:115]
    v_add_u32 v14, s50, v14
    v_mfma_f32_16x16x32_bf16 v[112:115], v[32:35], v[236:239], v[112:115]
    v_add_u32 v15, s50, v15
    v_mfma_f32_16x16x32_bf16 v[96:99], v[32:35], v[88:91], v[96:99]
    v_mfma_f32_16x16x32_bf16 v[96:99], v[28:31], v[84:87], v[96:99]
    s_waitcnt lgkmcnt(2)
    v_mfma_f32_16x16x32_bf16 v[124:127], v[36:39], v[84:87], v[124:127]
    ds_read_b128 v[28:31], v9 offset:8192
    v_mfma_f32_16x16x32_bf16 v[124:127], v[40:43], v[88:91], v[124:127]
    ds_read_b128 v[32:35], v11 offset:8192
    v_mfma_f32_16x16x32_bf16 v[140:143], v[40:43], v[236:239], v[140:143]
    s_add_u32 s48, s48, 1
    v_mfma_f32_16x16x32_bf16 v[140:143], v[36:39], v[232:235], v[140:143]
    v_mfma_f32_16x16x32_bf16 v[132:135], v[36:39], v[52:55], v[132:135]
    v_mfma_f32_16x16x32_bf16 v[132:135], v[40:43], v[56:59], v[132:135]
    v_mfma_f32_16x16x32_bf16 v[148:151], v[40:43], v[64:67], v[148:151]
    v_mfma_f32_16x16x32_bf16 v[148:151], v[36:39], v[60:63], v[148:151]
    v_mfma_f32_16x16x32_bf16 v[152:155], v[44:47], v[60:63], v[152:155]
    ds_read_b128 v[36:39], v8 offset:12288
    v_mfma_f32_16x16x32_bf16 v[152:155], v[48:51], v[64:67], v[152:155]
    ds_read_b128 v[40:43], v10 offset:12288
    v_mfma_f32_16x16x32_bf16 v[136:139], v[48:51], v[56:59], v[136:139]
    v_mfma_f32_16x16x32_bf16 v[136:139], v[44:47], v[52:55], v[136:139]
    v_mfma_f32_16x16x32_bf16 v[144:147], v[44:47], v[232:235], v[144:147]
    v_mfma_f32_16x16x32_bf16 v[144:147], v[48:51], v[236:239], v[144:147]
    v_mfma_f32_16x16x32_bf16 v[128:131], v[48:51], v[88:91], v[128:131]
    v_mfma_f32_16x16x32_bf16 v[128:131], v[44:47], v[84:87], v[128:131]
    s_waitcnt lgkmcnt(2)
    v_mfma_f32_16x16x32_bf16 v[156:159], v[20:23], v[84:87], v[156:159]
    ds_read_b128 v[44:47], v9 offset:12288
    v_mfma_f32_16x16x32_bf16 v[156:159], v[24:27], v[88:91], v[156:159]
    ds_read_b128 v[48:51], v11 offset:12288
    v_mfma_f32_16x16x32_bf16 v[172:175], v[24:27], v[236:239], v[172:175]
    v_add_u32 v8, s50, v8
    v_mfma_f32_16x16x32_bf16 v[172:175], v[20:23], v[232:235], v[172:175]
    v_add_u32 v9, s50, v9
    v_mfma_f32_16x16x32_bf16 v[164:167], v[20:23], v[52:55], v[164:167]
    v_add_u32 v10, s50, v10
    v_mfma_f32_16x16x32_bf16 v[164:167], v[24:27], v[56:59], v[164:167]
    v_add_u32 v11, s50, v11
    v_mfma_f32_16x16x32_bf16 v[180:183], v[24:27], v[64:67], v[180:183]
    s_cmp_eq_u32 s48, 8
    v_mfma_f32_16x16x32_bf16 v[180:183], v[20:23], v[60:63], v[180:183]
    s_waitcnt lgkmcnt(0)
    s_cbranch_scc1 K_vloop_nb
    s_barrier
K_vloop_nb:
    v_mfma_f32_16x16x32_bf16 v[184:187], v[28:31], v[60:63], v[184:187]
    ds_read_b128 v[20:23], v8 offset:0
    v_mfma_f32_16x16x32_bf16 v[184:187], v[32:35], v[64:67], v[184:187]
    ds_read_b128 v[24:27], v10 offset:0
    v_mfma_f32_16x16x32_bf16 v[168:171], v[32:35], v[56:59], v[168:171]
    ds_read_b64_tr_b16 v[68:69], v12 offset:0
    v_mfma_f32_16x16x32_bf16 v[168:171], v[28:31], v[52:55], v[168:171]
    ds_read_b64_tr_b16 v[70:71], v12 offset:512
    v_mfma_f32_16x16x32_bf16 v[176:179], v[28:31], v[232:235], v[176:179]
    ds_read_b64_tr_b16 v[72:73], v12 offset:4096
    v_mfma_f32_16x16x32_bf16 v[176:179], v[32:35], v[236:239], v[176:179]
    ds_read_b64_tr_b16 v[74:75], v12 offset:4608
    v_mfma_f32_16x16x32_bf16 v[160:163], v[32:35], v[88:91], v[160:163]
    s_add_u32 s49, s49, 1
    v_mfma_f32_16x16x32_bf16 v[160:163], v[28:31], v[84:87], v[160:163]
    s_cmp_eq_u32 s49, 2
    v_mfma_f32_16x16x32_bf16 v[188:191], v[36:39], v[84:87], v[188:191]
    ds_read_b128 v[28:31], v9 offset:0
    v_mfma_f32_16x16x32_bf16 v[188:191], v[40:43], v[88:91], v[188:191]
    ds_read_b128 v[32:35], v11 offset:0
    v_mfma_f32_16x16x32_bf16 v[204:207], v[40:43], v[236:239], v[204:207]
    ds_read_b64_tr_b16 v[80:81], v13 offset:4096
    v_mfma_f32_16x16x32_bf16 v[204:207], v[36:39], v[232:235], v[204:207]
    ds_read_b64_tr_b16 v[82:83], v13 offset:4608
    v_mfma_f32_16x16x32_bf16 v[196:199], v[36:39], v[52:55], v[196:199]
    ds_read_b64_tr_b16 v[76:77], v13 offset:0
    v_mfma_f32_16x16x32_bf16 v[196:199], v[40:43], v[56:59], v[196:199]
    ds_read_b64_tr_b16 v[78:79], v13 offset:512
    v_mfma_f32_16x16x32_bf16 v[212:215], v[40:43], v[64:67], v[212:215]
    s_cselect_b32 s49, -1, s49
    v_mfma_f32_16x16x32_bf16 v[212:215], v[36:39], v[60:63], v[212:215]
    s_cselect_b32 s50, 4294868992, s51
    v_mfma_f32_16x16x32_bf16 v[200:203], v[44:47], v[52:55], v[200:203]
    ds_read_b64_tr_b16 v[52:53], v14 offset:0
    v_mfma_f32_16x16x32_bf16 v[200:203], v[48:51], v[56:59], v[200:203]
    ds_read_b64_tr_b16 v[54:55], v14 offset:512
    v_mfma_f32_16x16x32_bf16 v[216:219], v[48:51], v[64:67], v[216:219]
    s_cmp_lt_u32 s48, 8
    ds_read_b64_tr_b16 v[56:57], v14 offset:4096
    v_mfma_f32_16x16x32_bf16 v[216:219], v[44:47], v[60:63], v[216:219]
    ds_read_b64_tr_b16 v[58:59], v14 offset:4608
    v_mfma_f32_16x16x32_bf16 v[208:211], v[44:47], v[232:235], v[208:211]
    ds_read_b64_tr_b16 v[64:65], v15 offset:4096
    s_waitcnt lgkmcnt(5)
    v_mfma_f32_16x16x32_bf16 v[208:211], v[48:51], v[236:239], v[208:211]
    ds_read_b64_tr_b16 v[66:67], v15 offset:4608
    v_mfma_f32_16x16x32_bf16 v[192:195], v[48:51], v[88:91], v[192:195]
    ds_read_b64_tr_b16 v[60:61], v15 offset:0
    v_mfma_f32_16x16x32_bf16 v[192:195], v[44:47], v[84:87], v[192:195]
    ds_read_b64_tr_b16 v[62:63], v15 offset:512
    s_cbranch_scc1 K_vloop_top
K_epi:
    v_lshlrev_b32 v5, 9, v3
    v_lshl_add_u32 v5, v2, 4, v5
    s_and_b32 s40, s38, 1
    s_lshl_b32 s40, s40, 11
    s_add_u32 s41, s40, 131072
    s_add_u32 s42, s40, 65536
    s_cmp_ge_u32 s38, 2
    s_cselect_b32 s41, s42, s41
    v_add_u32 v251, s41, v5
    s_cbranch_scc1 K_epikv
    s_cmp_eq_u32 s38, 0
    s_cbranch_scc0 K_epiqb
    v_cvt_pk_bf16_f32 v219, v218, v219
    v_cvt_pk_bf16_f32 v218, v216, v217
    v_cvt_pk_bf16_f32 v217, v214, v215
    v_cvt_pk_bf16_f32 v216, v212, v213
    ds_write_b128 v251, v[216:219] offset:28928
    v_cvt_pk_bf16_f32 v215, v210, v211
    v_cvt_pk_bf16_f32 v214, v208, v209
    v_cvt_pk_bf16_f32 v213, v206, v207
    v_cvt_pk_bf16_f32 v212, v204, v205
    ds_write_b128 v251, v[212:215] offset:24832
    v_cvt_pk_bf16_f32 v211, v202, v203
    v_cvt_pk_bf16_f32 v210, v200, v201
    v_cvt_pk_bf16_f32 v209, v198, v199
    v_cvt_pk_bf16_f32 v208, v196, v197
    ds_write_b128 v251, v[208:211] offset:28672
    v_cvt_pk_bf16_f32 v207, v194, v195
    v_cvt_pk_bf16_f32 v206, v192, v193
    v_cvt_pk_bf16_f32 v205, v190, v191
    v_cvt_pk_bf16_f32 v204, v188, v189
    ds_write_b128 v251, v[204:207] offset:24576
    v_cvt_pk_bf16_f32 v203, v186, v187
    v_cvt_pk_bf16_f32 v202, v184, v185
    v_cvt_pk_bf16_f32 v201, v182, v183
    v_cvt_pk_bf16_f32 v200, v180, v181
    ds_write_b128 v251, v[200:203] offset:20736
    v_cvt_pk_bf16_f32 v199, v178, v179
    v_cvt_pk_bf16_f32 v198, v176, v177
    v_cvt_pk_bf16_f32 v197, v174, v175
    v_cvt_pk_bf16_f32 v196, v172, v173
    ds_write_b128 v251, v[196:199] offset:16640
    v_cvt_pk_bf16_f32 v195, v170, v171
    v_cvt_pk_bf16_f32 v194, v168, v169
    v_cvt_pk_bf16_f32 v193, v166, v167
    v_cvt_pk_bf16_f32 v192, v164, v165
    ds_write_b128 v251, v[192:195] offset:20480
    v_cvt_pk_bf16_f32 v191, v162, v163
    v_cvt_pk_bf16_f32 v190, v160, v161
    v_cvt_pk_bf16_f32 v189, v158, v159
    v_cvt_pk_bf16_f32 v188, v156, v157
    ds_write_b128 v251, v[188:191] offset:16384
    v_cvt_pk_bf16_f32 v187, v154, v155
    v_cvt_pk_bf16_f32 v186, v152, v153
    v_cvt_pk_bf16_f32 v185, v150, v151
    v_cvt_pk_bf16_f32 v184, v148, v149
    ds_write_b128 v251, v[184:187] offset:12544
    v_cvt_pk_bf16_f32 v183, v146, v147
    v_cvt_pk_bf16_f32 v182, v144, v145
    v_cvt_pk_bf16_f32 v181, v142, v143
    v_cvt_pk_bf16_f32 v180, v140, v141
    ds_write_b128 v251, v[180:183] offset:8448
    v_cvt_pk_bf16_f32 v179, v138, v139
    v_cvt_pk_bf16_f32 v178, v136, v137
    v_cvt_pk_bf16_f32 v177, v134, v135
    v_cvt_pk_bf16_f32 v176, v132, v133
    ds_write_b128 v251, v[176:179] offset:12288
    v_cvt_pk_bf16_f32 v175, v130, v131
    v_cvt_pk_bf16_f32 v174, v128, v129
    v_cvt_pk_bf16_f32 v173, v126, v127
    v_cvt_pk_bf16_f32 v172, v124, v125
    ds_write_b128 v251, v[172:175] offset:8192
    v_cvt_pk_bf16_f32 v171, v122, v123
    v_cvt_pk_bf16_f32 v170, v120, v121
    v_cvt_pk_bf16_f32 v169, v118, v119
    v_cvt_pk_bf16_f32 v168, v116, v117
    ds_write_b128 v251, v[168:171] offset:4352
    v_cvt_pk_bf16_f32 v167, v114, v115
    v_cvt_pk_bf16_f32 v166, v112, v113
    v_cvt_pk_bf16_f32 v165, v110, v111
    v_cvt_pk_bf16_f32 v164, v108, v109
    ds_write_b128 v251, v[164:167] offset:256
    v_cvt_pk_bf16_f32 v163, v106, v107
    v_cvt_pk_bf16_f32 v162, v104, v105
    v_cvt_pk_bf16_f32 v161, v102, v103
    v_cvt_pk_bf16_f32 v160, v100, v101
    ds_write_b128 v251, v[160:163] offset:4096
    v_cvt_pk_bf16_f32 v159, v98, v99
    v_cvt_pk_bf16_f32 v158, v96, v97
    v_cvt_pk_bf16_f32 v157, v94, v95
    v_cvt_pk_bf16_f32 v156, v92, v93
    ds_write_b128 v251, v[156:159] offset:0
    s_branch K_join
K_epiqb:
    s_mov_b32 s52, 0x3e8293ee
    s_mov_b32 s53, 0x3e8293ee
    v_pk_mul_f32 v[212:213], v[212:213], s[52:53]
    v_pk_mul_f32 v[214:215], v[214:215], s[52:53]
    v_pk_mul_f32 v[216:217], v[216:217], s[52:53]
    v_pk_mul_f32 v[218:219], v[218:219], s[52:53]
    v_cvt_pk_bf16_f32 v219, v218, v219
    v_cvt_pk_bf16_f32 v218, v216, v217
    v_cvt_pk_bf16_f32 v217, v214, v215
    v_cvt_pk_bf16_f32 v216, v212, v213
    ds_write_b128 v251, v[216:219] offset:28928
    v_pk_mul_f32 v[204:205], v[204:205], s[52:53]
    v_pk_mul_f32 v[206:207], v[206:207], s[52:53]
    v_pk_mul_f32 v[208:209], v[208:209], s[52:53]
    v_pk_mul_f32 v[210:211], v[210:211], s[52:53]
    v_cvt_pk_bf16_f32 v215, v210, v211
    v_cvt_pk_bf16_f32 v214, v208, v209
    v_cvt_pk_bf16_f32 v213, v206, v207
    v_cvt_pk_bf16_f32 v212, v204, v205
    ds_write_b128 v251, v[212:215] offset:24832
    v_pk_mul_f32 v[196:197], v[196:197], s[52:53]
    v_pk_mul_f32 v[198:199], v[198:199], s[52:53]
    v_pk_mul_f32 v[200:201], v[200:201], s[52:53]
    v_pk_mul_f32 v[202:203], v[202:203], s[52:53]
    v_cvt_pk_bf16_f32 v211, v202, v203
    v_cvt_pk_bf16_f32 v210, v200, v201
    v_cvt_pk_bf16_f32 v209, v198, v199
    v_cvt_pk_bf16_f32 v208, v196, v197
    ds_write_b128 v251, v[208:211] offset:28672
    v_pk_mul_f32 v[188:189], v[188:189], s[52:53]
    v_pk_mul_f32 v[190:191], v[190:191], s[52:53]
    v_pk_mul_f32 v[192:193], v[192:193], s[52:53]
    v_pk_mul_f32 v[194:195], v[194:195], s[52:53]
    v_cvt_pk_bf16_f32 v207, v194, v195
    v_cvt_pk_bf16_f32 v206, v192, v193
    v_cvt_pk_bf16_f32 v205, v190, v191
    v_cvt_pk_bf16_f32 v204, v188, v189
    ds_write_b128 v251, v[204:207] offset:24576
    v_pk_mul_f32 v[180:181], v[180:181], s[52:53]
    v_pk_mul_f32 v[182:183], v[182:183], s[52:53]
    v_pk_mul_f32 v[184:185], v[184:185], s[52:53]
    v_pk_mul_f32 v[186:187], v[186:187], s[52:53]
    v_cvt_pk_bf16_f32 v203, v186, v187
    v_cvt_pk_bf16_f32 v202, v184, v185
    v_cvt_pk_bf16_f32 v201, v182, v183
    v_cvt_pk_bf16_f32 v200, v180, v181
    ds_write_b128 v251, v[200:203] offset:20736
    v_pk_mul_f32 v[172:173], v[172:173], s[52:53]
    v_pk_mul_f32 v[174:175], v[174:175], s[52:53]
    v_pk_mul_f32 v[176:177], v[176:177], s[52:53]
    v_pk_mul_f32 v[178:179], v[178:179], s[52:53]
    v_cvt_pk_bf16_f32 v199, v178, v179
    v_cvt_pk_bf16_f32 v198, v176, v177
    v_cvt_pk_bf16_f32 v197, v174, v175
    v_cvt_pk_bf16_f32 v196, v172, v173
    ds_write_b128 v251, v[196:199] offset:16640
    v_pk_mul_f32 v[164:165], v[164:165], s[52:53]
    v_pk_mul_f32 v[166:167], v[166:167], s[52:53]
    v_pk_mul_f32 v[168:169], v[168:169], s[52:53]
    v_pk_mul_f32 v[170:171], v[170:171], s[52:53]
    v_cvt_pk_bf16_f32 v195, v170, v171
    v_cvt_pk_bf16_f32 v194, v168, v169
    v_cvt_pk_bf16_f32 v193, v166, v167
    v_cvt_pk_bf16_f32 v192, v164, v165
    ds_write_b128 v251, v[192:195] offset:20480
    v_pk_mul_f32 v[156:157], v[156:157], s[52:53]
    v_pk_mul_f32 v[158:159], v[158:159], s[52:53]
    v_pk_mul_f32 v[160:161], v[160:161], s[52:53]
    v_pk_mul_f32 v[162:163], v[162:163], s[52:53]
    v_cvt_pk_bf16_f32 v191, v162, v163
    v_cvt_pk_bf16_f32 v190, v160, v161
    v_cvt_pk_bf16_f32 v189, v158, v159
    v_cvt_pk_bf16_f32 v188, v156, v157
    ds_write_b128 v251, v[188:191] offset:16384
    v_pk_mul_f32 v[148:149], v[148:149], s[52:53]
    v_pk_mul_f32 v[150:151], v[150:151], s[52:53]
    v_pk_mul_f32 v[152:153], v[152:153], s[52:53]
    v_pk_mul_f32 v[154:155], v[154:155], s[52:53]
    v_cvt_pk_bf16_f32 v187, v154, v155
    v_cvt_pk_bf16_f32 v186, v152, v153
    v_cvt_pk_bf16_f32 v185, v150, v151
    v_cvt_pk_bf16_f32 v184, v148, v149
    ds_write_b128 v251, v[184:187] offset:12544
    v_pk_mul_f32 v[140:141], v[140:141], s[52:53]
    v_pk_mul_f32 v[142:143], v[142:143], s[52:53]
    v_pk_mul_f32 v[144:145], v[144:145], s[52:53]
    v_pk_mul_f32 v[146:147], v[146:147], s[52:53]
    v_cvt_pk_bf16_f32 v183, v146, v147
    v_cvt_pk_bf16_f32 v182, v144, v145
    v_cvt_pk_bf16_f32 v181, v142, v143
    v_cvt_pk_bf16_f32 v180, v140, v141
    ds_write_b128 v251, v[180:183] offset:8448
    v_pk_mul_f32 v[132:133], v[132:133], s[52:53]
    v_pk_mul_f32 v[134:135], v[134:135], s[52:53]
    v_pk_mul_f32 v[136:137], v[136:137], s[52:53]
    v_pk_mul_f32 v[138:139], v[138:139], s[52:53]
    v_cvt_pk_bf16_f32 v179, v138, v139
    v_cvt_pk_bf16_f32 v178, v136, v137
    v_cvt_pk_bf16_f32 v177, v134, v135
    v_cvt_pk_bf16_f32 v176, v132, v133
    ds_write_b128 v251, v[176:179] offset:12288
    v_pk_mul_f32 v[124:125], v[124:125], s[52:53]
    v_pk_mul_f32 v[126:127], v[126:127], s[52:53]
    v_pk_mul_f32 v[128:129], v[128:129], s[52:53]
    v_pk_mul_f32 v[130:131], v[130:131], s[52:53]
    v_cvt_pk_bf16_f32 v175, v130, v131
    v_cvt_pk_bf16_f32 v174, v128, v129
    v_cvt_pk_bf16_f32 v173, v126, v127
    v_cvt_pk_bf16_f32 v172, v124, v125
    ds_write_b128 v251, v[172:175] offset:8192
    v_pk_mul_f32 v[116:117], v[116:117], s[52:53]
    v_pk_mul_f32 v[118:119], v[118:119], s[52:53]
    v_pk_mul_f32 v[120:121], v[120:121], s[52:53]
    v_pk_mul_f32 v[122:123], v[122:123], s[52:53]
    v_cvt_pk_bf16_f32 v171, v122, v123
    v_cvt_pk_bf16_f32 v170, v120, v121
    v_cvt_pk_bf16_f32 v169, v118, v119
    v_cvt_pk_bf16_f32 v168, v116, v117
    ds_write_b128 v251, v[168:171] offset:4352
    v_pk_mul_f32 v[108:109], v[108:109], s[52:53]
    v_pk_mul_f32 v[110:111], v[110:111], s[52:53]
    v_pk_mul_f32 v[112:113], v[112:113], s[52:53]
    v_pk_mul_f32 v[114:115], v[114:115], s[52:53]
    v_cvt_pk_bf16_f32 v167, v114, v115
    v_cvt_pk_bf16_f32 v166, v112, v113
    v_cvt_pk_bf16_f32 v165, v110, v111
    v_cvt_pk_bf16_f32 v164, v108, v109
    ds_write_b128 v251, v[164:167] offset:256
    v_pk_mul_f32 v[100:101], v[100:101], s[52:53]
    v_pk_mul_f32 v[102:103], v[102:103], s[52:53]
    v_pk_mul_f32 v[104:105], v[104:105], s[52:53]
    v_pk_mul_f32 v[106:107], v[106:107], s[52:53]
    v_cvt_pk_bf16_f32 v163, v106, v107
    v_cvt_pk_bf16_f32 v162, v104, v105
    v_cvt_pk_bf16_f32 v161, v102, v103
    v_cvt_pk_bf16_f32 v160, v100, v101
    ds_write_b128 v251, v[160:163] offset:4096
    v_pk_mul_f32 v[92:93], v[92:93], s[52:53]
    v_pk_mul_f32 v[94:95], v[94:95], s[52:53]
    v_pk_mul_f32 v[96:97], v[96:97], s[52:53]
    v_pk_mul_f32 v[98:99], v[98:99], s[52:53]
    v_cvt_pk_bf16_f32 v159, v98, v99
    v_cvt_pk_bf16_f32 v158, v96, v97
    v_cvt_pk_bf16_f32 v157, v94, v95
    v_cvt_pk_bf16_f32 v156, v92, v93
    ds_write_b128 v251, v[156:159] offset:0
    s_branch K_join
K_epikv:
    s_lshl_b32 s41, s37, 19
    s_lshl_b32 s42, s36, 14
    s_add_u32 s41, s41, s42
    s_add_u32 s41, s41, s40
    s_add_u32 s42, s41, 274432
    v_cvt_pk_bf16_f32 v219, v218, v219
    v_cvt_pk_bf16_f32 v218, v216, v217
    v_cvt_pk_bf16_f32 v217, v214, v215
    v_cvt_pk_bf16_f32 v216, v212, v213
    ds_write_b128 v251, v[216:219] offset:28928
    buffer_store_dwordx4 v[216:219], v5, s[20:23], s42 offen offset:256 sc1
    s_add_u32 s42, s41, 12288
    v_cvt_pk_bf16_f32 v215, v210, v211
    v_cvt_pk_bf16_f32 v214, v208, v209
    v_cvt_pk_bf16_f32 v213, v206, v207
    v_cvt_pk_bf16_f32 v212, v204, v205
    ds_write_b128 v251, v[212:215] offset:24832
    buffer_store_dwordx4 v[212:215], v5, s[20:23], s42 offen offset:256 sc1
    s_add_u32 s42, s41, 274432
    v_cvt_pk_bf16_f32 v211, v202, v203
    v_cvt_pk_bf16_f32 v210, v200, v201
    v_cvt_pk_bf16_f32 v209, v198, v199
    v_cvt_pk_bf16_f32 v208, v196, v197
    ds_write_b128 v251, v[208:211] offset:28672
    buffer_store_dwordx4 v[208:211], v5, s[20:23], s42 offen offset:0 sc1
    s_add_u32 s42, s41, 12288
    v_cvt_pk_bf16_f32 v207, v194, v195
    v_cvt_pk_bf16_f32 v206, v192, v193
    v_cvt_pk_bf16_f32 v205, v190, v191
    v_cvt_pk_bf16_f32 v204, v188, v189
    ds_write_b128 v251, v[204:207] offset:24576
    buffer_store_dwordx4 v[204:207], v5, s[20:23], s42 offen offset:0 sc1
    s_add_u32 s42, s41, 270336
    v_cvt_pk_bf16_f32 v203, v186, v187
    v_cvt_pk_bf16_f32 v202, v184, v185
    v_cvt_pk_bf16_f32 v201, v182, v183
    v_cvt_pk_bf16_f32 v200, v180, v181
    ds_write_b128 v251, v[200:203] offset:20736
    buffer_store_dwordx4 v[200:203], v5, s[20:23], s42 offen offset:256 sc1
    s_add_u32 s42, s41, 8192
    v_cvt_pk_bf16_f32 v199, v178, v179
    v_cvt_pk_bf16_f32 v198, v176, v177
    v_cvt_pk_bf16_f32 v197, v174, v175
    v_cvt_pk_bf16_f32 v196, v172, v173
    ds_write_b128 v251, v[196:199] offset:16640
    buffer_store_dwordx4 v[196:199], v5, s[20:23], s42 offen offset:256 sc1
    s_add_u32 s42, s41, 270336
    v_cvt_pk_bf16_f32 v195, v170, v171
    v_cvt_pk_bf16_f32 v194, v168, v169
    v_cvt_pk_bf16_f32 v193, v166, v167
    v_cvt_pk_bf16_f32 v192, v164, v165
    ds_write_b128 v251, v[192:195] offset:20480
    buffer_store_dwordx4 v[192:195], v5, s[20:23], s42 offen offset:0 sc1
    s_add_u32 s42, s41, 8192
    v_cvt_pk_bf16_f32 v191, v162, v163
    v_cvt_pk_bf16_f32 v190, v160, v161
    v_cvt_pk_bf16_f32 v189, v158, v159
    v_cvt_pk_bf16_f32 v188, v156, v157
    ds_write_b128 v251, v[188:191] offset:16384
    buffer_store_dwordx4 v[188:191], v5, s[20:23], s42 offen offset:0 sc1
    s_add_u32 s42, s41, 266240
    v_cvt_pk_bf16_f32 v187, v154, v155
    v_cvt_pk_bf16_f32 v186, v152, v153
    v_cvt_pk_bf16_f32 v185, v150, v151
    v_cvt_pk_bf16_f32 v184, v148, v149
    ds_write_b128 v251, v[184:187] offset:12544
    buffer_store_dwordx4 v[184:187], v5, s[20:23], s42 offen offset:256 sc1
    s_add_u32 s42, s41, 4096
    v_cvt_pk_bf16_f32 v183, v146, v147
    v_cvt_pk_bf16_f32 v182, v144, v145
    v_cvt_pk_bf16_f32 v181, v142, v143
    v_cvt_pk_bf16_f32 v180, v140, v141
    ds_write_b128 v251, v[180:183] offset:8448
    buffer_store_dwordx4 v[180:183], v5, s[20:23], s42 offen offset:256 sc1
    s_add_u32 s42, s41, 266240
    v_cvt_pk_bf16_f32 v179, v138, v139
    v_cvt_pk_bf16_f32 v178, v136, v137
    v_cvt_pk_bf16_f32 v177, v134, v135
    v_cvt_pk_bf16_f32 v176, v132, v133
    ds_write_b128 v251, v[176:179] offset:12288
    buffer_store_dwordx4 v[176:179], v5, s[20:23], s42 offen offset:0 sc1
    s_add_u32 s42, s41, 4096
    v_cvt_pk_bf16_f32 v175, v130, v131
    v_cvt_pk_bf16_f32 v174, v128, v129
    v_cvt_pk_bf16_f32 v173, v126, v127
    v_cvt_pk_bf16_f32 v172, v124, v125
    ds_write_b128 v251, v[172:175] offset:8192
    buffer_store_dwordx4 v[172:175], v5, s[20:23], s42 offen offset:0 sc1
    s_add_u32 s42, s41, 262144
    v_cvt_pk_bf16_f32 v171, v122, v123
    v_cvt_pk_bf16_f32 v170, v120, v121
    v_cvt_pk_bf16_f32 v169, v118, v119
    v_cvt_pk_bf16_f32 v168, v116, v117
    ds_write_b128 v251, v[168:171] offset:4352
    buffer_store_dwordx4 v[168:171], v5, s[20:23], s42 offen offset:256 sc1
    s_add_u32 s42, s41, 0
    v_cvt_pk_bf16_f32 v167, v114, v115
    v_cvt_pk_bf16_f32 v166, v112, v113
    v_cvt_pk_bf16_f32 v165, v110, v111
    v_cvt_pk_bf16_f32 v164, v108, v109
    ds_write_b128 v251, v[164:167] offset:256
    buffer_store_dwordx4 v[164:167], v5, s[20:23], s42 offen offset:256 sc1
    s_add_u32 s42, s41, 262144
    v_cvt_pk_bf16_f32 v163, v106, v107
    v_cvt_pk_bf16_f32 v162, v104, v105
    v_cvt_pk_bf16_f32 v161, v102, v103
    v_cvt_pk_bf16_f32 v160, v100, v101
    ds_write_b128 v251, v[160:163] offset:4096
    buffer_store_dwordx4 v[160:163], v5, s[20:23], s42 offen offset:0 sc1
    s_add_u32 s42, s41, 0
    v_cvt_pk_bf16_f32 v159, v98, v99
    v_cvt_pk_bf16_f32 v158, v96, v97
    v_cvt_pk_bf16_f32 v157, v94, v95
    v_cvt_pk_bf16_f32 v156, v92, v93
    ds_write_b128 v251, v[156:159] offset:0
    buffer_store_dwordx4 v[156:159], v5, s[20:23], s42 offen offset:0 sc1
K_join:
    s_waitcnt lgkmcnt(0)
    s_barrier
    v_add_u32 v252, 122880, v242
    v_xor_b32 v6, 0x1000, v252
    ds_read_b128 v[8:11], v252
    ds_read_b128 v[96:99], v241
    ds_read_b128 v[12:15], v252 offset:1024
    ds_read_b128 v[100:103], v241 offset:1024
    ds_read_b128 v[16:19], v6
    ds_read_b128 v[20:23], v6 offset:1024
    ds_read_b128 v[112:115], v241 offset:2048
    ds_read_b128 v[116:119], v241 offset:3072
    v_mfma_f32_32x32x16_bf16 v[24:39], v[244:247], v[244:247], 0
    v_mfma_f32_16x16x32_bf16 v[56:59], v[244:247], v[244:247], 0
    s_add_u32 s49, s67, 98304
    s_sub_u32 s53, s38, 1
    s_waitcnt lgkmcnt(6)
    v_mfma_f32_32x32x16_bf16 v[64:79], v[96:99], v[8:11], 0
    s_waitcnt lgkmcnt(4)
    v_mfma_f32_32x32x16_bf16 v[64:79], v[100:103], v[12:15], v[64:79]
    v_mfma_f32_32x32x16_bf16 v[40:55], v[244:247], v[244:247], 0
    v_mfma_f32_16x16x32_bf16 v[60:63], v[244:247], v[244:247], 0
    v_mfma_f32_32x32x16_bf16 v[136:151], v[244:247], v[244:247], 0
    v_mfma_f32_16x16x32_bf16 v[152:155], v[244:247], v[244:247], 0
    s_nop 7
    s_mov_b32 s54, 0
    v_exp_f32 v64, v64
    v_exp_f32 v65, v65
    s_waitcnt lgkmcnt(0)
    ds_read_b128 v[104:107], v241 offset:4096
    v_exp_f32 v66, v66
    v_exp_f32 v67, v67
    v_exp_f32 v68, v68
    s_setprio 1
    ds_read_b128 v[108:111], v241 offset:5120
    v_exp_f32 v69, v69
    v_mfma_f32_32x32x16_bf16 v[80:95], v[96:99], v[16:19], 0
    ds_read_b128 v[120:123], v241 offset:6144
    v_exp_f32 v70, v70
    v_exp_f32 v71, v71
    v_exp_f32 v72, v72
    v_mfma_f32_32x32x16_bf16 v[80:95], v[100:103], v[20:23], v[80:95]
    ds_read_b128 v[124:127], v241 offset:7168
    v_exp_f32 v73, v73
    v_exp_f32 v74, v74
    v_exp_f32 v75, v75
    v_smfmac_f32_32x32x32_bf16 v[24:39], v[112:115], v[64:71], v224
    v_exp_f32 v76, v76
    v_exp_f32 v77, v77
    v_exp_f32 v78, v78
    v_smfmac_f32_16x16x64_bf16 v[56:59], v[220:223], v[64:71], v224
    v_exp_f32 v79, v79
    v_exp_f32 v80, v80
    v_exp_f32 v81, v81
    v_smfmac_f32_32x32x32_bf16 v[24:39], v[116:119], v[72:79], v224
    s_waitcnt lgkmcnt(0)
    v_exp_f32 v82, v82
    v_exp_f32 v83, v83
    v_exp_f32 v84, v84
    v_smfmac_f32_16x16x64_bf16 v[56:59], v[220:223], v[72:79], v224
    s_setprio 0
    v_exp_f32 v85, v85
    v_mfma_f32_32x32x16_bf16 v[64:79], v[104:107], v[8:11], 0
    v_exp_f32 v86, v86
    v_exp_f32 v87, v87
    v_exp_f32 v88, v88
    v_mfma_f32_32x32x16_bf16 v[64:79], v[108:111], v[12:15], v[64:79]
    v_exp_f32 v89, v89
    v_exp_f32 v90, v90
    v_exp_f32 v91, v91
    v_smfmac_f32_32x32x32_bf16 v[40:55], v[112:115], v[80:87], v224
    v_exp_f32 v92, v92
    v_exp_f32 v93, v93
    v_exp_f32 v94, v94
    v_smfmac_f32_16x16x64_bf16 v[60:63], v[220:223], v[80:87], v224
    v_exp_f32 v95, v95
    v_exp_f32 v64, v64
    v_exp_f32 v65, v65
    v_smfmac_f32_32x32x32_bf16 v[40:55], v[116:119], v[88:95], v224
    s_cmp_eq_u32 s44, 0
    s_cbranch_scc1 K_s0_110
    s_waitcnt vmcnt(0)
K_s0_110:
    s_barrier
    ds_read_b128 v[96:99], v241 offset:16384
    v_exp_f32 v66, v66
    v_exp_f32 v67, v67
    v_exp_f32 v68, v68
    v_smfmac_f32_16x16x64_bf16 v[60:63], v[220:223], v[88:95], v224
    s_setprio 3
    ds_read_b128 v[100:103], v241 offset:17408
    v_exp_f32 v69, v69
    v_mfma_f32_32x32x16_bf16 v[80:95], v[104:107], v[16:19], 0
    ds_read_b128 v[112:115], v241 offset:18432
    v_exp_f32 v70, v70
    v_exp_f32 v71, v71
    v_exp_f32 v72, v72
    v_mfma_f32_32x32x16_bf16 v[80:95], v[108:111], v[20:23], v[80:95]
    ds_read_b128 v[116:119], v241 offset:19456
    v_exp_f32 v73, v73
    v_exp_f32 v74, v74
    v_exp_f32 v75, v75
    v_smfmac_f32_32x32x32_bf16 v[24:39], v[120:123], v[64:71], v224
    s_add_u32 m0, s49, 0
    s_add_u32 s48, s67, 16842752
    buffer_load_dwordx4 v4, s[20:23], s48 offen sc1 lds
    v_exp_f32 v76, v76
    v_exp_f32 v77, v77
    v_exp_f32 v78, v78
    v_smfmac_f32_16x16x64_bf16 v[56:59], v[220:223], v[64:71], v224
    buffer_load_dwordx4 v4, s[20:23], s48 offen offset:1024 sc1 lds
    v_exp_f32 v79, v79
    v_exp_f32 v80, v80
    v_exp_f32 v81, v81
    v_smfmac_f32_32x32x32_bf16 v[24:39], v[124:127], v[72:79], v224
    s_waitcnt lgkmcnt(0)
    s_cmp_eq_u32 s38, 4
    s_cbranch_scc0 K_f1_100
    v_lshlrev_b32 v5, 7, v1
    s_mov_b32 s51, 17301504
    buffer_load_dwordx4 v[212:215], v5, s[20:23], s51 offen sc1
K_f1_100:
    v_exp_f32 v82, v82
    v_exp_f32 v83, v83
    v_exp_f32 v84, v84
    v_smfmac_f32_16x16x64_bf16 v[56:59], v[220:223], v[72:79], v224
    s_setprio 2
    v_exp_f32 v85, v85
    v_mfma_f32_32x32x16_bf16 v[64:79], v[96:99], v[8:11], 0
    ds_read_b128 v[128:131], v252 offset:2048
    ds_read_b128 v[132:135], v252 offset:3072
    v_exp_f32 v86, v86
    v_exp_f32 v87, v87
    v_exp_f32 v88, v88
    v_mfma_f32_32x32x16_bf16 v[64:79], v[100:103], v[12:15], v[64:79]
    ds_read_b128 v[156:159], v4 offset:49152
    ds_read_b128 v[160:163], v4 offset:50176
    v_exp_f32 v89, v89
    v_exp_f32 v90, v90
    v_exp_f32 v91, v91
    v_smfmac_f32_32x32x32_bf16 v[40:55], v[120:123], v[80:87], v224
    ds_read_b128 v[164:167], v4 offset:51200
    ds_read_b128 v[168:171], v4 offset:52224
    v_exp_f32 v92, v92
    v_exp_f32 v93, v93
    v_exp_f32 v94, v94
    v_smfmac_f32_16x16x64_bf16 v[60:63], v[220:223], v[80:87], v224
    v_exp_f32 v95, v95
    v_exp_f32 v64, v64
    v_exp_f32 v65, v65
    v_smfmac_f32_32x32x32_bf16 v[40:55], v[124:127], v[88:95], v224
    ds_read_b128 v[104:107], v241 offset:20480
    v_exp_f32 v66, v66
    v_exp_f32 v67, v67
    v_exp_f32 v68, v68
    v_smfmac_f32_16x16x64_bf16 v[60:63], v[220:223], v[88:95], v224
    s_setprio 1
    ds_read_b128 v[108:111], v241 offset:21504
    v_exp_f32 v69, v69
    v_mfma_f32_32x32x16_bf16 v[80:95], v[96:99], v[16:19], 0
    ds_read_b128 v[120:123], v241 offset:22528
    v_exp_f32 v70, v70
    v_exp_f32 v71, v71
    v_exp_f32 v72, v72
    v_mfma_f32_32x32x16_bf16 v[80:95], v[100:103], v[20:23], v[80:95]
    ds_read_b128 v[124:127], v241 offset:23552
    v_exp_f32 v73, v73
    v_exp_f32 v74, v74
    v_exp_f32 v75, v75
    v_smfmac_f32_32x32x32_bf16 v[24:39], v[112:115], v[64:71], v224
    ds_read_b128 v[172:175], v4 offset:53248
    ds_read_b128 v[176:179], v4 offset:54272
    v_exp_f32 v76, v76
    v_exp_f32 v77, v77
    v_exp_f32 v78, v78
    v_smfmac_f32_16x16x64_bf16 v[56:59], v[220:223], v[64:71], v224
    v_exp_f32 v79, v79
    v_exp_f32 v80, v80
    v_exp_f32 v81, v81
    v_smfmac_f32_32x32x32_bf16 v[24:39], v[116:119], v[72:79], v224
    s_waitcnt lgkmcnt(0)
    ds_read_b128 v[180:183], v4 offset:55296
    ds_read_b128 v[184:187], v4 offset:56320
    v_exp_f32 v82, v82
    v_exp_f32 v83, v83
    v_exp_f32 v84, v84
    v_smfmac_f32_16x16x64_bf16 v[56:59], v[220:223], v[72:79], v224
    s_setprio 0
    v_exp_f32 v85, v85
    v_mfma_f32_32x32x16_bf16 v[64:79], v[104:107], v[8:11], 0
    v_exp_f32 v86, v86
    v_exp_f32 v87, v87
    v_exp_f32 v88, v88
    v_mfma_f32_32x32x16_bf16 v[64:79], v[108:111], v[12:15], v[64:79]
    v_exp_f32 v89, v89
    v_exp_f32 v90, v90
    v_exp_f32 v91, v91
    v_smfmac_f32_32x32x32_bf16 v[40:55], v[112:115], v[80:87], v224
    v_exp_f32 v92, v92
    v_exp_f32 v93, v93
    v_exp_f32 v94, v94
    v_smfmac_f32_16x16x64_bf16 v[60:63], v[220:223], v[80:87], v224
    v_exp_f32 v95, v95
    v_exp_f32 v64, v64
    v_exp_f32 v65, v65
    v_smfmac_f32_32x32x32_bf16 v[40:55], v[116:119], v[88:95], v224
    s_waitcnt vmcnt(0) lgkmcnt(0)
    s_barrier
    ds_read_b128 v[96:99], v241 offset:0
    v_exp_f32 v66, v66
    v_exp_f32 v67, v67
    v_exp_f32 v68, v68
    v_smfmac_f32_16x16x64_bf16 v[60:63], v[220:223], v[88:95], v224
    s_setprio 3
    ds_read_b128 v[100:103], v241 offset:1024
    v_exp_f32 v69, v69
    v_mfma_f32_32x32x16_bf16 v[80:95], v[104:107], v[16:19], 0
    ds_read_b128 v[112:115], v241 offset:2048
    v_exp_f32 v70, v70
    v_exp_f32 v71, v71
    v_exp_f32 v72, v72
    v_mfma_f32_32x32x16_bf16 v[80:95], v[108:111], v[20:23], v[80:95]
    ds_read_b128 v[116:119], v241 offset:3072
    v_exp_f32 v73, v73
    v_exp_f32 v74, v74
    v_exp_f32 v75, v75
    v_smfmac_f32_32x32x32_bf16 v[24:39], v[120:123], v[64:71], v224
    s_add_u32 m0, s49, 16384
    s_add_u32 s48, s67, 16859136
    buffer_load_dwordx4 v4, s[20:23], s48 offen sc1 lds
    v_exp_f32 v76, v76
    v_exp_f32 v77, v77
    v_exp_f32 v78, v78
    v_smfmac_f32_16x16x64_bf16 v[56:59], v[220:223], v[64:71], v224
    buffer_load_dwordx4 v4, s[20:23], s48 offen offset:1024 sc1 lds
    v_exp_f32 v79, v79
    v_exp_f32 v80, v80
    v_exp_f32 v81, v81
    v_smfmac_f32_32x32x32_bf16 v[24:39], v[124:127], v[72:79], v224
    s_waitcnt lgkmcnt(0)
    s_sub_u32 s40, s38, 2
    s_cmp_lt_u32 s40, 2
    s_cbranch_scc0 K_kf_103
    s_waitcnt vmcnt(4)
    s_lshl_b32 s41, s37, 4
    s_add_u32 s41, s41, s36
    s_lshl_b32 s41, s41, 5
    s_add_u32 s41, s41, s40
    s_lshl_b32 s41, s41, 2
    s_add_u32 s41, s41, 17309696
    s_mov_b64 exec, 1
    buffer_store_dword v240, off, s[20:23], s41 sc1
    s_mov_b64 exec, -1
K_kf_103:
    v_exp_f32 v82, v82
    v_exp_f32 v83, v83
    v_exp_f32 v84, v84
    v_smfmac_f32_16x16x64_bf16 v[56:59], v[220:223], v[72:79], v224
    s_setprio 2
    v_exp_f32 v85, v85
    v_mfma_f32_32x32x16_bf16 v[64:79], v[96:99], v[8:11], 0
    v_mfma_f32_32x32x16_bf16 v[188:203], v[244:247], v[244:247], 0
    s_cmp_eq_u32 s38, 4
    s_cbranch_scc0 K_f3_102
    s_waitcnt vmcnt(2)
K_f2_101:
    v_cmp_ne_u32 vcc, s39, v212
    v_cmp_ne_u32 s[42:43], s39, v213
    s_or_b64 vcc, vcc, s[42:43]
    v_cmp_ne_u32 s[42:43], s39, v214
    s_or_b64 vcc, vcc, s[42:43]
    v_cmp_ne_u32 s[42:43], s39, v215
    s_or_b64 vcc, vcc, s[42:43]
    s_cbranch_vccz K_f3_102
    s_add_u32 s3, s3, 1
    s_cmp_gt_u32 s3, 1048576
    s_cbranch_scc1 K_f3_102
    buffer_load_dwordx4 v[212:215], v5, s[20:23], s51 offen sc1
    s_waitcnt vmcnt(0)
    s_branch K_f2_101
K_f3_102:
    v_exp_f32 v86, v86
    v_exp_f32 v87, v87
    v_exp_f32 v88, v88
    v_mfma_f32_32x32x16_bf16 v[64:79], v[100:103], v[12:15], v[64:79]
    v_exp_f32 v89, v89
    v_exp_f32 v90, v90
    v_exp_f32 v91, v91
    v_smfmac_f32_32x32x32_bf16 v[40:55], v[120:123], v[80:87], v224
    v_exp_f32 v92, v92
    v_exp_f32 v93, v93
    v_exp_f32 v94, v94
    v_smfmac_f32_16x16x64_bf16 v[60:63], v[220:223], v[80:87], v224
    v_exp_f32 v95, v95
    v_exp_f32 v64, v64
    v_exp_f32 v65, v65
    v_smfmac_f32_32x32x32_bf16 v[40:55], v[124:127], v[88:95], v224
    ds_read_b128 v[104:107], v241 offset:4096
    v_exp_f32 v66, v66
    v_exp_f32 v67, v67
    v_exp_f32 v68, v68
    v_smfmac_f32_16x16x64_bf16 v[60:63], v[220:223], v[88:95], v224
    s_setprio 1
    ds_read_b128 v[108:111], v241 offset:5120
    v_exp_f32 v69, v69
    v_mfma_f32_32x32x16_bf16 v[80:95], v[96:99], v[16:19], 0
    ds_read_b128 v[120:123], v241 offset:6144
    v_exp_f32 v70, v70
    v_exp_f32 v71, v71
    v_exp_f32 v72, v72
    v_mfma_f32_32x32x16_bf16 v[80:95], v[100:103], v[20:23], v[80:95]
    ds_read_b128 v[124:127], v241 offset:7168
    v_exp_f32 v73, v73
    v_exp_f32 v74, v74
    v_exp_f32 v75, v75
    v_smfmac_f32_32x32x32_bf16 v[24:39], v[112:115], v[64:71], v224
    v_exp_f32 v76, v76
    v_exp_f32 v77, v77
    v_exp_f32 v78, v78
    v_smfmac_f32_16x16x64_bf16 v[56:59], v[220:223], v[64:71], v224
    v_exp_f32 v79, v79
    v_exp_f32 v80, v80
    v_exp_f32 v81, v81
    v_smfmac_f32_32x32x32_bf16 v[24:39], v[116:119], v[72:79], v224
    s_waitcnt lgkmcnt(0)
    v_exp_f32 v82, v82
    v_exp_f32 v83, v83
    v_exp_f32 v84, v84
    v_smfmac_f32_16x16x64_bf16 v[56:59], v[220:223], v[72:79], v224
    s_setprio 0
    v_exp_f32 v85, v85
    v_mfma_f32_32x32x16_bf16 v[64:79], v[104:107], v[8:11], 0
    v_exp_f32 v86, v86
    v_exp_f32 v87, v87
    v_exp_f32 v88, v88
    v_mfma_f32_32x32x16_bf16 v[64:79], v[108:111], v[12:15], v[64:79]
    v_exp_f32 v89, v89
    v_exp_f32 v90, v90
    v_exp_f32 v91, v91
    v_smfmac_f32_32x32x32_bf16 v[40:55], v[112:115], v[80:87], v224
    v_exp_f32 v92, v92
    v_exp_f32 v93, v93
    v_exp_f32 v94, v94
    v_smfmac_f32_16x16x64_bf16 v[60:63], v[220:223], v[80:87], v224
    v_exp_f32 v95, v95
    v_exp_f32 v64, v64
    v_exp_f32 v65, v65
    v_smfmac_f32_32x32x32_bf16 v[40:55], v[116:119], v[88:95], v224
    s_waitcnt vmcnt(0)
    s_barrier
    ds_read_b128 v[96:99], v241 offset:16384
    v_exp_f32 v66, v66
    v_exp_f32 v67, v67
    v_exp_f32 v68, v68
    v_smfmac_f32_16x16x64_bf16 v[60:63], v[220:223], v[88:95], v224
    s_setprio 3
    ds_read_b128 v[100:103], v241 offset:17408
    v_exp_f32 v69, v69
    v_mfma_f32_32x32x16_bf16 v[80:95], v[104:107], v[16:19], 0
    ds_read_b128 v[112:115], v241 offset:18432
    v_exp_f32 v70, v70
    v_exp_f32 v71, v71
    v_exp_f32 v72, v72
    v_mfma_f32_32x32x16_bf16 v[80:95], v[108:111], v[20:23], v[80:95]
    ds_read_b128 v[116:119], v241 offset:19456
    v_exp_f32 v73, v73
    v_exp_f32 v74, v74
    v_exp_f32 v75, v75
    v_smfmac_f32_32x32x32_bf16 v[24:39], v[120:123], v[64:71], v224
    s_add_u32 m0, s49, 0
    s_add_u32 s48, s67, 16908288
    buffer_load_dwordx4 v4, s[20:23], s48 offen sc1 lds
    v_exp_f32 v76, v76
    v_exp_f32 v77, v77
    v_exp_f32 v78, v78
    v_smfmac_f32_16x16x64_bf16 v[56:59], v[220:223], v[64:71], v224
    buffer_load_dwordx4 v4, s[20:23], s48 offen offset:1024 sc1 lds
    v_exp_f32 v79, v79
    v_exp_f32 v80, v80
    v_exp_f32 v81, v81
    v_smfmac_f32_32x32x32_bf16 v[24:39], v[124:127], v[72:79], v224
    s_waitcnt lgkmcnt(0)
    s_lshl_b32 s41, s45, 7
    s_add_u32 s41, s41, 17039360
    buffer_load_dword v248, v249, s[20:23], s41 offen sc1
    v_exp_f32 v82, v82
    v_exp_f32 v83, v83
    v_exp_f32 v84, v84
    v_smfmac_f32_16x16x64_bf16 v[56:59], v[220:223], v[72:79], v224
    s_setprio 2
    v_exp_f32 v85, v85
    v_mfma_f32_32x32x16_bf16 v[64:79], v[96:99], v[8:11], 0
    s_cmp_lt_u32 s45, 8
    s_cbranch_scc0 K_co_99
    v_mov_b32 v172, s47
    v_mov_b32 v173, s47
    v_mov_b32 v174, s47
    v_mov_b32 v175, s47
    v_mov_b32 v176, s47
    v_mov_b32 v177, s47
    v_mov_b32 v178, s47
    v_mov_b32 v179, s47
    v_mov_b32 v180, s47
    v_mov_b32 v181, s47
    v_mov_b32 v182, s47
    v_mov_b32 v183, s47
    v_mov_b32 v184, s47
    v_mov_b32 v185, s47
    v_mov_b32 v186, s47
    v_mov_b32 v187, s47
K_co_99:
    v_exp_f32 v86, v86
    v_exp_f32 v87, v87
    v_exp_f32 v88, v88
    v_mfma_f32_32x32x16_bf16 v[64:79], v[100:103], v[12:15], v[64:79]
    s_or_b32 s40, s2, s38
    s_cbranch_scc1 K_ep_104
    s_mov_b32 s41, 17375232
    s_mov_b64 exec, 1
    buffer_store_dword v240, off, s[20:23], s41 sc1
    s_mov_b64 exec, -1
K_ep_104:
    v_exp_f32 v89, v89
    v_exp_f32 v90, v90
    v_exp_f32 v91, v91
    v_smfmac_f32_32x32x32_bf16 v[40:55], v[120:123], v[80:87], v224
    v_exp_f32 v92, v92
    v_exp_f32 v93, v93
    v_exp_f32 v94, v94
    v_smfmac_f32_16x16x64_bf16 v[60:63], v[220:223], v[80:87], v224
    v_exp_f32 v95, v95
    v_exp_f32 v64, v64
    v_exp_f32 v65, v65
    v_smfmac_f32_32x32x32_bf16 v[40:55], v[124:127], v[88:95], v224
    ds_read_b128 v[104:107], v241 offset:20480
    v_exp_f32 v66, v66
    v_exp_f32 v67, v67
    v_exp_f32 v68, v68
    v_smfmac_f32_16x16x64_bf16 v[60:63], v[220:223], v[88:95], v224
    s_setprio 1
    ds_read_b128 v[108:111], v241 offset:21504
    v_exp_f32 v69, v69
    v_mfma_f32_32x32x16_bf16 v[80:95], v[96:99], v[16:19], 0
    ds_read_b128 v[120:123], v241 offset:22528
    v_exp_f32 v70, v70
    v_exp_f32 v71, v71
    v_exp_f32 v72, v72
    v_mfma_f32_32x32x16_bf16 v[80:95], v[100:103], v[20:23], v[80:95]
    ds_read_b128 v[124:127], v241 offset:23552
    v_exp_f32 v73, v73
    v_exp_f32 v74, v74
    v_exp_f32 v75, v75
    v_smfmac_f32_32x32x32_bf16 v[24:39], v[112:115], v[64:71], v224
    v_exp_f32 v76, v76
    v_exp_f32 v77, v77
    v_exp_f32 v78, v78
    v_smfmac_f32_16x16x64_bf16 v[56:59], v[220:223], v[64:71], v224
    v_exp_f32 v79, v79
    v_exp_f32 v80, v80
    v_exp_f32 v81, v81
    v_smfmac_f32_32x32x32_bf16 v[24:39], v[116:119], v[72:79], v224
    s_waitcnt lgkmcnt(0)
    v_exp_f32 v82, v82
    v_exp_f32 v83, v83
    v_exp_f32 v84, v84
    v_smfmac_f32_16x16x64_bf16 v[56:59], v[220:223], v[72:79], v224
    s_setprio 0
    v_exp_f32 v85, v85
    v_mfma_f32_32x32x16_bf16 v[64:79], v[104:107], v[8:11], 0
    v_exp_f32 v86, v86
    v_exp_f32 v87, v87
    v_exp_f32 v88, v88
    v_mfma_f32_32x32x16_bf16 v[64:79], v[108:111], v[12:15], v[64:79]
    v_exp_f32 v89, v89
    v_exp_f32 v90, v90
    v_exp_f32 v91, v91
    v_smfmac_f32_32x32x32_bf16 v[40:55], v[112:115], v[80:87], v224
    v_exp_f32 v92, v92
    v_exp_f32 v93, v93
    v_exp_f32 v94, v94
    v_smfmac_f32_16x16x64_bf16 v[60:63], v[220:223], v[80:87], v224
    v_exp_f32 v95, v95
    v_exp_f32 v64, v64
    v_exp_f32 v65, v65
    v_smfmac_f32_32x32x32_bf16 v[40:55], v[116:119], v[88:95], v224
    s_waitcnt vmcnt(1)
    s_barrier
    ds_read_b128 v[96:99], v241 offset:0
    v_exp_f32 v66, v66
    v_exp_f32 v67, v67
    v_exp_f32 v68, v68
    v_smfmac_f32_16x16x64_bf16 v[60:63], v[220:223], v[88:95], v224
    s_setprio 3
    ds_read_b128 v[100:103], v241 offset:1024
    v_exp_f32 v69, v69
    v_mfma_f32_32x32x16_bf16 v[80:95], v[104:107], v[16:19], 0
    ds_read_b128 v[112:115], v241 offset:2048
    v_exp_f32 v70, v70
    v_exp_f32 v71, v71
    v_exp_f32 v72, v72
    v_mfma_f32_32x32x16_bf16 v[80:95], v[108:111], v[20:23], v[80:95]
    ds_read_b128 v[116:119], v241 offset:3072
    v_exp_f32 v73, v73
    v_exp_f32 v74, v74
    v_exp_f32 v75, v75
    v_smfmac_f32_32x32x32_bf16 v[24:39], v[120:123], v[64:71], v224
    s_add_u32 m0, s49, 16384
    s_add_u32 s48, s67, 16924672
    buffer_load_dwordx4 v4, s[20:23], s48 offen sc1 lds
    v_exp_f32 v76, v76
    v_exp_f32 v77, v77
    v_exp_f32 v78, v78
    v_smfmac_f32_16x16x64_bf16 v[56:59], v[220:223], v[64:71], v224
    buffer_load_dwordx4 v4, s[20:23], s48 offen offset:1024 sc1 lds
    v_exp_f32 v79, v79
    v_exp_f32 v80, v80
    v_exp_f32 v81, v81
    v_smfmac_f32_32x32x32_bf16 v[24:39], v[124:127], v[72:79], v224
    s_waitcnt lgkmcnt(0)
    s_bfe_u32 s41, s38, 0x10001
    s_add_u32 s41, s41, s36
    s_sub_i32 s41, s41, 2
    s_max_i32 s41, s41, 0
    s_lshl_b32 s51, s37, 4
    s_add_u32 s51, s51, s41
    s_lshl_b32 s51, s51, 7
    s_add_u32 s51, s51, 17309696
    buffer_load_dwordx2 v[252:253], off, s[20:23], s51 sc1
    v_exp_f32 v82, v82
    v_exp_f32 v83, v83
    v_exp_f32 v84, v84
    v_smfmac_f32_16x16x64_bf16 v[56:59], v[220:223], v[72:79], v224
    s_setprio 2
    v_exp_f32 v85, v85
    v_mfma_f32_32x32x16_bf16 v[64:79], v[96:99], v[8:11], 0
    s_lshl_b32 s55, s46, 4
    s_add_u32 s55, s55, s41
    s_and_b32 s42, s38, 1
    s_lshl1_add_u32 s55, s55, s42
    s_lshl_b32 s55, s55, 13
    s_and_b32 s40, s38, 3
    s_lshl2_add_u32 s56, s40, s44
    s_lshl_b32 s56, s56, 12
    v_exp_f32 v86, v86
    v_exp_f32 v87, v87
    v_exp_f32 v88, v88
    v_mfma_f32_32x32x16_bf16 v[64:79], v[100:103], v[12:15], v[64:79]
    v_exp_f32 v89, v89
    v_exp_f32 v90, v90
    v_exp_f32 v91, v91
    v_smfmac_f32_32x32x32_bf16 v[40:55], v[120:123], v[80:87], v224
    v_exp_f32 v92, v92
    v_exp_f32 v93, v93
    v_exp_f32 v94, v94
    v_smfmac_f32_16x16x64_bf16 v[60:63], v[220:223], v[80:87], v224
    v_exp_f32 v95, v95
    v_exp_f32 v64, v64
    v_exp_f32 v65, v65
    v_smfmac_f32_32x32x32_bf16 v[40:55], v[124:127], v[88:95], v224
    ds_read_b128 v[104:107], v241 offset:4096
    v_exp_f32 v66, v66
    v_exp_f32 v67, v67
    v_exp_f32 v68, v68
    v_smfmac_f32_16x16x64_bf16 v[60:63], v[220:223], v[88:95], v224
    s_setprio 1
    ds_read_b128 v[108:111], v241 offset:5120
    v_exp_f32 v69, v69
    v_mfma_f32_32x32x16_bf16 v[80:95], v[96:99], v[16:19], 0
    ds_read_b128 v[120:123], v241 offset:6144
    v_exp_f32 v70, v70
    v_exp_f32 v71, v71
    v_exp_f32 v72, v72
    v_mfma_f32_32x32x16_bf16 v[80:95], v[100:103], v[20:23], v[80:95]
    ds_read_b128 v[124:127], v241 offset:7168
    v_exp_f32 v73, v73
    v_exp_f32 v74, v74
    v_exp_f32 v75, v75
    v_smfmac_f32_32x32x32_bf16 v[24:39], v[112:115], v[64:71], v224
    v_exp_f32 v76, v76
    v_exp_f32 v77, v77
    v_exp_f32 v78, v78
    v_smfmac_f32_16x16x64_bf16 v[56:59], v[220:223], v[64:71], v224
    v_exp_f32 v79, v79
    v_exp_f32 v80, v80
    v_exp_f32 v81, v81
    v_smfmac_f32_32x32x32_bf16 v[24:39], v[116:119], v[72:79], v224
    s_waitcnt lgkmcnt(0)
    v_exp_f32 v82, v82
    v_exp_f32 v83, v83
    v_exp_f32 v84, v84
    v_smfmac_f32_16x16x64_bf16 v[56:59], v[220:223], v[72:79], v224
    s_setprio 0
    v_exp_f32 v85, v85
    v_mfma_f32_32x32x16_bf16 v[64:79], v[104:107], v[8:11], 0
    v_exp_f32 v86, v86
    v_exp_f32 v87, v87
    v_exp_f32 v88, v88
    v_mfma_f32_32x32x16_bf16 v[64:79], v[108:111], v[12:15], v[64:79]
    v_exp_f32 v89, v89
    v_exp_f32 v90, v90
    v_exp_f32 v91, v91
    v_smfmac_f32_32x32x32_bf16 v[40:55], v[112:115], v[80:87], v224
    v_exp_f32 v92, v92
    v_exp_f32 v93, v93
    v_exp_f32 v94, v94
    v_smfmac_f32_16x16x64_bf16 v[60:63], v[220:223], v[80:87], v224
    v_exp_f32 v95, v95
    v_exp_f32 v64, v64
    v_exp_f32 v65, v65
    v_smfmac_f32_32x32x32_bf16 v[40:55], v[116:119], v[88:95], v224
    s_waitcnt vmcnt(1)
    s_barrier
    ds_read_b128 v[96:99], v241 offset:16384
    v_exp_f32 v66, v66
    v_exp_f32 v67, v67
    v_exp_f32 v68, v68
    v_smfmac_f32_16x16x64_bf16 v[60:63], v[220:223], v[88:95], v224
    s_setprio 3
    ds_read_b128 v[100:103], v241 offset:17408
    v_exp_f32 v69, v69
    v_mfma_f32_32x32x16_bf16 v[80:95], v[104:107], v[16:19], 0
    ds_read_b128 v[112:115], v241 offset:18432
    v_exp_f32 v70, v70
    v_exp_f32 v71, v71
    v_exp_f32 v72, v72
    v_mfma_f32_32x32x16_bf16 v[80:95], v[108:111], v[20:23], v[80:95]
    ds_read_b128 v[116:119], v241 offset:19456
    v_exp_f32 v73, v73
    v_exp_f32 v74, v74
    v_exp_f32 v75, v75
    v_smfmac_f32_32x32x32_bf16 v[24:39], v[120:123], v[64:71], v224
    s_add_u32 m0, s49, 0
    s_add_u32 s48, s67, 16973824
    buffer_load_dwordx4 v4, s[20:23], s48 offen sc1 lds
    v_exp_f32 v76, v76
    v_exp_f32 v77, v77
    v_exp_f32 v78, v78
    v_smfmac_f32_16x16x64_bf16 v[56:59], v[220:223], v[64:71], v224
    buffer_load_dwordx4 v4, s[20:23], s48 offen offset:1024 sc1 lds
    v_exp_f32 v79, v79
    v_exp_f32 v80, v80
    v_exp_f32 v81, v81
    v_smfmac_f32_32x32x32_bf16 v[24:39], v[124:127], v[72:79], v224
    s_waitcnt lgkmcnt(0)
    s_waitcnt vmcnt(2)
K_np_105:
    v_cmp_ne_u32 vcc, s39, v252
    v_cmp_ne_u32 s[42:43], s39, v253
    s_or_b64 vcc, vcc, s[42:43]
    s_cbranch_vccz K_no_106
    s_add_u32 s3, s3, 1
    s_cmp_gt_u32 s3, 1048576
    s_cbranch_scc1 K_no_106
    buffer_load_dwordx2 v[252:253], off, s[20:23], s51 sc1
    s_waitcnt vmcnt(0)
    s_branch K_np_105
K_no_106:
    v_exp_f32 v82, v82
    v_exp_f32 v83, v83
    v_exp_f32 v84, v84
    v_smfmac_f32_16x16x64_bf16 v[56:59], v[220:223], v[72:79], v224
    s_setprio 2
    v_exp_f32 v85, v85
    v_mfma_f32_32x32x16_bf16 v[64:79], v[96:99], v[8:11], 0
    s_add_u32 m0, s56, 0
    s_nop 0
    buffer_load_dwordx4 v4, s[20:23], s55 offen offset:0 sc1 lds
    v_exp_f32 v86, v86
    v_exp_f32 v87, v87
    v_exp_f32 v88, v88
    v_mfma_f32_32x32x16_bf16 v[64:79], v[100:103], v[12:15], v[64:79]
    s_add_u32 m0, s56, 0
    s_nop 0
    buffer_load_dwordx4 v4, s[20:23], s55 offen offset:1024 sc1 lds
    v_exp_f32 v89, v89
    v_exp_f32 v90, v90
    v_exp_f32 v91, v91
    v_smfmac_f32_32x32x32_bf16 v[40:55], v[120:123], v[80:87], v224
    s_add_u32 m0, s56, 0
    s_nop 0
    buffer_load_dwordx4 v4, s[20:23], s55 offen offset:2048 sc1 lds
    v_exp_f32 v92, v92
    v_exp_f32 v93, v93
    v_exp_f32 v94, v94
    v_smfmac_f32_16x16x64_bf16 v[60:63], v[220:223], v[80:87], v224
    v_exp_f32 v95, v95
    v_exp_f32 v64, v64
    v_exp_f32 v65, v65
    v_smfmac_f32_32x32x32_bf16 v[40:55], v[124:127], v[88:95], v224
    ds_read_b128 v[104:107], v241 offset:20480
    v_exp_f32 v66, v66
    v_exp_f32 v67, v67
    v_exp_f32 v68, v68
    v_smfmac_f32_16x16x64_bf16 v[60:63], v[220:223], v[88:95], v224
    s_setprio 1
    ds_read_b128 v[108:111], v241 offset:21504
    v_exp_f32 v69, v69
    v_mfma_f32_32x32x16_bf16 v[80:95], v[96:99], v[16:19], 0
    ds_read_b128 v[120:123], v241 offset:22528
    v_exp_f32 v70, v70
    v_exp_f32 v71, v71
    v_exp_f32 v72, v72
    v_mfma_f32_32x32x16_bf16 v[80:95], v[100:103], v[20:23], v[80:95]
    ds_read_b128 v[124:127], v241 offset:23552
    v_exp_f32 v73, v73
    v_exp_f32 v74, v74
    v_exp_f32 v75, v75
    v_smfmac_f32_32x32x32_bf16 v[24:39], v[112:115], v[64:71], v224
    s_add_u32 m0, s56, 0
    s_nop 0
    buffer_load_dwordx4 v4, s[20:23], s55 offen offset:3072 sc1 lds
    s_add_u32 s55, s55, 4096
    v_exp_f32 v76, v76
    v_exp_f32 v77, v77
    v_exp_f32 v78, v78
    v_smfmac_f32_16x16x64_bf16 v[56:59], v[220:223], v[64:71], v224
    v_exp_f32 v79, v79
    v_exp_f32 v80, v80
    v_exp_f32 v81, v81
    v_smfmac_f32_32x32x32_bf16 v[24:39], v[116:119], v[72:79], v224
    s_waitcnt lgkmcnt(0)
    v_exp_f32 v82, v82
    v_exp_f32 v83, v83
    v_exp_f32 v84, v84
    v_smfmac_f32_16x16x64_bf16 v[56:59], v[220:223], v[72:79], v224
    s_setprio 0
    v_exp_f32 v85, v85
    v_mfma_f32_32x32x16_bf16 v[64:79], v[104:107], v[8:11], 0
    v_exp_f32 v86, v86
    v_exp_f32 v87, v87
    v_exp_f32 v88, v88
    v_mfma_f32_32x32x16_bf16 v[64:79], v[108:111], v[12:15], v[64:79]
    v_exp_f32 v89, v89
    v_exp_f32 v90, v90
    v_exp_f32 v91, v91
    v_smfmac_f32_32x32x32_bf16 v[40:55], v[112:115], v[80:87], v224
    v_exp_f32 v92, v92
    v_exp_f32 v93, v93
    v_exp_f32 v94, v94
    v_smfmac_f32_16x16x64_bf16 v[60:63], v[220:223], v[80:87], v224
    v_exp_f32 v95, v95
    v_exp_f32 v64, v64
    v_exp_f32 v65, v65
    v_smfmac_f32_32x32x32_bf16 v[40:55], v[116:119], v[88:95], v224
    s_waitcnt vmcnt(4)
    s_barrier
    ds_read_b128 v[96:99], v241 offset:0
    v_exp_f32 v66, v66
    v_exp_f32 v67, v67
    v_exp_f32 v68, v68
    v_smfmac_f32_16x16x64_bf16 v[60:63], v[220:223], v[88:95], v224
    s_setprio 3
    ds_read_b128 v[100:103], v241 offset:1024
    v_exp_f32 v69, v69
    v_mfma_f32_32x32x16_bf16 v[80:95], v[104:107], v[16:19], 0
    ds_read_b128 v[112:115], v241 offset:2048
    v_exp_f32 v70, v70
    v_exp_f32 v71, v71
    v_exp_f32 v72, v72
    v_mfma_f32_32x32x16_bf16 v[80:95], v[108:111], v[20:23], v[80:95]
    ds_read_b128 v[116:119], v241 offset:3072
    v_exp_f32 v73, v73
    v_exp_f32 v74, v74
    v_exp_f32 v75, v75
    v_smfmac_f32_32x32x32_bf16 v[24:39], v[120:123], v[64:71], v224
    s_add_u32 m0, s49, 16384
    s_add_u32 s48, s67, 16990208
    buffer_load_dwordx4 v4, s[20:23], s48 offen sc1 lds
    v_exp_f32 v76, v76
    v_exp_f32 v77, v77
    v_exp_f32 v78, v78
    v_smfmac_f32_16x16x64_bf16 v[56:59], v[220:223], v[64:71], v224
    buffer_load_dwordx4 v4, s[20:23], s48 offen offset:1024 sc1 lds
    v_exp_f32 v79, v79
    v_exp_f32 v80, v80
    v_exp_f32 v81, v81
    v_smfmac_f32_32x32x32_bf16 v[24:39], v[124:127], v[72:79], v224
    s_waitcnt lgkmcnt(0)
    s_add_u32 m0, s56, 8192
    s_nop 0
    buffer_load_dwordx4 v4, s[20:23], s55 offen offset:0 sc1 lds
    v_exp_f32 v82, v82
    v_exp_f32 v83, v83
    v_exp_f32 v84, v84
    v_smfmac_f32_16x16x64_bf16 v[56:59], v[220:223], v[72:79], v224
    s_setprio 2
    v_exp_f32 v85, v85
    v_mfma_f32_32x32x16_bf16 v[64:79], v[96:99], v[8:11], 0
    s_add_u32 m0, s56, 8192
    s_nop 0
    buffer_load_dwordx4 v4, s[20:23], s55 offen offset:1024 sc1 lds
    v_exp_f32 v86, v86
    v_exp_f32 v87, v87
    v_exp_f32 v88, v88
    v_mfma_f32_32x32x16_bf16 v[64:79], v[100:103], v[12:15], v[64:79]
    s_add_u32 m0, s56, 8192
    s_nop 0
    buffer_load_dwordx4 v4, s[20:23], s55 offen offset:2048 sc1 lds
    v_exp_f32 v89, v89
    v_exp_f32 v90, v90
    v_exp_f32 v91, v91
    v_smfmac_f32_32x32x32_bf16 v[40:55], v[120:123], v[80:87], v224
    s_add_u32 m0, s56, 8192
    s_nop 0
    buffer_load_dwordx4 v4, s[20:23], s55 offen offset:3072 sc1 lds
    s_add_u32 s55, s55, 4096
    v_exp_f32 v92, v92
    v_exp_f32 v93, v93
    v_exp_f32 v94, v94
    v_smfmac_f32_16x16x64_bf16 v[60:63], v[220:223], v[80:87], v224
    v_exp_f32 v95, v95
    v_exp_f32 v64, v64
    v_exp_f32 v65, v65
    v_smfmac_f32_32x32x32_bf16 v[40:55], v[124:127], v[88:95], v224
    ds_read_b128 v[104:107], v241 offset:4096
    v_exp_f32 v66, v66
    v_exp_f32 v67, v67
    v_exp_f32 v68, v68
    v_smfmac_f32_16x16x64_bf16 v[60:63], v[220:223], v[88:95], v224
    s_setprio 1
    ds_read_b128 v[108:111], v241 offset:5120
    v_exp_f32 v69, v69
    v_mfma_f32_32x32x16_bf16 v[80:95], v[96:99], v[16:19], 0
    ds_read_b128 v[120:123], v241 offset:6144
    v_exp_f32 v70, v70
    v_exp_f32 v71, v71
    v_exp_f32 v72, v72
    v_mfma_f32_32x32x16_bf16 v[80:95], v[100:103], v[20:23], v[80:95]
    ds_read_b128 v[124:127], v241 offset:7168
    v_exp_f32 v73, v73
    v_exp_f32 v74, v74
    v_exp_f32 v75, v75
    v_smfmac_f32_32x32x32_bf16 v[24:39], v[112:115], v[64:71], v224
    v_exp_f32 v76, v76
    v_exp_f32 v77, v77
    v_exp_f32 v78, v78
    v_smfmac_f32_16x16x64_bf16 v[56:59], v[220:223], v[64:71], v224
    v_exp_f32 v79, v79
    v_exp_f32 v80, v80
    v_exp_f32 v81, v81
    v_smfmac_f32_32x32x32_bf16 v[24:39], v[116:119], v[72:79], v224
    s_waitcnt lgkmcnt(0)
    v_exp_f32 v82, v82
    v_exp_f32 v83, v83
    v_exp_f32 v84, v84
    v_smfmac_f32_16x16x64_bf16 v[56:59], v[220:223], v[72:79], v224
    s_setprio 0
    v_exp_f32 v85, v85
    v_mfma_f32_32x32x16_bf16 v[64:79], v[104:107], v[8:11], 0
    v_exp_f32 v86, v86
    v_exp_f32 v87, v87
    v_exp_f32 v88, v88
    v_mfma_f32_32x32x16_bf16 v[64:79], v[108:111], v[12:15], v[64:79]
    v_exp_f32 v89, v89
    v_exp_f32 v90, v90
    v_exp_f32 v91, v91
    v_smfmac_f32_32x32x32_bf16 v[40:55], v[112:115], v[80:87], v224
    v_exp_f32 v92, v92
    v_exp_f32 v93, v93
    v_exp_f32 v94, v94
    v_smfmac_f32_16x16x64_bf16 v[60:63], v[220:223], v[80:87], v224
    v_exp_f32 v95, v95
    v_exp_f32 v64, v64
    v_exp_f32 v65, v65
    v_smfmac_f32_32x32x32_bf16 v[40:55], v[116:119], v[88:95], v224
    s_waitcnt vmcnt(0)
    s_barrier
    ds_read_b128 v[96:99], v242 offset:57344
    v_exp_f32 v66, v66
    v_exp_f32 v67, v67
    v_exp_f32 v68, v68
    v_smfmac_f32_16x16x64_bf16 v[60:63], v[220:223], v[88:95], v224
    s_setprio 3
    ds_read_b128 v[100:103], v242 offset:58368
    v_exp_f32 v69, v69
    v_mfma_f32_32x32x16_bf16 v[80:95], v[104:107], v[16:19], 0
    ds_read_b128 v[112:115], v242 offset:59392
    v_exp_f32 v70, v70
    v_exp_f32 v71, v71
    v_exp_f32 v72, v72
    v_mfma_f32_32x32x16_bf16 v[80:95], v[108:111], v[20:23], v[80:95]
    ds_read_b128 v[116:119], v242 offset:60416
    v_exp_f32 v73, v73
    v_exp_f32 v74, v74
    v_exp_f32 v75, v75
    v_smfmac_f32_32x32x32_bf16 v[24:39], v[120:123], v[64:71], v224
    s_add_u32 m0, s49, 0
    s_add_u32 s48, s67, 16809984
    buffer_load_dwordx4 v4, s[20:23], s48 offen sc1 lds
    v_exp_f32 v76, v76
    v_exp_f32 v77, v77
    v_exp_f32 v78, v78
    v_smfmac_f32_16x16x64_bf16 v[56:59], v[220:223], v[64:71], v224
    buffer_load_dwordx4 v4, s[20:23], s48 offen offset:1024 sc1 lds
    v_exp_f32 v79, v79
    v_exp_f32 v80, v80
    v_exp_f32 v81, v81
    v_smfmac_f32_32x32x32_bf16 v[24:39], v[124:127], v[72:79], v224
    s_waitcnt lgkmcnt(0)
    ds_read_b128 v[104:107], v242 offset:49152
    v_exp_f32 v82, v82
    v_exp_f32 v83, v83
    v_exp_f32 v84, v84
    v_smfmac_f32_16x16x64_bf16 v[56:59], v[220:223], v[72:79], v224
    ds_read_b128 v[108:111], v242 offset:50176
    v_exp_f32 v85, v85
    v_mfma_f32_32x32x16_bf16 v[64:79], v[96:99], v[128:131], v[156:171]
    s_lshl3_add_u32 s40, s64, s38
    s_lshl_b32 s40, s40, 14
    s_lshl_b32 s41, s65, 7
    s_add_u32 s40, s40, s41
    v_lshlrev_b32 v5, 11, v1
    s_mov_b64 exec, 0xff
    buffer_load_dword v255, v5, s[28:31], s40 offen
    buffer_load_dword v255, v5, s[24:27], s40 offen
    s_mov_b64 exec, -1
    v_exp_f32 v86, v86
    v_exp_f32 v87, v87
    v_exp_f32 v88, v88
    v_mfma_f32_32x32x16_bf16 v[64:79], v[100:103], v[132:135], v[64:79]
    v_exp_f32 v89, v89
    v_exp_f32 v90, v90
    v_exp_f32 v91, v91
    v_smfmac_f32_32x32x32_bf16 v[40:55], v[120:123], v[80:87], v224
    v_exp_f32 v92, v92
    v_exp_f32 v93, v93
    v_exp_f32 v94, v94
    v_smfmac_f32_16x16x64_bf16 v[60:63], v[220:223], v[80:87], v224
    v_exp_f32 v95, v95
    v_exp_f32 v64, v64
    v_exp_f32 v65, v65
    v_smfmac_f32_32x32x32_bf16 v[40:55], v[124:127], v[88:95], v224
    s_waitcnt lgkmcnt(0)
    ds_read_b128 v[120:123], v242 offset:51200
    v_exp_f32 v66, v66
    v_exp_f32 v67, v67
    v_exp_f32 v68, v68
    v_smfmac_f32_16x16x64_bf16 v[60:63], v[220:223], v[88:95], v224
    s_cmp_lg_u32 s45, 0
    s_cbranch_scc1 K_cm_111
    v_mov_b32 v188, s47
    v_mov_b32 v189, s47
    v_mov_b32 v190, s47
    v_mov_b32 v191, s47
    v_mov_b32 v192, s47
    v_mov_b32 v193, s47
    v_mov_b32 v194, s47
    v_mov_b32 v195, s47
    v_mov_b32 v196, s47
    v_mov_b32 v197, s47
    v_mov_b32 v198, s47
    v_mov_b32 v199, s47
    v_mov_b32 v200, s47
    v_mov_b32 v201, s47
    v_mov_b32 v202, s47
    v_mov_b32 v203, s47
K_cm_111:
    ds_read_b128 v[124:127], v242 offset:52224
    v_exp_f32 v69, v69
    v_mfma_f32_32x32x16_bf16 v[80:95], v[104:107], v[128:131], v[188:203]
    ds_read_b128 v[96:99], v242 offset:40960
    v_exp_f32 v70, v70
    v_exp_f32 v71, v71
    v_exp_f32 v72, v72
    v_mfma_f32_32x32x16_bf16 v[80:95], v[108:111], v[132:135], v[80:95]
    ds_read_b128 v[100:103], v242 offset:41984
    v_exp_f32 v73, v73
    v_exp_f32 v74, v74
    v_exp_f32 v75, v75
    v_smfmac_f32_32x32x32_bf16 v[136:151], v[112:115], v[64:71], v224
    v_exp_f32 v76, v76
    v_exp_f32 v77, v77
    v_exp_f32 v78, v78
    v_smfmac_f32_16x16x64_bf16 v[152:155], v[220:223], v[64:71], v224
    v_exp_f32 v79, v79
    v_exp_f32 v80, v80
    v_exp_f32 v81, v81
    v_smfmac_f32_32x32x32_bf16 v[136:151], v[116:119], v[72:79], v224
    s_waitcnt lgkmcnt(0)
    ds_read_b128 v[112:115], v242 offset:43008
    v_exp_f32 v82, v82
    v_exp_f32 v83, v83
    v_exp_f32 v84, v84
    v_smfmac_f32_16x16x64_bf16 v[152:155], v[220:223], v[72:79], v224
    s_cmp_lg_u32 s45, 1
    s_cbranch_scc1 K_cm_112
    v_mov_b32 v188, s47
    v_mov_b32 v189, s47
    v_mov_b32 v190, s47
    v_mov_b32 v191, s47
    v_mov_b32 v192, s47
    v_mov_b32 v193, s47
    v_mov_b32 v194, s47
    v_mov_b32 v195, s47
    v_mov_b32 v196, s47
    v_mov_b32 v197, s47
    v_mov_b32 v198, s47
    v_mov_b32 v199, s47
    v_mov_b32 v200, s47
    v_mov_b32 v201, s47
    v_mov_b32 v202, s47
    v_mov_b32 v203, s47
K_cm_112:
    ds_read_b128 v[116:119], v242 offset:44032
    v_exp_f32 v85, v85
    v_mfma_f32_32x32x16_bf16 v[64:79], v[96:99], v[128:131], v[188:203]
    ds_read_b128 v[104:107], v242 offset:32768
    v_exp_f32 v86, v86
    v_exp_f32 v87, v87
    v_exp_f32 v88, v88
    v_mfma_f32_32x32x16_bf16 v[64:79], v[100:103], v[132:135], v[64:79]
    ds_read_b128 v[108:111], v242 offset:33792
    v_exp_f32 v89, v89
    v_exp_f32 v90, v90
    v_exp_f32 v91, v91
    v_smfmac_f32_32x32x32_bf16 v[136:151], v[120:123], v[80:87], v224
    v_exp_f32 v92, v92
    v_exp_f32 v93, v93
    v_exp_f32 v94, v94
    v_smfmac_f32_16x16x64_bf16 v[152:155], v[220:223], v[80:87], v224
    v_exp_f32 v95, v95
    v_exp_f32 v64, v64
    v_exp_f32 v65, v65
    v_smfmac_f32_32x32x32_bf16 v[136:151], v[124:127], v[88:95], v224
    s_waitcnt lgkmcnt(0)
    ds_read_b128 v[120:123], v242 offset:34816
    v_exp_f32 v66, v66
    v_exp_f32 v67, v67
    v_exp_f32 v68, v68
    v_smfmac_f32_16x16x64_bf16 v[152:155], v[220:223], v[88:95], v224
    s_cmp_lg_u32 s45, 2
    s_cbranch_scc1 K_cm_113
    v_mov_b32 v188, s47
    v_mov_b32 v189, s47
    v_mov_b32 v190, s47
    v_mov_b32 v191, s47
    v_mov_b32 v192, s47
    v_mov_b32 v193, s47
    v_mov_b32 v194, s47
    v_mov_b32 v195, s47
    v_mov_b32 v196, s47
    v_mov_b32 v197, s47
    v_mov_b32 v198, s47
    v_mov_b32 v199, s47
    v_mov_b32 v200, s47
    v_mov_b32 v201, s47
    v_mov_b32 v202, s47
    v_mov_b32 v203, s47
K_cm_113:
    ds_read_b128 v[124:127], v242 offset:35840
    v_exp_f32 v69, v69
    v_mfma_f32_32x32x16_bf16 v[80:95], v[104:107], v[128:131], v[188:203]
    ds_read_b128 v[96:99], v242 offset:24576
    v_exp_f32 v70, v70
    v_exp_f32 v71, v71
    v_exp_f32 v72, v72
    v_mfma_f32_32x32x16_bf16 v[80:95], v[108:111], v[132:135], v[80:95]
    ds_read_b128 v[100:103], v242 offset:25600
    v_exp_f32 v73, v73
    v_exp_f32 v74, v74
    v_exp_f32 v75, v75
    v_smfmac_f32_32x32x32_bf16 v[136:151], v[112:115], v[64:71], v224
    v_exp_f32 v76, v76
    v_exp_f32 v77, v77
    v_exp_f32 v78, v78
    v_smfmac_f32_16x16x64_bf16 v[152:155], v[220:223], v[64:71], v224
    v_exp_f32 v79, v79
    v_exp_f32 v80, v80
    v_exp_f32 v81, v81
    v_smfmac_f32_32x32x32_bf16 v[136:151], v[116:119], v[72:79], v224
    s_waitcnt lgkmcnt(0)
    ds_read_b128 v[112:115], v242 offset:26624
    v_exp_f32 v82, v82
    v_exp_f32 v83, v83
    v_exp_f32 v84, v84
    v_smfmac_f32_16x16x64_bf16 v[152:155], v[220:223], v[72:79], v224
    s_cmp_lg_u32 s45, 3
    s_cbranch_scc1 K_cm_114
    v_mov_b32 v188, s47
    v_mov_b32 v189, s47
    v_mov_b32 v190, s47
    v_mov_b32 v191, s47
    v_mov_b32 v192, s47
    v_mov_b32 v193, s47
    v_mov_b32 v194, s47
    v_mov_b32 v195, s47
    v_mov_b32 v196, s47
    v_mov_b32 v197, s47
    v_mov_b32 v198, s47
    v_mov_b32 v199, s47
    v_mov_b32 v200, s47
    v_mov_b32 v201, s47
    v_mov_b32 v202, s47
    v_mov_b32 v203, s47
K_cm_114:
    ds_read_b128 v[116:119], v242 offset:27648
    v_exp_f32 v85, v85
    v_mfma_f32_32x32x16_bf16 v[64:79], v[96:99], v[128:131], v[188:203]
    ds_read_b128 v[104:107], v242 offset:16384
    v_exp_f32 v86, v86
    v_exp_f32 v87, v87
    v_exp_f32 v88, v88
    v_mfma_f32_32x32x16_bf16 v[64:79], v[100:103], v[132:135], v[64:79]
    ds_read_b128 v[108:111], v242 offset:17408
    v_exp_f32 v89, v89
    v_exp_f32 v90, v90
    v_exp_f32 v91, v91
    v_smfmac_f32_32x32x32_bf16 v[136:151], v[120:123], v[80:87], v224
    v_exp_f32 v92, v92
    v_exp_f32 v93, v93
    v_exp_f32 v94, v94
    v_smfmac_f32_16x16x64_bf16 v[152:155], v[220:223], v[80:87], v224
    v_exp_f32 v95, v95
    v_exp_f32 v64, v64
    v_exp_f32 v65, v65
    v_smfmac_f32_32x32x32_bf16 v[136:151], v[124:127], v[88:95], v224
    s_waitcnt lgkmcnt(0)
    ds_read_b128 v[120:123], v242 offset:18432
    v_exp_f32 v66, v66
    v_exp_f32 v67, v67
    v_exp_f32 v68, v68
    v_smfmac_f32_16x16x64_bf16 v[152:155], v[220:223], v[88:95], v224
    s_cmp_lg_u32 s45, 4
    s_cbranch_scc1 K_cm_115
    v_mov_b32 v188, s47
    v_mov_b32 v189, s47
    v_mov_b32 v190, s47
    v_mov_b32 v191, s47
    v_mov_b32 v192, s47
    v_mov_b32 v193, s47
    v_mov_b32 v194, s47
    v_mov_b32 v195, s47
    v_mov_b32 v196, s47
    v_mov_b32 v197, s47
    v_mov_b32 v198, s47
    v_mov_b32 v199, s47
    v_mov_b32 v200, s47
    v_mov_b32 v201, s47
    v_mov_b32 v202, s47
    v_mov_b32 v203, s47
K_cm_115:
    ds_read_b128 v[124:127], v242 offset:19456
    v_exp_f32 v69, v69
    v_mfma_f32_32x32x16_bf16 v[80:95], v[104:107], v[128:131], v[188:203]
    ds_read_b128 v[96:99], v242 offset:8192
    v_exp_f32 v70, v70
    v_exp_f32 v71, v71
    v_exp_f32 v72, v72
    v_mfma_f32_32x32x16_bf16 v[80:95], v[108:111], v[132:135], v[80:95]
    ds_read_b128 v[100:103], v242 offset:9216
    v_exp_f32 v73, v73
    v_exp_f32 v74, v74
    v_exp_f32 v75, v75
    v_smfmac_f32_32x32x32_bf16 v[136:151], v[112:115], v[64:71], v224
    v_exp_f32 v76, v76
    v_exp_f32 v77, v77
    v_exp_f32 v78, v78
    v_smfmac_f32_16x16x64_bf16 v[152:155], v[220:223], v[64:71], v224
    v_exp_f32 v79, v79
    v_exp_f32 v80, v80
    v_exp_f32 v81, v81
    v_smfmac_f32_32x32x32_bf16 v[136:151], v[116:119], v[72:79], v224
    s_waitcnt lgkmcnt(0)
    ds_read_b128 v[112:115], v242 offset:10240
    v_exp_f32 v82, v82
    v_exp_f32 v83, v83
    v_exp_f32 v84, v84
    v_smfmac_f32_16x16x64_bf16 v[152:155], v[220:223], v[72:79], v224
    s_cmp_lg_u32 s45, 5
    s_cbranch_scc1 K_cm_116
    v_mov_b32 v188, s47
    v_mov_b32 v189, s47
    v_mov_b32 v190, s47
    v_mov_b32 v191, s47
    v_mov_b32 v192, s47
    v_mov_b32 v193, s47
    v_mov_b32 v194, s47
    v_mov_b32 v195, s47
    v_mov_b32 v196, s47
    v_mov_b32 v197, s47
    v_mov_b32 v198, s47
    v_mov_b32 v199, s47
    v_mov_b32 v200, s47
    v_mov_b32 v201, s47
    v_mov_b32 v202, s47
    v_mov_b32 v203, s47
K_cm_116:
    ds_read_b128 v[116:119], v242 offset:11264
    v_exp_f32 v85, v85
    v_mfma_f32_32x32x16_bf16 v[64:79], v[96:99], v[128:131], v[188:203]
    ds_read_b128 v[104:107], v242 offset:0
    v_exp_f32 v86, v86
    v_exp_f32 v87, v87
    v_exp_f32 v88, v88
    v_mfma_f32_32x32x16_bf16 v[64:79], v[100:103], v[132:135], v[64:79]
    ds_read_b128 v[108:111], v242 offset:1024
    v_exp_f32 v89, v89
    v_exp_f32 v90, v90
    v_exp_f32 v91, v91
    v_smfmac_f32_32x32x32_bf16 v[136:151], v[120:123], v[80:87], v224
    v_exp_f32 v92, v92
    v_exp_f32 v93, v93
    v_exp_f32 v94, v94
    v_smfmac_f32_16x16x64_bf16 v[152:155], v[220:223], v[80:87], v224
    v_exp_f32 v95, v95
    v_exp_f32 v64, v64
    v_exp_f32 v65, v65
    v_smfmac_f32_32x32x32_bf16 v[136:151], v[124:127], v[88:95], v224
    s_waitcnt lgkmcnt(0)
    ds_read_b128 v[120:123], v242 offset:2048
    v_exp_f32 v66, v66
    v_exp_f32 v67, v67
    v_exp_f32 v68, v68
    v_smfmac_f32_16x16x64_bf16 v[152:155], v[220:223], v[88:95], v224
    s_cmp_lg_u32 s45, 6
    s_cbranch_scc1 K_cm_117
    v_mov_b32 v188, s47
    v_mov_b32 v189, s47
    v_mov_b32 v190, s47
    v_mov_b32 v191, s47
    v_mov_b32 v192, s47
    v_mov_b32 v193, s47
    v_mov_b32 v194, s47
    v_mov_b32 v195, s47
    v_mov_b32 v196, s47
    v_mov_b32 v197, s47
    v_mov_b32 v198, s47
    v_mov_b32 v199, s47
    v_mov_b32 v200, s47
    v_mov_b32 v201, s47
    v_mov_b32 v202, s47
    v_mov_b32 v203, s47
K_cm_117:
    ds_read_b128 v[124:127], v242 offset:3072
    v_exp_f32 v69, v69
    v_mfma_f32_32x32x16_bf16 v[80:95], v[104:107], v[128:131], v[188:203]
    v_subrev_u32 v242, 8192, v242
    ds_read_b128 v[96:99], v242 offset:0
    v_exp_f32 v70, v70
    v_exp_f32 v71, v71
    v_exp_f32 v72, v72
    v_mfma_f32_32x32x16_bf16 v[80:95], v[108:111], v[132:135], v[80:95]
    ds_read_b128 v[100:103], v242 offset:1024
    v_exp_f32 v73, v73
    v_exp_f32 v74, v74
    v_exp_f32 v75, v75
    v_smfmac_f32_32x32x32_bf16 v[136:151], v[112:115], v[64:71], v224
    v_exp_f32 v76, v76
    v_exp_f32 v77, v77
    v_exp_f32 v78, v78
    v_smfmac_f32_16x16x64_bf16 v[152:155], v[220:223], v[64:71], v224
    v_exp_f32 v79, v79
    v_exp_f32 v80, v80
    v_exp_f32 v81, v81
    v_smfmac_f32_32x32x32_bf16 v[136:151], v[116:119], v[72:79], v224
    s_waitcnt lgkmcnt(0)
    ds_read_b128 v[112:115], v242 offset:2048
    v_exp_f32 v82, v82
    v_exp_f32 v83, v83
    v_exp_f32 v84, v84
    v_smfmac_f32_16x16x64_bf16 v[152:155], v[220:223], v[72:79], v224
    ds_read_b128 v[116:119], v242 offset:3072
    v_exp_f32 v85, v85
    v_mfma_f32_32x32x16_bf16 v[64:79], v[96:99], v[128:131], v[172:187]
    ds_read_b128 v[104:107], v241 offset:16384
    v_exp_f32 v86, v86
    v_exp_f32 v87, v87
    v_exp_f32 v88, v88
    v_mfma_f32_32x32x16_bf16 v[64:79], v[100:103], v[132:135], v[64:79]
    ds_read_b128 v[108:111], v241 offset:17408
    v_exp_f32 v89, v89
    v_exp_f32 v90, v90
    v_exp_f32 v91, v91
    v_smfmac_f32_32x32x32_bf16 v[136:151], v[120:123], v[80:87], v224
    v_exp_f32 v92, v92
    v_exp_f32 v93, v93
    v_exp_f32 v94, v94
    v_smfmac_f32_16x16x64_bf16 v[152:155], v[220:223], v[80:87], v224
    v_exp_f32 v95, v95
    v_exp_f32 v64, v64
    v_exp_f32 v65, v65
    v_smfmac_f32_32x32x32_bf16 v[136:151], v[124:127], v[88:95], v224
    s_waitcnt lgkmcnt(0)
    ds_read_b128 v[120:123], v241 offset:18432
    v_exp_f32 v66, v66
    v_exp_f32 v67, v67
    v_exp_f32 v68, v68
    v_smfmac_f32_16x16x64_bf16 v[152:155], v[220:223], v[88:95], v224
    s_setprio 2
    ds_read_b128 v[124:127], v241 offset:19456
    v_exp_f32 v69, v69
    v_mfma_f32_32x32x16_bf16 v[80:95], v[104:107], v[8:11], 0
    v_exp_f32 v70, v70
    v_exp_f32 v71, v71
    v_exp_f32 v72, v72
    v_mfma_f32_32x32x16_bf16 v[80:95], v[108:111], v[12:15], v[80:95]
    v_exp_f32 v73, v73
    v_exp_f32 v74, v74
    v_exp_f32 v75, v75
    v_smfmac_f32_32x32x32_bf16 v[136:151], v[112:115], v[64:71], v224
    v_exp_f32 v76, v76
    v_exp_f32 v77, v77
    v_exp_f32 v78, v78
    v_smfmac_f32_16x16x64_bf16 v[152:155], v[220:223], v[64:71], v224
    v_exp_f32 v79, v79
    v_exp_f32 v80, v80
    v_exp_f32 v81, v81
    v_smfmac_f32_32x32x32_bf16 v[136:151], v[116:119], v[72:79], v224
    s_waitcnt lgkmcnt(0)
    ds_read_b128 v[96:99], v241 offset:20480
    v_exp_f32 v82, v82
    v_exp_f32 v83, v83
    v_exp_f32 v84, v84
    v_smfmac_f32_16x16x64_bf16 v[152:155], v[220:223], v[72:79], v224
    s_setprio 1
    ds_read_b128 v[100:103], v241 offset:21504
    v_exp_f32 v85, v85
    v_mfma_f32_32x32x16_bf16 v[64:79], v[104:107], v[16:19], 0
    ds_read_b128 v[112:115], v241 offset:22528
    v_exp_f32 v86, v86
    v_exp_f32 v87, v87
    v_exp_f32 v88, v88
    v_mfma_f32_32x32x16_bf16 v[64:79], v[108:111], v[20:23], v[64:79]
    ds_read_b128 v[116:119], v241 offset:23552
    v_exp_f32 v89, v89
    v_exp_f32 v90, v90
    v_exp_f32 v91, v91
    v_smfmac_f32_32x32x32_bf16 v[24:39], v[120:123], v[80:87], v224
    v_exp_f32 v92, v92
    v_exp_f32 v93, v93
    v_exp_f32 v94, v94
    v_smfmac_f32_16x16x64_bf16 v[56:59], v[220:223], v[80:87], v224
    v_exp_f32 v95, v95
    s_waitcnt vmcnt(19)
K_backB:
    v_rcp_f32 v5, v152
    v_sub_f32 v6, 1.0, v248
    v_mul_f32 v6, v5, v6
    v_mul_f32 v136, v136, v6
    v_mul_f32 v137, v137, v6
    v_mul_f32 v138, v138, v6
    v_mul_f32 v139, v139, v6
    v_mul_f32 v140, v140, v6
    v_mul_f32 v141, v141, v6
    v_mul_f32 v142, v142, v6
    v_mul_f32 v143, v143, v6
    v_mul_f32 v144, v144, v6
    v_mul_f32 v145, v145, v6
    v_mul_f32 v146, v146, v6
    v_mul_f32 v147, v147, v6
    v_mul_f32 v148, v148, v6
    v_mul_f32 v149, v149, v6
    v_mul_f32 v150, v150, v6
    v_mul_f32 v151, v151, v6
    v_mov_b32 v5, 0
    v_cvt_pk_bf16_f32 v204, v136, v137
    v_cvt_pk_bf16_f32 v205, v138, v139
    v_cvt_pk_bf16_f32 v206, v140, v141
    v_cvt_pk_bf16_f32 v207, v142, v143
    v_cvt_pk_bf16_f32 v208, v144, v145
    v_cvt_pk_bf16_f32 v209, v146, v147
    v_cvt_pk_bf16_f32 v210, v148, v149
    v_cvt_pk_bf16_f32 v211, v150, v151
    v_dot2_f32_bf16 v5, v204, v204, v5
    v_dot2_f32_bf16 v5, v205, v205, v5
    v_dot2_f32_bf16 v5, v206, v206, v5
    v_dot2_f32_bf16 v5, v207, v207, v5
    v_dot2_f32_bf16 v5, v208, v208, v5
    v_dot2_f32_bf16 v5, v209, v209, v5
    v_dot2_f32_bf16 v5, v210, v210, v5
    v_dot2_f32_bf16 v5, v211, v211, v5
    v_cmp_lt_f32 vcc, 0x30800000, v152
    s_lshl_b32 s50, s45, 6
    s_add_u32 s50, s50, s46
    s_xor_b32 s50, s50, 0
    s_mov_b64 s[42:43], vcc
    v_add_f32 v5, v5, v152
    v_cmp_gt_f32 vcc, 0x71800000, v5
    s_lshl_b32 s50, s50, 11
    s_add_u32 s50, s50, 8454144
    s_and_b64 vcc, vcc, s[42:43]
    s_cmp_eq_u64 vcc, -1
    s_cbranch_scc0 K_slowB
K_okB:
    buffer_store_dwordx4 v[204:207], v225, s[20:23], s50 offen sc1
    buffer_store_dwordx4 v[208:211], v225, s[20:23], s50 offen offset:512 sc1
    v_exp_f32 v64, v64
    v_exp_f32 v65, v65
    v_smfmac_f32_32x32x32_bf16 v[24:39], v[124:127], v[88:95], v224
    s_waitcnt lgkmcnt(0)
    v_exp_f32 v66, v66
    v_exp_f32 v67, v67
    v_exp_f32 v68, v68
    v_smfmac_f32_16x16x64_bf16 v[56:59], v[220:223], v[88:95], v224
    s_setprio 0
    v_exp_f32 v69, v69
    v_mfma_f32_32x32x16_bf16 v[80:95], v[96:99], v[8:11], 0
    v_exp_f32 v70, v70
    v_exp_f32 v71, v71
    v_exp_f32 v72, v72
    v_mfma_f32_32x32x16_bf16 v[80:95], v[100:103], v[12:15], v[80:95]
    v_exp_f32 v73, v73
    v_exp_f32 v74, v74
    v_exp_f32 v75, v75
    v_smfmac_f32_32x32x32_bf16 v[40:55], v[120:123], v[64:71], v224
    v_exp_f32 v76, v76
    v_exp_f32 v77, v77
    v_exp_f32 v78, v78
    v_smfmac_f32_16x16x64_bf16 v[60:63], v[220:223], v[64:71], v224
    v_exp_f32 v79, v79
    v_exp_f32 v80, v80
    v_exp_f32 v81, v81
    v_smfmac_f32_32x32x32_bf16 v[40:55], v[124:127], v[72:79], v224
    s_waitcnt vmcnt(4)
    s_barrier
    ds_read_b128 v[104:107], v241 offset:0
    v_exp_f32 v82, v82
    v_exp_f32 v83, v83
    v_exp_f32 v84, v84
    v_smfmac_f32_16x16x64_bf16 v[60:63], v[220:223], v[72:79], v224
    s_setprio 3
    ds_read_b128 v[108:111], v241 offset:1024
    v_exp_f32 v85, v85
    v_mfma_f32_32x32x16_bf16 v[64:79], v[96:99], v[16:19], 0
    ds_read_b128 v[120:123], v241 offset:2048
    v_exp_f32 v86, v86
    v_exp_f32 v87, v87
    v_exp_f32 v88, v88
    v_mfma_f32_32x32x16_bf16 v[64:79], v[100:103], v[20:23], v[64:79]
    ds_read_b128 v[124:127], v241 offset:3072
    v_exp_f32 v89, v89
    v_exp_f32 v90, v90
    v_exp_f32 v91, v91
    v_smfmac_f32_32x32x32_bf16 v[24:39], v[112:115], v[80:87], v224
    s_add_u32 m0, s49, 16384
    s_add_u32 s48, s67, 16875520
    buffer_load_dwordx4 v4, s[20:23], s48 offen sc1 lds
    v_exp_f32 v92, v92
    v_exp_f32 v93, v93
    v_exp_f32 v94, v94
    v_smfmac_f32_16x16x64_bf16 v[56:59], v[220:223], v[80:87], v224
    buffer_load_dwordx4 v4, s[20:23], s48 offen offset:1024 sc1 lds
    v_exp_f32 v95, v95
    v_exp_f32 v64, v64
    v_exp_f32 v65, v65
    v_smfmac_f32_32x32x32_bf16 v[24:39], v[116:119], v[88:95], v224
    s_waitcnt lgkmcnt(0)
    s_add_u32 m0, s67, 0
    s_mov_b32 s58, 0
    buffer_load_dwordx4 v226, s[28:31], s58 offen  lds
    v_exp_f32 v66, v66
    v_exp_f32 v67, v67
    v_exp_f32 v68, v68
    v_smfmac_f32_16x16x64_bf16 v[56:59], v[220:223], v[88:95], v224
    s_setprio 2
    v_exp_f32 v69, v69
    v_mfma_f32_32x32x16_bf16 v[80:95], v[104:107], v[8:11], 0
    s_add_u32 m0, s67, 1024
    s_nop 0
    buffer_load_dwordx4 v227, s[28:31], s58 offen  lds
    v_exp_f32 v70, v70
    v_exp_f32 v71, v71
    v_exp_f32 v72, v72
    v_mfma_f32_32x32x16_bf16 v[80:95], v[108:111], v[12:15], v[80:95]
    s_add_u32 m0, s67, 16384
    s_mov_b32 s58, 262144
    buffer_load_dwordx4 v226, s[28:31], s58 offen  lds
    v_exp_f32 v73, v73
    v_exp_f32 v74, v74
    v_exp_f32 v75, v75
    v_smfmac_f32_32x32x32_bf16 v[40:55], v[112:115], v[64:71], v224
    s_add_u32 m0, s67, 17408
    s_nop 0
    buffer_load_dwordx4 v227, s[28:31], s58 offen  lds
    v_exp_f32 v76, v76
    v_exp_f32 v77, v77
    v_exp_f32 v78, v78
    v_smfmac_f32_16x16x64_bf16 v[60:63], v[220:223], v[64:71], v224
    v_exp_f32 v79, v79
    v_exp_f32 v80, v80
    v_exp_f32 v81, v81
    v_smfmac_f32_32x32x32_bf16 v[40:55], v[116:119], v[72:79], v224
    ds_read_b128 v[96:99], v241 offset:4096
    v_exp_f32 v82, v82
    v_exp_f32 v83, v83
    v_exp_f32 v84, v84
    v_smfmac_f32_16x16x64_bf16 v[60:63], v[220:223], v[72:79], v224
    s_setprio 1
    ds_read_b128 v[100:103], v241 offset:5120
    v_exp_f32 v85, v85
    v_mfma_f32_32x32x16_bf16 v[64:79], v[104:107], v[16:19], 0
    ds_read_b128 v[112:115], v241 offset:6144
    v_exp_f32 v86, v86
    v_exp_f32 v87, v87
    v_exp_f32 v88, v88
    v_mfma_f32_32x32x16_bf16 v[64:79], v[108:111], v[20:23], v[64:79]
    ds_read_b128 v[116:119], v241 offset:7168
    v_exp_f32 v89, v89
    v_exp_f32 v90, v90
    v_exp_f32 v91, v91
    v_smfmac_f32_32x32x32_bf16 v[24:39], v[120:123], v[80:87], v224
    v_exp_f32 v92, v92
    v_exp_f32 v93, v93
    v_exp_f32 v94, v94
    v_smfmac_f32_16x16x64_bf16 v[56:59], v[220:223], v[80:87], v224
    v_exp_f32 v95, v95
    v_exp_f32 v64, v64
    v_exp_f32 v65, v65
    v_smfmac_f32_32x32x32_bf16 v[24:39], v[124:127], v[88:95], v224
    s_waitcnt lgkmcnt(0)
    v_exp_f32 v66, v66
    v_exp_f32 v67, v67
    v_exp_f32 v68, v68
    v_smfmac_f32_16x16x64_bf16 v[56:59], v[220:223], v[88:95], v224
    s_setprio 0
    v_exp_f32 v69, v69
    v_mfma_f32_32x32x16_bf16 v[80:95], v[96:99], v[8:11], 0
    v_exp_f32 v70, v70
    v_exp_f32 v71, v71
    v_exp_f32 v72, v72
    v_mfma_f32_32x32x16_bf16 v[80:95], v[100:103], v[12:15], v[80:95]
    v_exp_f32 v73, v73
    v_exp_f32 v74, v74
    v_exp_f32 v75, v75
    v_smfmac_f32_32x32x32_bf16 v[40:55], v[120:123], v[64:71], v224
    v_exp_f32 v76, v76
    v_exp_f32 v77, v77
    v_exp_f32 v78, v78
    v_smfmac_f32_16x16x64_bf16 v[60:63], v[220:223], v[64:71], v224
    v_exp_f32 v79, v79
    v_exp_f32 v80, v80
    v_exp_f32 v81, v81
    v_smfmac_f32_32x32x32_bf16 v[40:55], v[124:127], v[72:79], v224
    s_waitcnt vmcnt(4)
    s_barrier
    ds_read_b128 v[104:107], v241 offset:16384
    v_exp_f32 v82, v82
    v_exp_f32 v83, v83
    v_exp_f32 v84, v84
    v_smfmac_f32_16x16x64_bf16 v[60:63], v[220:223], v[72:79], v224
    s_setprio 3
    ds_read_b128 v[108:111], v241 offset:17408
    v_exp_f32 v85, v85
    v_mfma_f32_32x32x16_bf16 v[64:79], v[96:99], v[16:19], 0
    ds_read_b128 v[120:123], v241 offset:18432
    v_exp_f32 v86, v86
    v_exp_f32 v87, v87
    v_exp_f32 v88, v88
    v_mfma_f32_32x32x16_bf16 v[64:79], v[100:103], v[20:23], v[64:79]
    ds_read_b128 v[124:127], v241 offset:19456
    v_exp_f32 v89, v89
    v_exp_f32 v90, v90
    v_exp_f32 v91, v91
    v_smfmac_f32_32x32x32_bf16 v[24:39], v[112:115], v[80:87], v224
    s_add_u32 m0, s49, 0
    s_add_u32 s48, s67, 16941056
    buffer_load_dwordx4 v4, s[20:23], s48 offen sc1 lds
    v_exp_f32 v92, v92
    v_exp_f32 v93, v93
    v_exp_f32 v94, v94
    v_smfmac_f32_16x16x64_bf16 v[56:59], v[220:223], v[80:87], v224
    buffer_load_dwordx4 v4, s[20:23], s48 offen offset:1024 sc1 lds
    v_exp_f32 v95, v95
    v_exp_f32 v64, v64
    v_exp_f32 v65, v65
    v_smfmac_f32_32x32x32_bf16 v[24:39], v[116:119], v[88:95], v224
    s_waitcnt lgkmcnt(0)
    s_waitcnt vmcnt(8)
    s_lshl1_add_u32 s40, s45, s44
    s_lshl_b32 s40, s40, 5
    s_add_u32 s40, s40, s37
    s_lshl_b32 s40, s40, 2
    s_add_u32 s40, s40, 17358848
    s_mov_b64 exec, 1
    buffer_store_dword v240, off, s[20:23], s40 sc1
    s_mov_b64 exec, -1
    v_exp_f32 v66, v66
    v_exp_f32 v67, v67
    v_exp_f32 v68, v68
    v_smfmac_f32_16x16x64_bf16 v[56:59], v[220:223], v[88:95], v224
    s_setprio 2
    v_exp_f32 v69, v69
    v_mfma_f32_32x32x16_bf16 v[80:95], v[104:107], v[8:11], 0
    s_add_u32 m0, s67, 32768
    s_mov_b32 s58, 524288
    buffer_load_dwordx4 v226, s[28:31], s58 offen  lds
    v_exp_f32 v70, v70
    v_exp_f32 v71, v71
    v_exp_f32 v72, v72
    v_mfma_f32_32x32x16_bf16 v[80:95], v[108:111], v[12:15], v[80:95]
    s_add_u32 m0, s67, 33792
    s_nop 0
    buffer_load_dwordx4 v227, s[28:31], s58 offen  lds
    v_exp_f32 v73, v73
    v_exp_f32 v74, v74
    v_exp_f32 v75, v75
    v_smfmac_f32_32x32x32_bf16 v[40:55], v[112:115], v[64:71], v224
    s_add_u32 m0, s67, 49152
    s_mov_b32 s58, 786432
    buffer_load_dwordx4 v226, s[28:31], s58 offen  lds
    v_exp_f32 v76, v76
    v_exp_f32 v77, v77
    v_exp_f32 v78, v78
    v_smfmac_f32_16x16x64_bf16 v[60:63], v[220:223], v[64:71], v224
    v_exp_f32 v79, v79
    v_exp_f32 v80, v80
    v_exp_f32 v81, v81
    v_smfmac_f32_32x32x32_bf16 v[40:55], v[116:119], v[72:79], v224
    ds_read_b128 v[96:99], v241 offset:20480
    v_exp_f32 v82, v82
    v_exp_f32 v83, v83
    v_exp_f32 v84, v84
    v_smfmac_f32_16x16x64_bf16 v[60:63], v[220:223], v[72:79], v224
    s_setprio 1
    ds_read_b128 v[100:103], v241 offset:21504
    v_exp_f32 v85, v85
    v_mfma_f32_32x32x16_bf16 v[64:79], v[104:107], v[16:19], 0
    ds_read_b128 v[112:115], v241 offset:22528
    v_exp_f32 v86, v86
    v_exp_f32 v87, v87
    v_exp_f32 v88, v88
    v_mfma_f32_32x32x16_bf16 v[64:79], v[108:111], v[20:23], v[64:79]
    ds_read_b128 v[116:119], v241 offset:23552
    v_exp_f32 v89, v89
    v_exp_f32 v90, v90
    v_exp_f32 v91, v91
    v_smfmac_f32_32x32x32_bf16 v[24:39], v[120:123], v[80:87], v224
    s_add_u32 m0, s67, 50176
    s_nop 0
    buffer_load_dwordx4 v227, s[28:31], s58 offen  lds
    v_exp_f32 v92, v92
    v_exp_f32 v93, v93
    v_exp_f32 v94, v94
    v_smfmac_f32_16x16x64_bf16 v[56:59], v[220:223], v[80:87], v224
    v_exp_f32 v95, v95
    v_exp_f32 v64, v64
    v_exp_f32 v65, v65
    v_smfmac_f32_32x32x32_bf16 v[24:39], v[124:127], v[88:95], v224
    s_waitcnt lgkmcnt(0)
    s_add_u32 m0, s67, 65536
    s_mov_b32 s58, 1048576
    buffer_load_dwordx4 v226, s[28:31], s58 offen  lds
    v_exp_f32 v66, v66
    v_exp_f32 v67, v67
    v_exp_f32 v68, v68
    v_smfmac_f32_16x16x64_bf16 v[56:59], v[220:223], v[88:95], v224
    s_setprio 0
    v_exp_f32 v69, v69
    v_mfma_f32_32x32x16_bf16 v[80:95], v[96:99], v[8:11], 0
    v_exp_f32 v70, v70
    v_exp_f32 v71, v71
    v_exp_f32 v72, v72
    v_mfma_f32_32x32x16_bf16 v[80:95], v[100:103], v[12:15], v[80:95]
    v_exp_f32 v73, v73
    v_exp_f32 v74, v74
    v_exp_f32 v75, v75
    v_smfmac_f32_32x32x32_bf16 v[40:55], v[120:123], v[64:71], v224
    v_exp_f32 v76, v76
    v_exp_f32 v77, v77
    v_exp_f32 v78, v78
    v_smfmac_f32_16x16x64_bf16 v[60:63], v[220:223], v[64:71], v224
    v_exp_f32 v79, v79
    v_exp_f32 v80, v80
    v_exp_f32 v81, v81
    v_smfmac_f32_32x32x32_bf16 v[40:55], v[124:127], v[72:79], v224
    s_waitcnt vmcnt(6)
    s_barrier
    ds_read_b128 v[104:107], v241 offset:0
    v_exp_f32 v82, v82
    v_exp_f32 v83, v83
    v_exp_f32 v84, v84
    v_smfmac_f32_16x16x64_bf16 v[60:63], v[220:223], v[72:79], v224
    s_setprio 3
    ds_read_b128 v[108:111], v241 offset:1024
    v_exp_f32 v85, v85
    v_mfma_f32_32x32x16_bf16 v[64:79], v[96:99], v[16:19], 0
    ds_read_b128 v[120:123], v241 offset:2048
    v_exp_f32 v86, v86
    v_exp_f32 v87, v87
    v_exp_f32 v88, v88
    v_mfma_f32_32x32x16_bf16 v[64:79], v[100:103], v[20:23], v[64:79]
    ds_read_b128 v[124:127], v241 offset:3072
    v_exp_f32 v89, v89
    v_exp_f32 v90, v90
    v_exp_f32 v91, v91
    v_smfmac_f32_32x32x32_bf16 v[24:39], v[112:115], v[80:87], v224
    s_add_u32 m0, s49, 16384
    s_add_u32 s48, s67, 17006592
    buffer_load_dwordx4 v4, s[20:23], s48 offen sc1 lds
    v_exp_f32 v92, v92
    v_exp_f32 v93, v93
    v_exp_f32 v94, v94
    v_smfmac_f32_16x16x64_bf16 v[56:59], v[220:223], v[80:87], v224
    buffer_load_dwordx4 v4, s[20:23], s48 offen offset:1024 sc1 lds
    v_exp_f32 v95, v95
    v_exp_f32 v64, v64
    v_exp_f32 v65, v65
    v_smfmac_f32_32x32x32_bf16 v[24:39], v[116:119], v[88:95], v224
    s_waitcnt lgkmcnt(0)
    s_add_u32 m0, s67, 66560
    s_nop 0
    buffer_load_dwordx4 v227, s[28:31], s58 offen  lds
    v_exp_f32 v66, v66
    v_exp_f32 v67, v67
    v_exp_f32 v68, v68
    v_smfmac_f32_16x16x64_bf16 v[56:59], v[220:223], v[88:95], v224
    s_setprio 2
    v_exp_f32 v69, v69
    v_mfma_f32_32x32x16_bf16 v[80:95], v[104:107], v[8:11], 0
    s_add_u32 m0, s67, 81920
    s_mov_b32 s58, 1310720
    buffer_load_dwordx4 v226, s[28:31], s58 offen  lds
    v_exp_f32 v70, v70
    v_exp_f32 v71, v71
    v_exp_f32 v72, v72
    v_mfma_f32_32x32x16_bf16 v[80:95], v[108:111], v[12:15], v[80:95]
    s_add_u32 m0, s67, 82944
    s_nop 0
    buffer_load_dwordx4 v227, s[28:31], s58 offen  lds
    v_exp_f32 v73, v73
    v_exp_f32 v74, v74
    v_exp_f32 v75, v75
    v_smfmac_f32_32x32x32_bf16 v[40:55], v[112:115], v[64:71], v224
    s_add_u32 m0, s67, 131072
    s_mov_b32 s58, 1572864
    buffer_load_dwordx4 v226, s[28:31], s58 offen  lds
    v_exp_f32 v76, v76
    v_exp_f32 v77, v77
    v_exp_f32 v78, v78
    v_smfmac_f32_16x16x64_bf16 v[60:63], v[220:223], v[64:71], v224
    v_exp_f32 v79, v79
    v_exp_f32 v80, v80
    v_exp_f32 v81, v81
    v_smfmac_f32_32x32x32_bf16 v[40:55], v[116:119], v[72:79], v224
    ds_read_b128 v[96:99], v241 offset:4096
    v_exp_f32 v82, v82
    v_exp_f32 v83, v83
    v_exp_f32 v84, v84
    v_smfmac_f32_16x16x64_bf16 v[60:63], v[220:223], v[72:79], v224
    s_setprio 1
    ds_read_b128 v[100:103], v241 offset:5120
    v_exp_f32 v85, v85
    v_mfma_f32_32x32x16_bf16 v[64:79], v[104:107], v[16:19], 0
    ds_read_b128 v[112:115], v241 offset:6144
    v_exp_f32 v86, v86
    v_exp_f32 v87, v87
    v_exp_f32 v88, v88
    v_mfma_f32_32x32x16_bf16 v[64:79], v[108:111], v[20:23], v[64:79]
    ds_read_b128 v[116:119], v241 offset:7168
    v_exp_f32 v89, v89
    v_exp_f32 v90, v90
    v_exp_f32 v91, v91
    v_smfmac_f32_32x32x32_bf16 v[24:39], v[120:123], v[80:87], v224
    s_add_u32 m0, s67, 132096
    s_nop 0
    buffer_load_dwordx4 v227, s[28:31], s58 offen  lds
    v_exp_f32 v92, v92
    v_exp_f32 v93, v93
    v_exp_f32 v94, v94
    v_smfmac_f32_16x16x64_bf16 v[56:59], v[220:223], v[80:87], v224
    v_exp_f32 v95, v95
    v_exp_f32 v64, v64
    v_exp_f32 v65, v65
    v_smfmac_f32_32x32x32_bf16 v[24:39], v[124:127], v[88:95], v224
    s_waitcnt lgkmcnt(0)
    s_cmp_eq_u32 s38, 7
    s_cbranch_scc1 K_w7_107
    s_add_u32 m0, s67, 147456
    s_mov_b32 s58, 1835008
    buffer_load_dwordx4 v226, s[28:31], s58 offen  lds
    s_add_u32 m0, s67, 148480
    s_nop 0
    buffer_load_dwordx4 v227, s[28:31], s58 offen  lds
K_w7_107:
    v_exp_f32 v66, v66
    v_exp_f32 v67, v67
    v_exp_f32 v68, v68
    v_smfmac_f32_16x16x64_bf16 v[56:59], v[220:223], v[88:95], v224
    s_setprio 0
    v_exp_f32 v69, v69
    v_mfma_f32_32x32x16_bf16 v[80:95], v[96:99], v[8:11], 0
    v_exp_f32 v70, v70
    v_exp_f32 v71, v71
    v_exp_f32 v72, v72
    v_mfma_f32_32x32x16_bf16 v[80:95], v[100:103], v[12:15], v[80:95]
    v_exp_f32 v73, v73
    v_exp_f32 v74, v74
    v_exp_f32 v75, v75
    v_smfmac_f32_32x32x32_bf16 v[40:55], v[120:123], v[64:71], v224
    v_exp_f32 v76, v76
    v_exp_f32 v77, v77
    v_exp_f32 v78, v78
    v_smfmac_f32_16x16x64_bf16 v[60:63], v[220:223], v[64:71], v224
    v_exp_f32 v79, v79
    v_exp_f32 v80, v80
    v_exp_f32 v81, v81
    v_smfmac_f32_32x32x32_bf16 v[40:55], v[124:127], v[72:79], v224
    s_waitcnt vmcnt(5)
    s_barrier
    ds_read_b128 v[104:107], v241 offset:16384
    v_exp_f32 v82, v82
    v_exp_f32 v83, v83
    v_exp_f32 v84, v84
    v_smfmac_f32_16x16x64_bf16 v[60:63], v[220:223], v[72:79], v224
    s_setprio 3
    ds_read_b128 v[108:111], v241 offset:17408
    v_exp_f32 v85, v85
    v_mfma_f32_32x32x16_bf16 v[64:79], v[96:99], v[16:19], 0
    ds_read_b128 v[120:123], v241 offset:18432
    v_exp_f32 v86, v86
    v_exp_f32 v87, v87
    v_exp_f32 v88, v88
    v_mfma_f32_32x32x16_bf16 v[64:79], v[100:103], v[20:23], v[64:79]
    ds_read_b128 v[124:127], v241 offset:19456
    v_exp_f32 v89, v89
    v_exp_f32 v90, v90
    v_exp_f32 v91, v91
    v_smfmac_f32_32x32x32_bf16 v[24:39], v[112:115], v[80:87], v224
    s_add_u32 m0, s49, 0
    s_add_u32 s48, s67, 16826368
    buffer_load_dwordx4 v4, s[20:23], s48 offen sc1 lds
    v_exp_f32 v92, v92
    v_exp_f32 v93, v93
    v_exp_f32 v94, v94
    v_smfmac_f32_16x16x64_bf16 v[56:59], v[220:223], v[80:87], v224
    buffer_load_dwordx4 v4, s[20:23], s48 offen offset:1024 sc1 lds
    v_exp_f32 v95, v95
    v_exp_f32 v64, v64
    v_exp_f32 v65, v65
    v_smfmac_f32_32x32x32_bf16 v[24:39], v[116:119], v[88:95], v224
    s_waitcnt lgkmcnt(0)
    s_lshl1_add_u32 s51, s66, s44
    s_lshl_b32 s51, s51, 7
    s_add_u32 s51, s51, 17358848
    buffer_load_dword v251, v243, s[20:23], s51 offen sc1
    v_exp_f32 v66, v66
    v_exp_f32 v67, v67
    v_exp_f32 v68, v68
    v_smfmac_f32_16x16x64_bf16 v[56:59], v[220:223], v[88:95], v224
    s_setprio 2
    v_exp_f32 v69, v69
    v_mfma_f32_32x32x16_bf16 v[80:95], v[104:107], v[8:11], 0
    s_lshl_b32 s57, s66, 6
    s_add_u32 s57, s57, s44
    s_lshl_b32 s57, s57, 11
    s_add_u32 s57, s57, 8454144
    s_and_b32 s59, s65, 7
    s_lshl_b32 s40, s44, 10
    v_add_u32 v242, s40, v4
    v_xor_b32 v249, 0x400, v242
    v_exp_f32 v70, v70
    v_exp_f32 v71, v71
    v_exp_f32 v72, v72
    v_mfma_f32_32x32x16_bf16 v[80:95], v[108:111], v[12:15], v[80:95]
    s_and_b32 s40, s64, 3
    s_lshl3_add_u32 s40, s40, s38
    s_lshl_b32 s40, s40, 16
    s_lshl_b32 s41, s65, 7
    s_add_u32 s40, s40, s41
    v_lshlrev_b32 v5, 11, v1
    s_mov_b32 exec_hi, 0
    buffer_load_dword v255, v5, s[24:27], s40 offen
    s_mov_b32 exec_hi, -1
    v_exp_f32 v73, v73
    v_exp_f32 v74, v74
    v_exp_f32 v75, v75
    v_smfmac_f32_32x32x32_bf16 v[40:55], v[112:115], v[64:71], v224
    v_exp_f32 v76, v76
    v_exp_f32 v77, v77
    v_exp_f32 v78, v78
    v_smfmac_f32_16x16x64_bf16 v[60:63], v[220:223], v[64:71], v224
    v_exp_f32 v79, v79
    v_exp_f32 v80, v80
    v_exp_f32 v81, v81
    v_smfmac_f32_32x32x32_bf16 v[40:55], v[116:119], v[72:79], v224
    ds_read_b128 v[96:99], v241 offset:20480
    v_exp_f32 v82, v82
    v_exp_f32 v83, v83
    v_exp_f32 v84, v84
    v_smfmac_f32_16x16x64_bf16 v[60:63], v[220:223], v[72:79], v224
    s_setprio 1
    ds_read_b128 v[100:103], v241 offset:21504
    v_exp_f32 v85, v85
    v_mfma_f32_32x32x16_bf16 v[64:79], v[104:107], v[16:19], 0
    ds_read_b128 v[112:115], v241 offset:22528
    v_exp_f32 v86, v86
    v_exp_f32 v87, v87
    v_exp_f32 v88, v88
    v_mfma_f32_32x32x16_bf16 v[64:79], v[108:111], v[20:23], v[64:79]
    ds_read_b128 v[116:119], v241 offset:23552
    v_exp_f32 v89, v89
    v_exp_f32 v90, v90
    v_exp_f32 v91, v91
    v_smfmac_f32_32x32x32_bf16 v[24:39], v[120:123], v[80:87], v224
    v_exp_f32 v92, v92
    v_exp_f32 v93, v93
    v_exp_f32 v94, v94
    v_smfmac_f32_16x16x64_bf16 v[56:59], v[220:223], v[80:87], v224
    v_exp_f32 v95, v95
    v_exp_f32 v64, v64
    v_exp_f32 v65, v65
    v_smfmac_f32_32x32x32_bf16 v[24:39], v[124:127], v[88:95], v224
    s_waitcnt lgkmcnt(0)
    v_exp_f32 v66, v66
    v_exp_f32 v67, v67
    v_exp_f32 v68, v68
    v_smfmac_f32_16x16x64_bf16 v[56:59], v[220:223], v[88:95], v224
    s_setprio 0
    v_exp_f32 v69, v69
    v_mfma_f32_32x32x16_bf16 v[80:95], v[96:99], v[8:11], 0
    v_exp_f32 v70, v70
    v_exp_f32 v71, v71
    v_exp_f32 v72, v72
    v_mfma_f32_32x32x16_bf16 v[80:95], v[100:103], v[12:15], v[80:95]
    v_exp_f32 v73, v73
    v_exp_f32 v74, v74
    v_exp_f32 v75, v75
    v_smfmac_f32_32x32x32_bf16 v[40:55], v[120:123], v[64:71], v224
    v_exp_f32 v76, v76
    v_exp_f32 v77, v77
    v_exp_f32 v78, v78
    v_smfmac_f32_16x16x64_bf16 v[60:63], v[220:223], v[64:71], v224
    v_exp_f32 v79, v79
    v_exp_f32 v80, v80
    v_exp_f32 v81, v81
    v_smfmac_f32_32x32x32_bf16 v[40:55], v[124:127], v[72:79], v224
    s_waitcnt vmcnt(2)
    s_barrier
    ds_read_b128 v[104:107], v241 offset:0
    v_exp_f32 v82, v82
    v_exp_f32 v83, v83
    v_exp_f32 v84, v84
    v_smfmac_f32_16x16x64_bf16 v[60:63], v[220:223], v[72:79], v224
    s_setprio 3
    ds_read_b128 v[108:111], v241 offset:1024
    v_exp_f32 v85, v85
    v_mfma_f32_32x32x16_bf16 v[64:79], v[96:99], v[16:19], 0
    ds_read_b128 v[120:123], v241 offset:2048
    v_exp_f32 v86, v86
    v_exp_f32 v87, v87
    v_exp_f32 v88, v88
    v_mfma_f32_32x32x16_bf16 v[64:79], v[100:103], v[20:23], v[64:79]
    ds_read_b128 v[124:127], v241 offset:3072
    v_exp_f32 v89, v89
    v_exp_f32 v90, v90
    v_exp_f32 v91, v91
    v_smfmac_f32_32x32x32_bf16 v[24:39], v[112:115], v[80:87], v224
    s_add_u32 m0, s49, 16384
    s_add_u32 s48, s67, 16891904
    buffer_load_dwordx4 v4, s[20:23], s48 offen sc1 lds
    v_exp_f32 v92, v92
    v_exp_f32 v93, v93
    v_exp_f32 v94, v94
    v_smfmac_f32_16x16x64_bf16 v[56:59], v[220:223], v[80:87], v224
    buffer_load_dwordx4 v4, s[20:23], s48 offen offset:1024 sc1 lds
    v_exp_f32 v95, v95
    v_exp_f32 v64, v64
    v_exp_f32 v65, v65
    v_smfmac_f32_32x32x32_bf16 v[24:39], v[116:119], v[88:95], v224
    s_waitcnt lgkmcnt(0)
    s_waitcnt vmcnt(3)
K_op_108:
    v_cmp_ne_u32 vcc, s39, v251
    s_cbranch_vccz K_oo_109
    s_add_u32 s3, s3, 1
    s_cmp_gt_u32 s3, 1048576
    s_cbranch_scc1 K_oo_109
    buffer_load_dword v251, v243, s[20:23], s51 offen sc1
    s_waitcnt vmcnt(0)
    s_branch K_op_108
K_oo_109:
    v_exp_f32 v66, v66
    v_exp_f32 v67, v67
    v_exp_f32 v68, v68
    v_smfmac_f32_16x16x64_bf16 v[56:59], v[220:223], v[88:95], v224
    s_setprio 2
    v_exp_f32 v69, v69
    v_mfma_f32_32x32x16_bf16 v[80:95], v[104:107], v[8:11], 0
    buffer_load_dwordx4 v[128:131], v242, s[20:23], s57 offen sc1
    v_exp_f32 v70, v70
    v_exp_f32 v71, v71
    v_exp_f32 v72, v72
    v_mfma_f32_32x32x16_bf16 v[80:95], v[108:111], v[12:15], v[80:95]
    buffer_load_dwordx4 v[132:135], v249, s[20:23], s57 offen sc1
    s_add_u32 s57, s57, 4096
    v_exp_f32 v73, v73
    v_exp_f32 v74, v74
    v_exp_f32 v75, v75
    v_smfmac_f32_32x32x32_bf16 v[40:55], v[112:115], v[64:71], v224
    buffer_load_dwordx4 v[136:139], v242, s[20:23], s57 offen sc1
    v_exp_f32 v76, v76
    v_exp_f32 v77, v77
    v_exp_f32 v78, v78
    v_smfmac_f32_16x16x64_bf16 v[60:63], v[220:223], v[64:71], v224
    v_exp_f32 v79, v79
    v_exp_f32 v80, v80
    v_exp_f32 v81, v81
    v_smfmac_f32_32x32x32_bf16 v[40:55], v[116:119], v[72:79], v224
    ds_read_b128 v[96:99], v241 offset:4096
    v_exp_f32 v82, v82
    v_exp_f32 v83, v83
    v_exp_f32 v84, v84
    v_smfmac_f32_16x16x64_bf16 v[60:63], v[220:223], v[72:79], v224
    s_setprio 1
    ds_read_b128 v[100:103], v241 offset:5120
    v_exp_f32 v85, v85
    v_mfma_f32_32x32x16_bf16 v[64:79], v[104:107], v[16:19], 0
    ds_read_b128 v[112:115], v241 offset:6144
    v_exp_f32 v86, v86
    v_exp_f32 v87, v87
    v_exp_f32 v88, v88
    v_mfma_f32_32x32x16_bf16 v[64:79], v[108:111], v[20:23], v[64:79]
    ds_read_b128 v[116:119], v241 offset:7168
    v_exp_f32 v89, v89
    v_exp_f32 v90, v90
    v_exp_f32 v91, v91
    v_smfmac_f32_32x32x32_bf16 v[24:39], v[120:123], v[80:87], v224
    buffer_load_dwordx4 v[140:143], v249, s[20:23], s57 offen sc1
    s_add_u32 s57, s57, 4096
    v_exp_f32 v92, v92
    v_exp_f32 v93, v93
    v_exp_f32 v94, v94
    v_smfmac_f32_16x16x64_bf16 v[56:59], v[220:223], v[80:87], v224
    v_exp_f32 v95, v95
    v_exp_f32 v64, v64
    v_exp_f32 v65, v65
    v_smfmac_f32_32x32x32_bf16 v[24:39], v[124:127], v[88:95], v224
    s_waitcnt lgkmcnt(0)
    buffer_load_dwordx4 v[144:147], v242, s[20:23], s57 offen sc1
    v_exp_f32 v66, v66
    v_exp_f32 v67, v67
    v_exp_f32 v68, v68
    v_smfmac_f32_16x16x64_bf16 v[56:59], v[220:223], v[88:95], v224
    s_setprio 0
    v_exp_f32 v69, v69
    v_mfma_f32_32x32x16_bf16 v[80:95], v[96:99], v[8:11], 0
    buffer_load_dwordx4 v[148:151], v249, s[20:23], s57 offen sc1
    s_add_u32 s57, s57, 4096
    v_exp_f32 v70, v70
    v_exp_f32 v71, v71
    v_exp_f32 v72, v72
    v_mfma_f32_32x32x16_bf16 v[80:95], v[100:103], v[12:15], v[80:95]
    buffer_load_dwordx4 v[152:155], v242, s[20:23], s57 offen sc1
    v_exp_f32 v73, v73
    v_exp_f32 v74, v74
    v_exp_f32 v75, v75
    v_smfmac_f32_32x32x32_bf16 v[40:55], v[120:123], v[64:71], v224
    v_exp_f32 v76, v76
    v_exp_f32 v77, v77
    v_exp_f32 v78, v78
    v_smfmac_f32_16x16x64_bf16 v[60:63], v[220:223], v[64:71], v224
    v_exp_f32 v79, v79
    v_exp_f32 v80, v80
    v_exp_f32 v81, v81
    v_smfmac_f32_32x32x32_bf16 v[40:55], v[124:127], v[72:79], v224
    s_waitcnt vmcnt(7)
    s_barrier
    ds_read_b128 v[104:107], v241 offset:16384
    v_exp_f32 v82, v82
    v_exp_f32 v83, v83
    v_exp_f32 v84, v84
    v_smfmac_f32_16x16x64_bf16 v[60:63], v[220:223], v[72:79], v224
    s_setprio 3
    ds_read_b128 v[108:111], v241 offset:17408
    v_exp_f32 v85, v85
    v_mfma_f32_32x32x16_bf16 v[64:79], v[96:99], v[16:19], 0
    ds_read_b128 v[120:123], v241 offset:18432
    v_exp_f32 v86, v86
    v_exp_f32 v87, v87
    v_exp_f32 v88, v88
    v_mfma_f32_32x32x16_bf16 v[64:79], v[100:103], v[20:23], v[64:79]
    ds_read_b128 v[124:127], v241 offset:19456
    v_exp_f32 v89, v89
    v_exp_f32 v90, v90
    v_exp_f32 v91, v91
    v_smfmac_f32_32x32x32_bf16 v[24:39], v[112:115], v[80:87], v224
    s_add_u32 m0, s49, 0
    s_add_u32 s48, s67, 16957440
    buffer_load_dwordx4 v4, s[20:23], s48 offen sc1 lds
    v_exp_f32 v92, v92
    v_exp_f32 v93, v93
    v_exp_f32 v94, v94
    v_smfmac_f32_16x16x64_bf16 v[56:59], v[220:223], v[80:87], v224
    buffer_load_dwordx4 v4, s[20:23], s48 offen offset:1024 sc1 lds
    v_exp_f32 v95, v95
    v_exp_f32 v64, v64
    v_exp_f32 v65, v65
    v_smfmac_f32_32x32x32_bf16 v[24:39], v[116:119], v[88:95], v224
    s_waitcnt lgkmcnt(0)
    buffer_load_dwordx4 v[156:159], v249, s[20:23], s57 offen sc1
    s_add_u32 s57, s57, 4096
    v_exp_f32 v66, v66
    v_exp_f32 v67, v67
    v_exp_f32 v68, v68
    v_smfmac_f32_16x16x64_bf16 v[56:59], v[220:223], v[88:95], v224
    s_setprio 2
    v_exp_f32 v69, v69
    v_mfma_f32_32x32x16_bf16 v[80:95], v[104:107], v[8:11], 0
    buffer_load_dwordx4 v[160:163], v242, s[20:23], s57 offen sc1
    v_exp_f32 v70, v70
    v_exp_f32 v71, v71
    v_exp_f32 v72, v72
    v_mfma_f32_32x32x16_bf16 v[80:95], v[108:111], v[12:15], v[80:95]
    buffer_load_dwordx4 v[164:167], v249, s[20:23], s57 offen sc1
    s_add_u32 s57, s57, 4096
    v_exp_f32 v73, v73
    v_exp_f32 v74, v74
    v_exp_f32 v75, v75
    v_smfmac_f32_32x32x32_bf16 v[40:55], v[112:115], v[64:71], v224
    buffer_load_dwordx4 v[168:171], v242, s[20:23], s57 offen sc1
    v_exp_f32 v76, v76
    v_exp_f32 v77, v77
    v_exp_f32 v78, v78
    v_smfmac_f32_16x16x64_bf16 v[60:63], v[220:223], v[64:71], v224
    v_exp_f32 v79, v79
    v_exp_f32 v80, v80
    v_exp_f32 v81, v81
    v_smfmac_f32_32x32x32_bf16 v[40:55], v[116:119], v[72:79], v224
    ds_read_b128 v[96:99], v241 offset:20480
    v_exp_f32 v82, v82
    v_exp_f32 v83, v83
    v_exp_f32 v84, v84
    v_smfmac_f32_16x16x64_bf16 v[60:63], v[220:223], v[72:79], v224
    s_setprio 1
    ds_read_b128 v[100:103], v241 offset:21504
    v_exp_f32 v85, v85
    v_mfma_f32_32x32x16_bf16 v[64:79], v[104:107], v[16:19], 0
    ds_read_b128 v[112:115], v241 offset:22528
    v_exp_f32 v86, v86
    v_exp_f32 v87, v87
    v_exp_f32 v88, v88
    v_mfma_f32_32x32x16_bf16 v[64:79], v[108:111], v[20:23], v[64:79]
    ds_read_b128 v[116:119], v241 offset:23552
    v_exp_f32 v89, v89
    v_exp_f32 v90, v90
    v_exp_f32 v91, v91
    v_smfmac_f32_32x32x32_bf16 v[24:39], v[120:123], v[80:87], v224
    buffer_load_dwordx4 v[172:175], v249, s[20:23], s57 offen sc1
    s_add_u32 s57, s57, 4096
    v_exp_f32 v92, v92
    v_exp_f32 v93, v93
    v_exp_f32 v94, v94
    v_smfmac_f32_16x16x64_bf16 v[56:59], v[220:223], v[80:87], v224
    v_exp_f32 v95, v95
    v_exp_f32 v64, v64
    v_exp_f32 v65, v65
    v_smfmac_f32_32x32x32_bf16 v[24:39], v[124:127], v[88:95], v224
    s_waitcnt lgkmcnt(0)
    buffer_load_dwordx4 v[176:179], v242, s[20:23], s57 offen sc1
    v_exp_f32 v66, v66
    v_exp_f32 v67, v67
    v_exp_f32 v68, v68
    v_smfmac_f32_16x16x64_bf16 v[56:59], v[220:223], v[88:95], v224
    s_setprio 0
    v_exp_f32 v69, v69
    v_mfma_f32_32x32x16_bf16 v[80:95], v[96:99], v[8:11], 0
    buffer_load_dwordx4 v[180:183], v249, s[20:23], s57 offen sc1
    s_add_u32 s57, s57, 4096
    v_exp_f32 v70, v70
    v_exp_f32 v71, v71
    v_exp_f32 v72, v72
    v_mfma_f32_32x32x16_bf16 v[80:95], v[100:103], v[12:15], v[80:95]
    v_exp_f32 v73, v73
    v_exp_f32 v74, v74
    v_exp_f32 v75, v75
    v_smfmac_f32_32x32x32_bf16 v[40:55], v[120:123], v[64:71], v224
    v_exp_f32 v76, v76
    v_exp_f32 v77, v77
    v_exp_f32 v78, v78
    v_smfmac_f32_16x16x64_bf16 v[60:63], v[220:223], v[64:71], v224
    v_exp_f32 v79, v79
    v_exp_f32 v80, v80
    v_exp_f32 v81, v81
    v_smfmac_f32_32x32x32_bf16 v[40:55], v[124:127], v[72:79], v224
    s_waitcnt vmcnt(7)
    s_barrier
    ds_read_b128 v[104:107], v241 offset:0
    v_exp_f32 v82, v82
    v_exp_f32 v83, v83
    v_exp_f32 v84, v84
    v_smfmac_f32_16x16x64_bf16 v[60:63], v[220:223], v[72:79], v224
    s_setprio 3
    ds_read_b128 v[108:111], v241 offset:1024
    v_exp_f32 v85, v85
    v_mfma_f32_32x32x16_bf16 v[64:79], v[96:99], v[16:19], 0
    ds_read_b128 v[120:123], v241 offset:2048
    v_exp_f32 v86, v86
    v_exp_f32 v87, v87
    v_exp_f32 v88, v88
    v_mfma_f32_32x32x16_bf16 v[64:79], v[100:103], v[20:23], v[64:79]
    ds_read_b128 v[124:127], v241 offset:3072
    v_exp_f32 v89, v89
    v_exp_f32 v90, v90
    v_exp_f32 v91, v91
    v_smfmac_f32_32x32x32_bf16 v[24:39], v[112:115], v[80:87], v224
    s_add_u32 m0, s49, 16384
    s_add_u32 s48, s67, 17022976
    buffer_load_dwordx4 v4, s[20:23], s48 offen sc1 lds
    v_exp_f32 v92, v92
    v_exp_f32 v93, v93
    v_exp_f32 v94, v94
    v_smfmac_f32_16x16x64_bf16 v[56:59], v[220:223], v[80:87], v224
    buffer_load_dwordx4 v4, s[20:23], s48 offen offset:1024 sc1 lds
    v_exp_f32 v95, v95
    v_exp_f32 v64, v64
    v_exp_f32 v65, v65
    v_smfmac_f32_32x32x32_bf16 v[24:39], v[116:119], v[88:95], v224
    s_waitcnt lgkmcnt(0)
    buffer_load_dwordx4 v[184:187], v242, s[20:23], s57 offen sc1
    v_exp_f32 v66, v66
    v_exp_f32 v67, v67
    v_exp_f32 v68, v68
    v_smfmac_f32_16x16x64_bf16 v[56:59], v[220:223], v[88:95], v224
    s_setprio 2
    v_exp_f32 v69, v69
    v_mfma_f32_32x32x16_bf16 v[80:95], v[104:107], v[8:11], 0
    buffer_load_dwordx4 v[188:191], v249, s[20:23], s57 offen sc1
    s_add_u32 s57, s57, 4096
    v_exp_f32 v70, v70
    v_exp_f32 v71, v71
    v_exp_f32 v72, v72
    v_mfma_f32_32x32x16_bf16 v[80:95], v[108:111], v[12:15], v[80:95]
    buffer_load_dwordx4 v[192:195], v242, s[20:23], s57 offen sc1
    v_exp_f32 v73, v73
    v_exp_f32 v74, v74
    v_exp_f32 v75, v75
    v_smfmac_f32_32x32x32_bf16 v[40:55], v[112:115], v[64:71], v224
    buffer_load_dwordx4 v[196:199], v249, s[20:23], s57 offen sc1
    s_add_u32 s57, s57, 4096
    v_exp_f32 v76, v76
    v_exp_f32 v77, v77
    v_exp_f32 v78, v78
    v_smfmac_f32_16x16x64_bf16 v[60:63], v[220:223], v[64:71], v224
    v_exp_f32 v79, v79
    v_exp_f32 v80, v80
    v_exp_f32 v81, v81
    v_smfmac_f32_32x32x32_bf16 v[40:55], v[116:119], v[72:79], v224
    ds_read_b128 v[96:99], v241 offset:4096
    v_exp_f32 v82, v82
    v_exp_f32 v83, v83
    v_exp_f32 v84, v84
    v_smfmac_f32_16x16x64_bf16 v[60:63], v[220:223], v[72:79], v224
    s_setprio 1
    ds_read_b128 v[100:103], v241 offset:5120
    v_exp_f32 v85, v85
    v_mfma_f32_32x32x16_bf16 v[64:79], v[104:107], v[16:19], 0
    ds_read_b128 v[112:115], v241 offset:6144
    v_exp_f32 v86, v86
    v_exp_f32 v87, v87
    v_exp_f32 v88, v88
    v_mfma_f32_32x32x16_bf16 v[64:79], v[108:111], v[20:23], v[64:79]
    ds_read_b128 v[116:119], v241 offset:7168
    v_exp_f32 v89, v89
    v_exp_f32 v90, v90
    v_exp_f32 v91, v91
    v_smfmac_f32_32x32x32_bf16 v[24:39], v[120:123], v[80:87], v224
    buffer_load_dwordx4 v[200:203], v242, s[20:23], s57 offen sc1
    v_exp_f32 v92, v92
    v_exp_f32 v93, v93
    v_exp_f32 v94, v94
    v_smfmac_f32_16x16x64_bf16 v[56:59], v[220:223], v[80:87], v224
    v_exp_f32 v95, v95
    v_exp_f32 v64, v64
    v_exp_f32 v65, v65
    v_smfmac_f32_32x32x32_bf16 v[24:39], v[124:127], v[88:95], v224
    s_waitcnt lgkmcnt(0)
    buffer_load_dwordx4 v[204:207], v249, s[20:23], s57 offen sc1
    s_add_u32 s57, s57, 4096
    v_exp_f32 v66, v66
    v_exp_f32 v67, v67
    v_exp_f32 v68, v68
    v_smfmac_f32_16x16x64_bf16 v[56:59], v[220:223], v[88:95], v224
    s_setprio 0
    v_exp_f32 v69, v69
    v_mfma_f32_32x32x16_bf16 v[80:95], v[96:99], v[8:11], 0
    buffer_load_dwordx4 v[208:211], v242, s[20:23], s57 offen sc1
    v_exp_f32 v70, v70
    v_exp_f32 v71, v71
    v_exp_f32 v72, v72
    v_mfma_f32_32x32x16_bf16 v[80:95], v[100:103], v[12:15], v[80:95]
    v_exp_f32 v73, v73
    v_exp_f32 v74, v74
    v_exp_f32 v75, v75
    v_smfmac_f32_32x32x32_bf16 v[40:55], v[120:123], v[64:71], v224
    v_exp_f32 v76, v76
    v_exp_f32 v77, v77
    v_exp_f32 v78, v78
    v_smfmac_f32_16x16x64_bf16 v[60:63], v[220:223], v[64:71], v224
    v_exp_f32 v79, v79
    v_exp_f32 v80, v80
    v_exp_f32 v81, v81
    v_smfmac_f32_32x32x32_bf16 v[40:55], v[124:127], v[72:79], v224
    s_waitcnt vmcnt(7)
    s_barrier
    ds_read_b128 v[104:107], v241 offset:16384
    v_exp_f32 v82, v82
    v_exp_f32 v83, v83
    v_exp_f32 v84, v84
    v_smfmac_f32_16x16x64_bf16 v[60:63], v[220:223], v[72:79], v224
    s_setprio 3
    ds_read_b128 v[108:111], v241 offset:17408
    v_exp_f32 v85, v85
    v_mfma_f32_32x32x16_bf16 v[64:79], v[96:99], v[16:19], 0
    ds_read_b128 v[120:123], v241 offset:18432
    v_exp_f32 v86, v86
    v_exp_f32 v87, v87
    v_exp_f32 v88, v88
    v_mfma_f32_32x32x16_bf16 v[64:79], v[100:103], v[20:23], v[64:79]
    ds_read_b128 v[124:127], v241 offset:19456
    v_exp_f32 v89, v89
    v_exp_f32 v90, v90
    v_exp_f32 v91, v91
    v_smfmac_f32_32x32x32_bf16 v[24:39], v[112:115], v[80:87], v224
    v_exp_f32 v92, v92
    v_exp_f32 v93, v93
    v_exp_f32 v94, v94
    v_smfmac_f32_16x16x64_bf16 v[56:59], v[220:223], v[80:87], v224
    v_exp_f32 v95, v95
    v_exp_f32 v64, v64
    v_exp_f32 v65, v65
    v_smfmac_f32_32x32x32_bf16 v[24:39], v[116:119], v[88:95], v224
    s_waitcnt lgkmcnt(0)
    buffer_load_dwordx4 v[212:215], v249, s[20:23], s57 offen sc1
    s_add_u32 s57, s57, 4096
    v_exp_f32 v66, v66
    v_exp_f32 v67, v67
    v_exp_f32 v68, v68
    v_smfmac_f32_16x16x64_bf16 v[56:59], v[220:223], v[88:95], v224
    s_setprio 2
    v_exp_f32 v69, v69
    v_mfma_f32_32x32x16_bf16 v[80:95], v[104:107], v[8:11], 0
    buffer_load_dwordx4 v[216:219], v242, s[20:23], s57 offen sc1
    v_exp_f32 v70, v70
    v_exp_f32 v71, v71
    v_exp_f32 v72, v72
    v_mfma_f32_32x32x16_bf16 v[80:95], v[108:111], v[12:15], v[80:95]
    buffer_load_dwordx4 v[232:235], v249, s[20:23], s57 offen sc1
    s_add_u32 s57, s57, 4096
    v_exp_f32 v73, v73
    v_exp_f32 v74, v74
    v_exp_f32 v75, v75
    v_smfmac_f32_32x32x32_bf16 v[40:55], v[112:115], v[64:71], v224
    buffer_load_dwordx4 v[236:239], v242, s[20:23], s57 offen sc1
    v_exp_f32 v76, v76
    v_exp_f32 v77, v77
    v_exp_f32 v78, v78
    v_smfmac_f32_16x16x64_bf16 v[60:63], v[220:223], v[64:71], v224
    v_exp_f32 v79, v79
    v_exp_f32 v80, v80
    v_exp_f32 v81, v81
    v_smfmac_f32_32x32x32_bf16 v[40:55], v[116:119], v[72:79], v224
    ds_read_b128 v[96:99], v241 offset:20480
    v_exp_f32 v82, v82
    v_exp_f32 v83, v83
    v_exp_f32 v84, v84
    v_smfmac_f32_16x16x64_bf16 v[60:63], v[220:223], v[72:79], v224
    s_setprio 1
    ds_read_b128 v[100:103], v241 offset:21504
    v_exp_f32 v85, v85
    v_mfma_f32_32x32x16_bf16 v[64:79], v[104:107], v[16:19], 0
    ds_read_b128 v[112:115], v241 offset:22528
    v_exp_f32 v86, v86
    v_exp_f32 v87, v87
    v_exp_f32 v88, v88
    v_mfma_f32_32x32x16_bf16 v[64:79], v[108:111], v[20:23], v[64:79]
    ds_read_b128 v[116:119], v241 offset:23552
    v_exp_f32 v89, v89
    v_exp_f32 v90, v90
    v_exp_f32 v91, v91
    v_smfmac_f32_32x32x32_bf16 v[24:39], v[120:123], v[80:87], v224
    buffer_load_dwordx4 v[244:247], v249, s[20:23], s57 offen sc1
    s_add_u32 s57, s57, 4096
    v_exp_f32 v92, v92
    v_exp_f32 v93, v93
    v_exp_f32 v94, v94
    v_smfmac_f32_16x16x64_bf16 v[56:59], v[220:223], v[80:87], v224
    v_exp_f32 v95, v95
    v_exp_f32 v64, v64
    v_exp_f32 v65, v65
    v_smfmac_f32_32x32x32_bf16 v[24:39], v[124:127], v[88:95], v224
    s_waitcnt lgkmcnt(0)
    v_exp_f32 v66, v66
    v_exp_f32 v67, v67
    v_exp_f32 v68, v68
    v_smfmac_f32_16x16x64_bf16 v[56:59], v[220:223], v[88:95], v224
    s_setprio 0
    v_exp_f32 v69, v69
    v_mfma_f32_32x32x16_bf16 v[80:95], v[96:99], v[16:19], 0
    v_exp_f32 v70, v70
    v_exp_f32 v71, v71
    v_exp_f32 v72, v72
    v_mfma_f32_32x32x16_bf16 v[80:95], v[100:103], v[20:23], v[80:95]
    v_exp_f32 v73, v73
    v_exp_f32 v74, v74
    v_exp_f32 v75, v75
    v_smfmac_f32_32x32x32_bf16 v[40:55], v[120:123], v[64:71], v224
    v_exp_f32 v76, v76
    v_exp_f32 v77, v77
    v_exp_f32 v78, v78
    v_smfmac_f32_16x16x64_bf16 v[60:63], v[220:223], v[64:71], v224
    v_exp_f32 v79, v79
    v_exp_f32 v80, v80
    v_exp_f32 v81, v81
    v_smfmac_f32_32x32x32_bf16 v[40:55], v[124:127], v[72:79], v224
    s_barrier
    v_exp_f32 v82, v82
    v_exp_f32 v83, v83
    v_exp_f32 v84, v84
    v_smfmac_f32_16x16x64_bf16 v[60:63], v[220:223], v[72:79], v224
    s_setprio 2
    v_exp_f32 v85, v85
    v_mfma_f32_32x32x16_bf16 v[64:79], v[96:99], v[8:11], 0
    v_add_u32 v5, 98304, v250
    v_lshrrev_b32 v7, 4, v250
    v_and_b32 v7, 0x700, v7
    v_lshl_add_u32 v7, v1, 2, v7
    v_exp_f32 v86, v86
    v_exp_f32 v87, v87
    v_exp_f32 v88, v88
    v_mfma_f32_32x32x16_bf16 v[64:79], v[100:103], v[12:15], v[64:79]
    v_add_u32 v7, 161792, v7
    v_xor_b32 v6, 0x4000, v5
    v_xor_b32 v252, 0x400, v7
    v_exp_f32 v89, v89
    v_exp_f32 v90, v90
    v_exp_f32 v91, v91
    v_smfmac_f32_32x32x32_bf16 v[40:55], v[112:115], v[80:87], v224
    v_exp_f32 v92, v92
    v_exp_f32 v93, v93
    v_exp_f32 v94, v94
    v_smfmac_f32_16x16x64_bf16 v[60:63], v[220:223], v[80:87], v224
    v_exp_f32 v95, v95
    v_exp_f32 v64, v64
    v_exp_f32 v65, v65
    v_smfmac_f32_32x32x32_bf16 v[40:55], v[116:119], v[88:95], v224
    v_exp_f32 v66, v66
    v_exp_f32 v67, v67
    v_exp_f32 v68, v68
    v_smfmac_f32_16x16x64_bf16 v[60:63], v[220:223], v[88:95], v224
    s_setprio 1
    v_exp_f32 v69, v69
    v_exp_f32 v70, v70
    v_exp_f32 v71, v71
    v_exp_f32 v72, v72
    ds_write_b128 v5, v[40:43] offset:0
    ds_write_b128 v5, v[44:47] offset:1024
    v_exp_f32 v73, v73
    v_exp_f32 v74, v74
    v_exp_f32 v75, v75
    v_smfmac_f32_32x32x32_bf16 v[24:39], v[112:115], v[64:71], v224
    ds_write_b128 v5, v[48:51] offset:2048
    ds_write_b128 v5, v[52:55] offset:3072
    v_exp_f32 v76, v76
    v_exp_f32 v77, v77
    v_exp_f32 v78, v78
    v_smfmac_f32_16x16x64_bf16 v[56:59], v[220:223], v[64:71], v224
    ds_write_b32 v7, v60
    v_exp_f32 v79, v79
    s_mov_b32 s54, 0
    s_setprio 0
    v_smfmac_f32_32x32x32_bf16 v[24:39], v[116:119], v[72:79], v224
    v_smfmac_f32_16x16x64_bf16 v[56:59], v[220:223], v[72:79], v224
    s_waitcnt lgkmcnt(0)
    s_barrier
    ds_read_b32 v60, v252
    ds_read_b128 v[40:43], v6 offset:0
    ds_read_b128 v[44:47], v6 offset:1024
    ds_read_b128 v[48:51], v6 offset:2048
    ds_read_b128 v[52:55], v6 offset:3072
    ds_read_b64_tr_b16 v[96:97], v228 offset:0
    ds_read_b64_tr_b16 v[98:99], v228 offset:1024
    ds_read_b64_tr_b16 v[100:101], v228 offset:8192
    ds_read_b64_tr_b16 v[102:103], v228 offset:9216
    ds_read_b64_tr_b16 v[104:105], v229 offset:0
    ds_read_b64_tr_b16 v[106:107], v229 offset:1024
    ds_read_b64_tr_b16 v[108:109], v229 offset:8192
    ds_read_b64_tr_b16 v[110:111], v229 offset:9216
    s_waitcnt lgkmcnt(12)
    v_add_f32 v56, v56, v60
    s_waitcnt lgkmcnt(11)
    v_pk_add_f32 v[24:25], v[24:25], v[40:41]
    v_pk_add_f32 v[26:27], v[26:27], v[42:43]
    s_waitcnt lgkmcnt(10)
    v_pk_add_f32 v[28:29], v[28:29], v[44:45]
    v_pk_add_f32 v[30:31], v[30:31], v[46:47]
    s_waitcnt lgkmcnt(9)
    v_pk_add_f32 v[32:33], v[32:33], v[48:49]
    v_pk_add_f32 v[34:35], v[34:35], v[50:51]
    s_waitcnt lgkmcnt(8)
    v_pk_add_f32 v[36:37], v[36:37], v[52:53]
    v_pk_add_f32 v[38:39], v[38:39], v[54:55]
    ds_read_b64_tr_b16 v[112:113], v230 offset:0
    ds_read_b64_tr_b16 v[114:115], v230 offset:1024
    ds_read_b64_tr_b16 v[116:117], v230 offset:8192
    ds_read_b64_tr_b16 v[118:119], v230 offset:9216
    ds_read_b64_tr_b16 v[120:121], v231 offset:0
    ds_read_b64_tr_b16 v[122:123], v231 offset:1024
    ds_read_b64_tr_b16 v[124:125], v231 offset:8192
    ds_read_b64_tr_b16 v[126:127], v231 offset:9216
K_backA:
    v_rcp_f32 v5, v56
    s_nop 0
    v_mul_f32 v6, v5, v248
    v_pk_mul_f32 v[24:25], v[24:25], v[6:7] op_sel_hi:[1,0]
    v_pk_mul_f32 v[26:27], v[26:27], v[6:7] op_sel_hi:[1,0]
    v_pk_mul_f32 v[28:29], v[28:29], v[6:7] op_sel_hi:[1,0]
    v_pk_mul_f32 v[30:31], v[30:31], v[6:7] op_sel_hi:[1,0]
    v_pk_mul_f32 v[32:33], v[32:33], v[6:7] op_sel_hi:[1,0]
    v_pk_mul_f32 v[34:35], v[34:35], v[6:7] op_sel_hi:[1,0]
    v_pk_mul_f32 v[36:37], v[36:37], v[6:7] op_sel_hi:[1,0]
    v_pk_mul_f32 v[38:39], v[38:39], v[6:7] op_sel_hi:[1,0]
    v_mov_b32 v5, 0
    v_cvt_pk_bf16_f32 v16, v24, v25
    v_cvt_pk_bf16_f32 v17, v26, v27
    v_cvt_pk_bf16_f32 v18, v28, v29
    v_cvt_pk_bf16_f32 v19, v30, v31
    v_cvt_pk_bf16_f32 v20, v32, v33
    v_cvt_pk_bf16_f32 v21, v34, v35
    v_cvt_pk_bf16_f32 v22, v36, v37
    v_cvt_pk_bf16_f32 v23, v38, v39
    v_dot2_f32_bf16 v5, v16, v16, v5
    v_dot2_f32_bf16 v5, v17, v17, v5
    v_dot2_f32_bf16 v5, v18, v18, v5
    v_dot2_f32_bf16 v5, v19, v19, v5
    v_dot2_f32_bf16 v5, v20, v20, v5
    v_dot2_f32_bf16 v5, v21, v21, v5
    v_dot2_f32_bf16 v5, v22, v22, v5
    v_dot2_f32_bf16 v5, v23, v23, v5
    v_cmp_lt_f32 vcc, 0x30800000, v56
    s_lshl_b32 s50, s45, 6
    s_add_u32 s50, s50, s46
    s_xor_b32 s50, s50, 2
    s_mov_b64 s[42:43], vcc
    v_add_f32 v5, v5, v56
    v_cmp_gt_f32 vcc, 0x71800000, v5
    s_lshl_b32 s50, s50, 11
    s_add_u32 s50, s50, 8388608
    s_and_b64 vcc, vcc, s[42:43]
    s_cmp_eq_u64 vcc, -1
    s_cbranch_scc0 K_slowA
K_okA:
    buffer_store_dwordx4 v[16:19], v225, s[20:23], s50 offen sc1
    buffer_store_dwordx4 v[20:23], v225, s[20:23], s50 offen offset:512 sc1
    s_waitcnt vmcnt(28) lgkmcnt(8)
    s_setprio 1
    v_mfma_f32_16x16x32_bf16 v[64:67], v[96:99], v[128:131], 0
    ds_read_b64_tr_b16 v[48:49], v228 offset:16384
    v_mfma_f32_16x16x32_bf16 v[64:67], v[100:103], v[136:139], v[64:67]
    ds_read_b64_tr_b16 v[50:51], v228 offset:17408
    buffer_load_dwordx4 v[24:27], v242, s[20:23], s57 offen sc1
    v_mfma_f32_16x16x32_bf16 v[80:83], v[100:103], v[140:143], 0
    ds_read_b64_tr_b16 v[52:53], v228 offset:24576
    v_mfma_f32_16x16x32_bf16 v[80:83], v[96:99], v[132:135], v[80:83]
    ds_read_b64_tr_b16 v[54:55], v228 offset:25600
    v_mfma_f32_16x16x32_bf16 v[84:87], v[104:107], v[132:135], 0
    ds_read_b64_tr_b16 v[56:57], v229 offset:16384
    v_mfma_f32_16x16x32_bf16 v[84:87], v[108:111], v[140:143], v[84:87]
    ds_read_b64_tr_b16 v[58:59], v229 offset:17408
    buffer_load_dwordx4 v[28:31], v249, s[20:23], s57 offen sc1
    s_add_u32 s57, s57, 4096
    v_mfma_f32_16x16x32_bf16 v[68:71], v[108:111], v[136:139], 0
    ds_read_b64_tr_b16 v[60:61], v229 offset:24576
    v_mfma_f32_16x16x32_bf16 v[68:71], v[104:107], v[128:131], v[68:71]
    ds_read_b64_tr_b16 v[62:63], v229 offset:25600
    s_waitcnt vmcnt(30) lgkmcnt(8)
    s_setprio 0
    v_mfma_f32_16x16x32_bf16 v[72:75], v[112:115], v[128:131], 0
    ds_read_b64_tr_b16 v[96:97], v230 offset:16384
    v_add_u32 v8, 0x10000, v228
    v_mfma_f32_16x16x32_bf16 v[72:75], v[116:119], v[136:139], v[72:75]
    ds_read_b64_tr_b16 v[98:99], v230 offset:17408
    v_add_u32 v9, 0x10000, v229
    buffer_load_dwordx4 v[32:35], v242, s[20:23], s57 offen sc1
    v_mfma_f32_16x16x32_bf16 v[88:91], v[116:119], v[140:143], 0
    ds_read_b64_tr_b16 v[100:101], v230 offset:24576
    v_add_u32 v10, 0x10000, v230
    v_mfma_f32_16x16x32_bf16 v[88:91], v[112:115], v[132:135], v[88:91]
    ds_read_b64_tr_b16 v[102:103], v230 offset:25600
    v_add_u32 v11, 0x10000, v231
    v_mfma_f32_16x16x32_bf16 v[92:95], v[120:123], v[132:135], 0
    ds_read_b64_tr_b16 v[104:105], v231 offset:16384
    v_add_u32 v12, 0x20000, v228
    v_mfma_f32_16x16x32_bf16 v[92:95], v[124:127], v[140:143], v[92:95]
    ds_read_b64_tr_b16 v[106:107], v231 offset:17408
    v_add_u32 v13, 0x20000, v229
    buffer_load_dwordx4 v[36:39], v249, s[20:23], s57 offen sc1
    s_add_u32 s57, s57, 4096
    v_mfma_f32_16x16x32_bf16 v[76:79], v[124:127], v[136:139], 0
    ds_read_b64_tr_b16 v[108:109], v231 offset:24576
    v_add_u32 v14, 0x20000, v230
    v_mfma_f32_16x16x32_bf16 v[76:79], v[120:123], v[128:131], v[76:79]
    ds_read_b64_tr_b16 v[110:111], v231 offset:25600
    v_add_u32 v15, 0x20000, v231
    s_waitcnt vmcnt(26) lgkmcnt(0)
    s_barrier
    s_setprio 3
    v_mfma_f32_16x16x32_bf16 v[64:67], v[48:51], v[144:147], v[64:67]
    ds_read_b64_tr_b16 v[112:113], v228 offset:32768
    v_mfma_f32_16x16x32_bf16 v[64:67], v[52:55], v[152:155], v[64:67]
    ds_read_b64_tr_b16 v[114:115], v228 offset:33792
    s_cmp_lg_u32 s38, 7
    s_cbranch_scc1 K_w7b_118
    s_add_u32 m0, s67, 147456
    s_mov_b32 s58, 1835008
    buffer_load_dwordx4 v226, s[28:31], s58 offen  lds
    s_add_u32 m0, s67, 148480
    s_nop 0
    buffer_load_dwordx4 v227, s[28:31], s58 offen  lds
K_w7b_118:
    s_add_u32 m0, s67, 98304
    s_add_u32 s58, s59, 0
    s_and_b32 s58, s58, 7
    s_lshl_b32 s58, s58, 18
    buffer_load_dwordx4 v226, s[24:27], s58 offen  lds
    v_mfma_f32_16x16x32_bf16 v[80:83], v[52:55], v[156:159], v[80:83]
    ds_read_b64_tr_b16 v[116:117], v228 offset:40960
    v_mfma_f32_16x16x32_bf16 v[80:83], v[48:51], v[148:151], v[80:83]
    ds_read_b64_tr_b16 v[118:119], v228 offset:41984
    v_mfma_f32_16x16x32_bf16 v[84:87], v[56:59], v[148:151], v[84:87]
    ds_read_b64_tr_b16 v[120:121], v229 offset:32768
    v_mfma_f32_16x16x32_bf16 v[84:87], v[60:63], v[156:159], v[84:87]
    ds_read_b64_tr_b16 v[122:123], v229 offset:33792
    s_add_u32 m0, s67, 99328
    s_nop 0
    buffer_load_dwordx4 v227, s[24:27], s58 offen  lds
    v_mfma_f32_16x16x32_bf16 v[68:71], v[60:63], v[152:155], v[68:71]
    ds_read_b64_tr_b16 v[124:125], v229 offset:40960
    v_mfma_f32_16x16x32_bf16 v[68:71], v[56:59], v[144:147], v[68:71]
    ds_read_b64_tr_b16 v[126:127], v229 offset:41984
    s_waitcnt vmcnt(28) lgkmcnt(8)
    s_setprio 2
    v_mfma_f32_16x16x32_bf16 v[72:75], v[96:99], v[144:147], v[72:75]
    ds_read_b64_tr_b16 v[48:49], v230 offset:32768
    v_mfma_f32_16x16x32_bf16 v[72:75], v[100:103], v[152:155], v[72:75]
    ds_read_b64_tr_b16 v[50:51], v230 offset:33792
    s_add_u32 m0, s67, 114688
    s_add_u32 s58, s59, 1
    s_and_b32 s58, s58, 7
    s_lshl_b32 s58, s58, 18
    buffer_load_dwordx4 v226, s[24:27], s58 offen  lds
    v_mfma_f32_16x16x32_bf16 v[88:91], v[100:103], v[156:159], v[88:91]
    ds_read_b64_tr_b16 v[52:53], v230 offset:40960
    v_mfma_f32_16x16x32_bf16 v[88:91], v[96:99], v[148:151], v[88:91]
    ds_read_b64_tr_b16 v[54:55], v230 offset:41984
    v_mfma_f32_16x16x32_bf16 v[92:95], v[104:107], v[148:151], v[92:95]
    ds_read_b64_tr_b16 v[56:57], v231 offset:32768
    v_mfma_f32_16x16x32_bf16 v[92:95], v[108:111], v[156:159], v[92:95]
    ds_read_b64_tr_b16 v[58:59], v231 offset:33792
    s_add_u32 m0, s67, 115712
    s_nop 0
    buffer_load_dwordx4 v227, s[24:27], s58 offen  lds
    v_mfma_f32_16x16x32_bf16 v[76:79], v[108:111], v[152:155], v[76:79]
    ds_read_b64_tr_b16 v[60:61], v231 offset:40960
    v_mfma_f32_16x16x32_bf16 v[76:79], v[104:107], v[144:147], v[76:79]
    ds_read_b64_tr_b16 v[62:63], v231 offset:41984
    s_waitcnt vmcnt(26) lgkmcnt(8)
    s_setprio 1
    s_waitcnt vmcnt(8)
    s_lshl1_add_u32 s40, s45, s44
    s_lshl_b32 s40, s40, 5
    s_add_u32 s40, s40, s37
    s_lshl_b32 s40, s40, 2
    s_add_u32 s40, s40, 17342464
    s_mov_b64 exec, 1
    buffer_store_dword v240, off, s[20:23], s40 sc1
    s_mov_b64 exec, -1
    v_mfma_f32_16x16x32_bf16 v[64:67], v[112:115], v[160:163], v[64:67]
    ds_read_b64_tr_b16 v[96:97], v228 offset:49152
    v_mfma_f32_16x16x32_bf16 v[64:67], v[116:119], v[168:171], v[64:67]
    ds_read_b64_tr_b16 v[98:99], v228 offset:50176
    buffer_load_dwordx4 v[40:43], v242, s[20:23], s57 offen sc1
    v_mfma_f32_16x16x32_bf16 v[80:83], v[116:119], v[172:175], v[80:83]
    ds_read_b64_tr_b16 v[100:101], v228 offset:57344
    v_mfma_f32_16x16x32_bf16 v[80:83], v[112:115], v[164:167], v[80:83]
    ds_read_b64_tr_b16 v[102:103], v228 offset:58368
    v_mfma_f32_16x16x32_bf16 v[84:87], v[120:123], v[164:167], v[84:87]
    ds_read_b64_tr_b16 v[104:105], v229 offset:49152
    v_mfma_f32_16x16x32_bf16 v[84:87], v[124:127], v[172:175], v[84:87]
    ds_read_b64_tr_b16 v[106:107], v229 offset:50176
    buffer_load_dwordx4 v[44:47], v249, s[20:23], s57 offen sc1
    s_add_u32 s57, s57, 4096
    v_mfma_f32_16x16x32_bf16 v[68:71], v[124:127], v[168:171], v[68:71]
    ds_read_b64_tr_b16 v[108:109], v229 offset:57344
    v_mfma_f32_16x16x32_bf16 v[68:71], v[120:123], v[160:163], v[68:71]
    ds_read_b64_tr_b16 v[110:111], v229 offset:58368
    s_waitcnt vmcnt(29) lgkmcnt(8)
    s_setprio 0
    v_mfma_f32_16x16x32_bf16 v[72:75], v[48:51], v[160:163], v[72:75]
    ds_read_b64_tr_b16 v[112:113], v230 offset:49152
    v_mfma_f32_16x16x32_bf16 v[72:75], v[52:55], v[168:171], v[72:75]
    ds_read_b64_tr_b16 v[114:115], v230 offset:50176
    s_add_u32 m0, s67, 0
    s_add_u32 s58, s59, 2
    s_and_b32 s58, s58, 7
    s_lshl_b32 s58, s58, 18
    buffer_load_dwordx4 v226, s[24:27], s58 offen  lds
    v_mfma_f32_16x16x32_bf16 v[88:91], v[52:55], v[172:175], v[88:91]
    ds_read_b64_tr_b16 v[116:117], v230 offset:57344
    v_mfma_f32_16x16x32_bf16 v[88:91], v[48:51], v[164:167], v[88:91]
    ds_read_b64_tr_b16 v[118:119], v230 offset:58368
    v_mfma_f32_16x16x32_bf16 v[92:95], v[56:59], v[164:167], v[92:95]
    ds_read_b64_tr_b16 v[120:121], v231 offset:49152
    v_mfma_f32_16x16x32_bf16 v[92:95], v[60:63], v[172:175], v[92:95]
    ds_read_b64_tr_b16 v[122:123], v231 offset:50176
    s_add_u32 m0, s67, 1024
    s_nop 0
    buffer_load_dwordx4 v227, s[24:27], s58 offen  lds
    v_mfma_f32_16x16x32_bf16 v[76:79], v[60:63], v[168:171], v[76:79]
    ds_read_b64_tr_b16 v[124:125], v231 offset:57344
    v_mfma_f32_16x16x32_bf16 v[76:79], v[56:59], v[160:163], v[76:79]
    ds_read_b64_tr_b16 v[126:127], v231 offset:58368
    s_waitcnt vmcnt(25) lgkmcnt(0)
    s_barrier
    s_setprio 3
    v_mfma_f32_16x16x32_bf16 v[64:67], v[96:99], v[176:179], v[64:67]
    ds_read_b64_tr_b16 v[48:49], v8 offset:0
    v_mfma_f32_16x16x32_bf16 v[64:67], v[100:103], v[184:187], v[64:67]
    ds_read_b64_tr_b16 v[50:51], v8 offset:1024
    s_add_u32 m0, s67, 16384
    s_add_u32 s58, s59, 3
    s_and_b32 s58, s58, 7
    s_lshl_b32 s58, s58, 18
    buffer_load_dwordx4 v226, s[24:27], s58 offen  lds
    v_mfma_f32_16x16x32_bf16 v[80:83], v[100:103], v[188:191], v[80:83]
    ds_read_b64_tr_b16 v[52:53], v8 offset:8192
    v_mfma_f32_16x16x32_bf16 v[80:83], v[96:99], v[180:183], v[80:83]
    ds_read_b64_tr_b16 v[54:55], v8 offset:9216
    v_mfma_f32_16x16x32_bf16 v[84:87], v[104:107], v[180:183], v[84:87]
    ds_read_b64_tr_b16 v[56:57], v9 offset:0
    v_mfma_f32_16x16x32_bf16 v[84:87], v[108:111], v[188:191], v[84:87]
    ds_read_b64_tr_b16 v[58:59], v9 offset:1024
    s_add_u32 m0, s67, 17408
    s_nop 0
    buffer_load_dwordx4 v227, s[24:27], s58 offen  lds
    v_mfma_f32_16x16x32_bf16 v[68:71], v[108:111], v[184:187], v[68:71]
    ds_read_b64_tr_b16 v[60:61], v9 offset:8192
    v_mfma_f32_16x16x32_bf16 v[68:71], v[104:107], v[176:179], v[68:71]
    ds_read_b64_tr_b16 v[62:63], v9 offset:9216
    s_waitcnt vmcnt(27) lgkmcnt(8)
    s_setprio 2
    v_mfma_f32_16x16x32_bf16 v[72:75], v[112:115], v[176:179], v[72:75]
    ds_read_b64_tr_b16 v[96:97], v10 offset:0
    v_mfma_f32_16x16x32_bf16 v[72:75], v[116:119], v[184:187], v[72:75]
    ds_read_b64_tr_b16 v[98:99], v10 offset:1024
    s_add_u32 m0, s67, 32768
    s_add_u32 s58, s59, 4
    s_and_b32 s58, s58, 7
    s_lshl_b32 s58, s58, 18
    buffer_load_dwordx4 v226, s[24:27], s58 offen  lds
    v_mfma_f32_16x16x32_bf16 v[88:91], v[116:119], v[188:191], v[88:91]
    ds_read_b64_tr_b16 v[100:101], v10 offset:8192
    v_mfma_f32_16x16x32_bf16 v[88:91], v[112:115], v[180:183], v[88:91]
    ds_read_b64_tr_b16 v[102:103], v10 offset:9216
    v_mfma_f32_16x16x32_bf16 v[92:95], v[120:123], v[180:183], v[92:95]
    ds_read_b64_tr_b16 v[104:105], v11 offset:0
    v_mfma_f32_16x16x32_bf16 v[92:95], v[124:127], v[188:191], v[92:95]
    ds_read_b64_tr_b16 v[106:107], v11 offset:1024
    s_add_u32 m0, s67, 33792
    s_nop 0
    buffer_load_dwordx4 v227, s[24:27], s58 offen  lds
    v_mfma_f32_16x16x32_bf16 v[76:79], v[124:127], v[184:187], v[76:79]
    ds_read_b64_tr_b16 v[108:109], v11 offset:8192
    v_mfma_f32_16x16x32_bf16 v[76:79], v[120:123], v[176:179], v[76:79]
    ds_read_b64_tr_b16 v[110:111], v11 offset:9216
    s_waitcnt vmcnt(25) lgkmcnt(8)
    s_setprio 1
    v_mfma_f32_16x16x32_bf16 v[64:67], v[48:51], v[192:195], v[64:67]
    ds_read_b64_tr_b16 v[112:113], v8 offset:16384
    v_mfma_f32_16x16x32_bf16 v[64:67], v[52:55], v[200:203], v[64:67]
    ds_read_b64_tr_b16 v[114:115], v8 offset:17408
    s_add_u32 m0, s67, 49152
    s_add_u32 s58, s59, 5
    s_and_b32 s58, s58, 7
    s_lshl_b32 s58, s58, 18
    buffer_load_dwordx4 v226, s[24:27], s58 offen  lds
    v_mfma_f32_16x16x32_bf16 v[80:83], v[52:55], v[204:207], v[80:83]
    ds_read_b64_tr_b16 v[116:117], v8 offset:24576
    v_mfma_f32_16x16x32_bf16 v[80:83], v[48:51], v[196:199], v[80:83]
    ds_read_b64_tr_b16 v[118:119], v8 offset:25600
    v_mfma_f32_16x16x32_bf16 v[84:87], v[56:59], v[196:199], v[84:87]
    ds_read_b64_tr_b16 v[120:121], v9 offset:16384
    v_mfma_f32_16x16x32_bf16 v[84:87], v[60:63], v[204:207], v[84:87]
    ds_read_b64_tr_b16 v[122:123], v9 offset:17408
    s_add_u32 m0, s67, 50176
    s_nop 0
    buffer_load_dwordx4 v227, s[24:27], s58 offen  lds
    v_mfma_f32_16x16x32_bf16 v[68:71], v[60:63], v[200:203], v[68:71]
    ds_read_b64_tr_b16 v[124:125], v9 offset:24576
    v_mfma_f32_16x16x32_bf16 v[68:71], v[56:59], v[192:195], v[68:71]
    ds_read_b64_tr_b16 v[126:127], v9 offset:25600
    s_waitcnt vmcnt(27) lgkmcnt(8)
    s_setprio 0
    s_lshl1_add_u32 s51, s66, s44
    s_lshl_b32 s51, s51, 7
    s_add_u32 s51, s51, 17342464
    buffer_load_dword v251, v243, s[20:23], s51 offen sc1
    s_sub_u32 s52, s57, 131072
    v_mfma_f32_16x16x32_bf16 v[72:75], v[96:99], v[192:195], v[72:75]
    ds_read_b64_tr_b16 v[48:49], v10 offset:16384
    v_mfma_f32_16x16x32_bf16 v[72:75], v[100:103], v[200:203], v[72:75]
    ds_read_b64_tr_b16 v[50:51], v10 offset:17408
    v_mfma_f32_16x16x32_bf16 v[88:91], v[100:103], v[204:207], v[88:91]
    ds_read_b64_tr_b16 v[52:53], v10 offset:24576
    v_mfma_f32_16x16x32_bf16 v[88:91], v[96:99], v[196:199], v[88:91]
    ds_read_b64_tr_b16 v[54:55], v10 offset:25600
    v_mfma_f32_16x16x32_bf16 v[92:95], v[104:107], v[196:199], v[92:95]
    ds_read_b64_tr_b16 v[56:57], v11 offset:16384
    v_mfma_f32_16x16x32_bf16 v[92:95], v[108:111], v[204:207], v[92:95]
    ds_read_b64_tr_b16 v[58:59], v11 offset:17408
    v_mfma_f32_16x16x32_bf16 v[76:79], v[108:111], v[200:203], v[76:79]
    ds_read_b64_tr_b16 v[60:61], v11 offset:24576
    v_mfma_f32_16x16x32_bf16 v[76:79], v[104:107], v[192:195], v[76:79]
    ds_read_b64_tr_b16 v[62:63], v11 offset:25600
    s_waitcnt vmcnt(12) lgkmcnt(0)
    s_barrier
    s_setprio 3
    v_mfma_f32_16x16x32_bf16 v[64:67], v[112:115], v[208:211], v[64:67]
    ds_read_b64_tr_b16 v[96:97], v12 offset:0
    v_mfma_f32_16x16x32_bf16 v[64:67], v[116:119], v[216:219], v[64:67]
    ds_read_b64_tr_b16 v[98:99], v12 offset:1024
    s_add_u32 m0, s67, 65536
    s_add_u32 s58, s59, 6
    s_and_b32 s58, s58, 7
    s_lshl_b32 s58, s58, 18
    buffer_load_dwordx4 v226, s[24:27], s58 offen  lds
    v_mfma_f32_16x16x32_bf16 v[80:83], v[116:119], v[232:235], v[80:83]
    ds_read_b64_tr_b16 v[100:101], v12 offset:8192
    v_mfma_f32_16x16x32_bf16 v[80:83], v[112:115], v[212:215], v[80:83]
    ds_read_b64_tr_b16 v[102:103], v12 offset:9216
    v_mfma_f32_16x16x32_bf16 v[84:87], v[120:123], v[212:215], v[84:87]
    ds_read_b64_tr_b16 v[104:105], v13 offset:0
    v_mfma_f32_16x16x32_bf16 v[84:87], v[124:127], v[232:235], v[84:87]
    ds_read_b64_tr_b16 v[106:107], v13 offset:1024
    s_add_u32 m0, s67, 66560
    s_nop 0
    buffer_load_dwordx4 v227, s[24:27], s58 offen  lds
    v_mfma_f32_16x16x32_bf16 v[68:71], v[124:127], v[216:219], v[68:71]
    ds_read_b64_tr_b16 v[108:109], v13 offset:8192
    v_mfma_f32_16x16x32_bf16 v[68:71], v[120:123], v[208:211], v[68:71]
    ds_read_b64_tr_b16 v[110:111], v13 offset:9216
    s_waitcnt vmcnt(26) lgkmcnt(8)
    s_setprio 3
    s_waitcnt vmcnt(2)
K_op_119:
    v_cmp_ne_u32 vcc, s39, v251
    s_cbranch_vccz K_oo_120
    s_add_u32 s3, s3, 1
    s_cmp_gt_u32 s3, 1048576
    s_cbranch_scc1 K_oo_120
    buffer_load_dword v251, v243, s[20:23], s51 offen sc1
    s_waitcnt vmcnt(0)
    s_branch K_op_119
K_oo_120:
    v_mfma_f32_16x16x32_bf16 v[72:75], v[48:51], v[208:211], v[72:75]
    ds_read_b64_tr_b16 v[112:113], v14 offset:0
    v_mfma_f32_16x16x32_bf16 v[72:75], v[52:55], v[216:219], v[72:75]
    ds_read_b64_tr_b16 v[114:115], v14 offset:1024
    s_add_u32 m0, s67, 81920
    s_add_u32 s58, s59, 7
    s_and_b32 s58, s58, 7
    s_lshl_b32 s58, s58, 18
    buffer_load_dwordx4 v226, s[24:27], s58 offen  lds
    v_mfma_f32_16x16x32_bf16 v[88:91], v[52:55], v[232:235], v[88:91]
    ds_read_b64_tr_b16 v[116:117], v14 offset:8192
    v_mfma_f32_16x16x32_bf16 v[88:91], v[48:51], v[212:215], v[88:91]
    ds_read_b64_tr_b16 v[118:119], v14 offset:9216
    v_mfma_f32_16x16x32_bf16 v[92:95], v[56:59], v[212:215], v[92:95]
    ds_read_b64_tr_b16 v[120:121], v15 offset:0
    v_mfma_f32_16x16x32_bf16 v[92:95], v[60:63], v[232:235], v[92:95]
    ds_read_b64_tr_b16 v[122:123], v15 offset:1024
    s_add_u32 m0, s67, 82944
    s_nop 0
    buffer_load_dwordx4 v227, s[24:27], s58 offen  lds
    v_mfma_f32_16x16x32_bf16 v[76:79], v[60:63], v[216:219], v[76:79]
    ds_read_b64_tr_b16 v[124:125], v15 offset:8192
    v_mfma_f32_16x16x32_bf16 v[76:79], v[56:59], v[208:211], v[76:79]
    ds_read_b64_tr_b16 v[126:127], v15 offset:9216
    s_waitcnt vmcnt(22) lgkmcnt(8)
    s_setprio 3
    v_mfma_f32_16x16x32_bf16 v[64:67], v[96:99], v[236:239], v[64:67]
    ds_read_b64_tr_b16 v[48:49], v12 offset:16384
    v_mfma_f32_16x16x32_bf16 v[64:67], v[100:103], v[24:27], v[64:67]
    ds_read_b64_tr_b16 v[50:51], v12 offset:17408
    s_add_u32 s57, s59, 0
    s_and_b32 s57, s57, 7
    s_lshl_b32 s57, s57, 13
    s_add_u32 s57, s57, s52
    buffer_load_dwordx4 v[128:131], v242, s[20:23], s57 offen sc1
    v_mfma_f32_16x16x32_bf16 v[80:83], v[100:103], v[28:31], v[80:83]
    ds_read_b64_tr_b16 v[52:53], v12 offset:24576
    v_mfma_f32_16x16x32_bf16 v[80:83], v[96:99], v[244:247], v[80:83]
    ds_read_b64_tr_b16 v[54:55], v12 offset:25600
    v_mfma_f32_16x16x32_bf16 v[84:87], v[104:107], v[244:247], v[84:87]
    ds_read_b64_tr_b16 v[56:57], v13 offset:16384
    v_mfma_f32_16x16x32_bf16 v[84:87], v[108:111], v[28:31], v[84:87]
    ds_read_b64_tr_b16 v[58:59], v13 offset:17408
    buffer_load_dwordx4 v[132:135], v249, s[20:23], s57 offen sc1
    s_add_u32 s57, s57, 4096
    v_mfma_f32_16x16x32_bf16 v[68:71], v[108:111], v[24:27], v[68:71]
    ds_read_b64_tr_b16 v[60:61], v13 offset:24576
    v_mfma_f32_16x16x32_bf16 v[68:71], v[104:107], v[236:239], v[68:71]
    ds_read_b64_tr_b16 v[62:63], v13 offset:25600
    s_waitcnt vmcnt(24) lgkmcnt(8)
    s_setprio 2
    v_mfma_f32_16x16x32_bf16 v[72:75], v[112:115], v[236:239], v[72:75]
    ds_read_b64_tr_b16 v[96:97], v14 offset:16384
    v_mfma_f32_16x16x32_bf16 v[72:75], v[116:119], v[24:27], v[72:75]
    ds_read_b64_tr_b16 v[98:99], v14 offset:17408
    buffer_load_dwordx4 v[136:139], v242, s[20:23], s57 offen sc1
    v_mfma_f32_16x16x32_bf16 v[88:91], v[116:119], v[28:31], v[88:91]
    ds_read_b64_tr_b16 v[100:101], v14 offset:24576
    v_mfma_f32_16x16x32_bf16 v[88:91], v[112:115], v[244:247], v[88:91]
    ds_read_b64_tr_b16 v[102:103], v14 offset:25600
    v_mfma_f32_16x16x32_bf16 v[92:95], v[120:123], v[244:247], v[92:95]
    ds_read_b64_tr_b16 v[104:105], v15 offset:16384
    v_mfma_f32_16x16x32_bf16 v[92:95], v[124:127], v[28:31], v[92:95]
    ds_read_b64_tr_b16 v[106:107], v15 offset:17408
    buffer_load_dwordx4 v[140:143], v249, s[20:23], s57 offen sc1
    s_add_u32 s57, s57, 4096
    v_mfma_f32_16x16x32_bf16 v[76:79], v[124:127], v[24:27], v[76:79]
    ds_read_b64_tr_b16 v[108:109], v15 offset:24576
    v_mfma_f32_16x16x32_bf16 v[76:79], v[120:123], v[236:239], v[76:79]
    ds_read_b64_tr_b16 v[110:111], v15 offset:25600
    s_waitcnt vmcnt(17) lgkmcnt(8)
    s_setprio 1
    v_mfma_f32_16x16x32_bf16 v[64:67], v[48:51], v[32:35], v[64:67]
    ds_read_b64_tr_b16 v[112:113], v8 offset:32768
    v_mfma_f32_16x16x32_bf16 v[64:67], v[52:55], v[40:43], v[64:67]
    ds_read_b64_tr_b16 v[114:115], v8 offset:33792
    s_add_u32 s57, s59, 1
    s_and_b32 s57, s57, 7
    s_lshl_b32 s57, s57, 13
    s_add_u32 s57, s57, s52
    buffer_load_dwordx4 v[144:147], v242, s[20:23], s57 offen sc1
    v_mfma_f32_16x16x32_bf16 v[80:83], v[52:55], v[44:47], v[80:83]
    ds_read_b64_tr_b16 v[116:117], v8 offset:40960
    v_mfma_f32_16x16x32_bf16 v[80:83], v[48:51], v[36:39], v[80:83]
    ds_read_b64_tr_b16 v[118:119], v8 offset:41984
    v_mfma_f32_16x16x32_bf16 v[84:87], v[56:59], v[36:39], v[84:87]
    ds_read_b64_tr_b16 v[120:121], v9 offset:32768
    v_mfma_f32_16x16x32_bf16 v[84:87], v[60:63], v[44:47], v[84:87]
    ds_read_b64_tr_b16 v[122:123], v9 offset:33792
    buffer_load_dwordx4 v[148:151], v249, s[20:23], s57 offen sc1
    s_add_u32 s57, s57, 4096
    v_mfma_f32_16x16x32_bf16 v[68:71], v[60:63], v[40:43], v[68:71]
    ds_read_b64_tr_b16 v[124:125], v9 offset:40960
    v_mfma_f32_16x16x32_bf16 v[68:71], v[56:59], v[32:35], v[68:71]
    ds_read_b64_tr_b16 v[126:127], v9 offset:41984
    s_waitcnt vmcnt(19) lgkmcnt(8)
    s_setprio 0
    v_mfma_f32_16x16x32_bf16 v[72:75], v[96:99], v[32:35], v[72:75]
    ds_read_b64_tr_b16 v[48:49], v10 offset:32768
    v_mfma_f32_16x16x32_bf16 v[72:75], v[100:103], v[40:43], v[72:75]
    ds_read_b64_tr_b16 v[50:51], v10 offset:33792
    buffer_load_dwordx4 v[152:155], v242, s[20:23], s57 offen sc1
    v_mfma_f32_16x16x32_bf16 v[88:91], v[100:103], v[44:47], v[88:91]
    ds_read_b64_tr_b16 v[52:53], v10 offset:40960
    v_mfma_f32_16x16x32_bf16 v[88:91], v[96:99], v[36:39], v[88:91]
    ds_read_b64_tr_b16 v[54:55], v10 offset:41984
    v_mfma_f32_16x16x32_bf16 v[92:95], v[104:107], v[36:39], v[92:95]
    ds_read_b64_tr_b16 v[56:57], v11 offset:32768
    v_mfma_f32_16x16x32_bf16 v[92:95], v[108:111], v[44:47], v[92:95]
    ds_read_b64_tr_b16 v[58:59], v11 offset:33792
    buffer_load_dwordx4 v[156:159], v249, s[20:23], s57 offen sc1
    s_add_u32 s57, s57, 4096
    v_mfma_f32_16x16x32_bf16 v[76:79], v[108:111], v[40:43], v[76:79]
    ds_read_b64_tr_b16 v[60:61], v11 offset:40960
    v_mfma_f32_16x16x32_bf16 v[76:79], v[104:107], v[32:35], v[76:79]
    ds_read_b64_tr_b16 v[62:63], v11 offset:41984
    s_waitcnt vmcnt(4) lgkmcnt(0)
    s_barrier
    s_setprio 3
    v_mfma_f32_16x16x32_bf16 v[64:67], v[112:115], v[128:131], v[64:67]
    ds_read_b64_tr_b16 v[96:97], v8 offset:49152
    v_mfma_f32_16x16x32_bf16 v[64:67], v[116:119], v[136:139], v[64:67]
    ds_read_b64_tr_b16 v[98:99], v8 offset:50176
    s_add_u32 s57, s59, 2
    s_and_b32 s57, s57, 7
    s_lshl_b32 s57, s57, 13
    s_add_u32 s57, s57, s52
    buffer_load_dwordx4 v[160:163], v242, s[20:23], s57 offen sc1
    v_mfma_f32_16x16x32_bf16 v[80:83], v[116:119], v[140:143], v[80:83]
    ds_read_b64_tr_b16 v[100:101], v8 offset:57344
    v_mfma_f32_16x16x32_bf16 v[80:83], v[112:115], v[132:135], v[80:83]
    ds_read_b64_tr_b16 v[102:103], v8 offset:58368
    v_mfma_f32_16x16x32_bf16 v[84:87], v[120:123], v[132:135], v[84:87]
    ds_read_b64_tr_b16 v[104:105], v9 offset:49152
    v_mfma_f32_16x16x32_bf16 v[84:87], v[124:127], v[140:143], v[84:87]
    ds_read_b64_tr_b16 v[106:107], v9 offset:50176
    buffer_load_dwordx4 v[164:167], v249, s[20:23], s57 offen sc1
    s_add_u32 s57, s57, 4096
    v_mfma_f32_16x16x32_bf16 v[68:71], v[124:127], v[136:139], v[68:71]
    ds_read_b64_tr_b16 v[108:109], v9 offset:57344
    v_mfma_f32_16x16x32_bf16 v[68:71], v[120:123], v[128:131], v[68:71]
    ds_read_b64_tr_b16 v[110:111], v9 offset:58368
    s_waitcnt vmcnt(6) lgkmcnt(8)
    s_setprio 3
    v_mfma_f32_16x16x32_bf16 v[72:75], v[48:51], v[128:131], v[72:75]
    ds_read_b64_tr_b16 v[112:113], v10 offset:49152
    v_mfma_f32_16x16x32_bf16 v[72:75], v[52:55], v[136:139], v[72:75]
    ds_read_b64_tr_b16 v[114:115], v10 offset:50176
    buffer_load_dwordx4 v[168:171], v242, s[20:23], s57 offen sc1
    v_mfma_f32_16x16x32_bf16 v[88:91], v[52:55], v[140:143], v[88:91]
    ds_read_b64_tr_b16 v[116:117], v10 offset:57344
    v_mfma_f32_16x16x32_bf16 v[88:91], v[48:51], v[132:135], v[88:91]
    ds_read_b64_tr_b16 v[118:119], v10 offset:58368
    v_mfma_f32_16x16x32_bf16 v[92:95], v[56:59], v[132:135], v[92:95]
    ds_read_b64_tr_b16 v[120:121], v11 offset:49152
    v_mfma_f32_16x16x32_bf16 v[92:95], v[60:63], v[140:143], v[92:95]
    ds_read_b64_tr_b16 v[122:123], v11 offset:50176
    buffer_load_dwordx4 v[172:175], v249, s[20:23], s57 offen sc1
    s_add_u32 s57, s57, 4096
    v_mfma_f32_16x16x32_bf16 v[76:79], v[60:63], v[136:139], v[76:79]
    ds_read_b64_tr_b16 v[124:125], v11 offset:57344
    v_mfma_f32_16x16x32_bf16 v[76:79], v[56:59], v[128:131], v[76:79]
    ds_read_b64_tr_b16 v[126:127], v11 offset:58368
    s_waitcnt vmcnt(4) lgkmcnt(8)
    s_setprio 3
    v_mfma_f32_16x16x32_bf16 v[64:67], v[96:99], v[144:147], v[64:67]
    ds_read_b64_tr_b16 v[48:49], v228 offset:0
    v_mfma_f32_16x16x32_bf16 v[64:67], v[100:103], v[152:155], v[64:67]
    ds_read_b64_tr_b16 v[50:51], v228 offset:1024
    s_add_u32 s57, s59, 3
    s_and_b32 s57, s57, 7
    s_lshl_b32 s57, s57, 13
    s_add_u32 s57, s57, s52
    buffer_load_dwordx4 v[176:179], v242, s[20:23], s57 offen sc1
    v_mfma_f32_16x16x32_bf16 v[80:83], v[100:103], v[156:159], v[80:83]
    ds_read_b64_tr_b16 v[52:53], v228 offset:8192
    v_mfma_f32_16x16x32_bf16 v[80:83], v[96:99], v[148:151], v[80:83]
    ds_read_b64_tr_b16 v[54:55], v228 offset:9216
    v_mfma_f32_16x16x32_bf16 v[84:87], v[104:107], v[148:151], v[84:87]
    ds_read_b64_tr_b16 v[56:57], v229 offset:0
    v_mfma_f32_16x16x32_bf16 v[84:87], v[108:111], v[156:159], v[84:87]
    ds_read_b64_tr_b16 v[58:59], v229 offset:1024
    buffer_load_dwordx4 v[180:183], v249, s[20:23], s57 offen sc1
    s_add_u32 s57, s57, 4096
    v_mfma_f32_16x16x32_bf16 v[68:71], v[108:111], v[152:155], v[68:71]
    ds_read_b64_tr_b16 v[60:61], v229 offset:8192
    v_mfma_f32_16x16x32_bf16 v[68:71], v[104:107], v[144:147], v[68:71]
    ds_read_b64_tr_b16 v[62:63], v229 offset:9216
    s_waitcnt vmcnt(6) lgkmcnt(8)
    s_setprio 3
    v_mfma_f32_16x16x32_bf16 v[72:75], v[112:115], v[144:147], v[72:75]
    ds_read_b64_tr_b16 v[96:97], v230 offset:0
    v_mfma_f32_16x16x32_bf16 v[72:75], v[116:119], v[152:155], v[72:75]
    ds_read_b64_tr_b16 v[98:99], v230 offset:1024
    buffer_load_dwordx4 v[184:187], v242, s[20:23], s57 offen sc1
    v_mfma_f32_16x16x32_bf16 v[88:91], v[116:119], v[156:159], v[88:91]
    ds_read_b64_tr_b16 v[100:101], v230 offset:8192
    v_mfma_f32_16x16x32_bf16 v[88:91], v[112:115], v[148:151], v[88:91]
    ds_read_b64_tr_b16 v[102:103], v230 offset:9216
    v_mfma_f32_16x16x32_bf16 v[92:95], v[120:123], v[148:151], v[92:95]
    ds_read_b64_tr_b16 v[104:105], v231 offset:0
    v_mfma_f32_16x16x32_bf16 v[92:95], v[124:127], v[156:159], v[92:95]
    ds_read_b64_tr_b16 v[106:107], v231 offset:1024
    buffer_load_dwordx4 v[188:191], v249, s[20:23], s57 offen sc1
    s_add_u32 s57, s57, 4096
    v_mfma_f32_16x16x32_bf16 v[76:79], v[124:127], v[152:155], v[76:79]
    ds_read_b64_tr_b16 v[108:109], v231 offset:8192
    v_mfma_f32_16x16x32_bf16 v[76:79], v[120:123], v[144:147], v[76:79]
    ds_read_b64_tr_b16 v[110:111], v231 offset:9216
    s_waitcnt vmcnt(4) lgkmcnt(8)
    s_setprio 3
    v_mfma_f32_16x16x32_bf16 v[64:67], v[48:51], v[160:163], v[64:67]
    ds_read_b64_tr_b16 v[112:113], v228 offset:16384
    v_mfma_f32_16x16x32_bf16 v[64:67], v[52:55], v[168:171], v[64:67]
    ds_read_b64_tr_b16 v[114:115], v228 offset:17408
    s_add_u32 s57, s59, 4
    s_and_b32 s57, s57, 7
    s_lshl_b32 s57, s57, 13
    s_add_u32 s57, s57, s52
    buffer_load_dwordx4 v[192:195], v242, s[20:23], s57 offen sc1
    v_mfma_f32_16x16x32_bf16 v[80:83], v[52:55], v[172:175], v[80:83]
    ds_read_b64_tr_b16 v[116:117], v228 offset:24576
    v_mfma_f32_16x16x32_bf16 v[80:83], v[48:51], v[164:167], v[80:83]
    ds_read_b64_tr_b16 v[118:119], v228 offset:25600
    v_mfma_f32_16x16x32_bf16 v[84:87], v[56:59], v[164:167], v[84:87]
    ds_read_b64_tr_b16 v[120:121], v229 offset:16384
    v_mfma_f32_16x16x32_bf16 v[84:87], v[60:63], v[172:175], v[84:87]
    ds_read_b64_tr_b16 v[122:123], v229 offset:17408
    buffer_load_dwordx4 v[196:199], v249, s[20:23], s57 offen sc1
    s_add_u32 s57, s57, 4096
    v_mfma_f32_16x16x32_bf16 v[68:71], v[60:63], v[168:171], v[68:71]
    ds_read_b64_tr_b16 v[124:125], v229 offset:24576
    v_mfma_f32_16x16x32_bf16 v[68:71], v[56:59], v[160:163], v[68:71]
    ds_read_b64_tr_b16 v[126:127], v229 offset:25600
    s_waitcnt vmcnt(6) lgkmcnt(8)
    s_setprio 3
    v_mfma_f32_16x16x32_bf16 v[72:75], v[96:99], v[160:163], v[72:75]
    ds_read_b64_tr_b16 v[48:49], v230 offset:16384
    v_mfma_f32_16x16x32_bf16 v[72:75], v[100:103], v[168:171], v[72:75]
    ds_read_b64_tr_b16 v[50:51], v230 offset:17408
    buffer_load_dwordx4 v[200:203], v242, s[20:23], s57 offen sc1
    v_mfma_f32_16x16x32_bf16 v[88:91], v[100:103], v[172:175], v[88:91]
    ds_read_b64_tr_b16 v[52:53], v230 offset:24576
    v_mfma_f32_16x16x32_bf16 v[88:91], v[96:99], v[164:167], v[88:91]
    ds_read_b64_tr_b16 v[54:55], v230 offset:25600
    v_mfma_f32_16x16x32_bf16 v[92:95], v[104:107], v[164:167], v[92:95]
    ds_read_b64_tr_b16 v[56:57], v231 offset:16384
    v_mfma_f32_16x16x32_bf16 v[92:95], v[108:111], v[172:175], v[92:95]
    ds_read_b64_tr_b16 v[58:59], v231 offset:17408
    buffer_load_dwordx4 v[204:207], v249, s[20:23], s57 offen sc1
    s_add_u32 s57, s57, 4096
    v_mfma_f32_16x16x32_bf16 v[76:79], v[108:111], v[168:171], v[76:79]
    ds_read_b64_tr_b16 v[60:61], v231 offset:24576
    v_mfma_f32_16x16x32_bf16 v[76:79], v[104:107], v[160:163], v[76:79]
    ds_read_b64_tr_b16 v[62:63], v231 offset:25600
    s_waitcnt vmcnt(4) lgkmcnt(8)
    s_setprio 3
    v_mfma_f32_16x16x32_bf16 v[64:67], v[112:115], v[176:179], v[64:67]
    ds_read_b64_tr_b16 v[96:97], v228 offset:32768
    v_mfma_f32_16x16x32_bf16 v[64:67], v[116:119], v[184:187], v[64:67]
    ds_read_b64_tr_b16 v[98:99], v228 offset:33792
    s_add_u32 s57, s59, 5
    s_and_b32 s57, s57, 7
    s_lshl_b32 s57, s57, 13
    s_add_u32 s57, s57, s52
    buffer_load_dwordx4 v[208:211], v242, s[20:23], s57 offen sc1
    v_mfma_f32_16x16x32_bf16 v[80:83], v[116:119], v[188:191], v[80:83]
    ds_read_b64_tr_b16 v[100:101], v228 offset:40960
    v_mfma_f32_16x16x32_bf16 v[80:83], v[112:115], v[180:183], v[80:83]
    ds_read_b64_tr_b16 v[102:103], v228 offset:41984
    v_mfma_f32_16x16x32_bf16 v[84:87], v[120:123], v[180:183], v[84:87]
    ds_read_b64_tr_b16 v[104:105], v229 offset:32768
    v_mfma_f32_16x16x32_bf16 v[84:87], v[124:127], v[188:191], v[84:87]
    ds_read_b64_tr_b16 v[106:107], v229 offset:33792
    buffer_load_dwordx4 v[212:215], v249, s[20:23], s57 offen sc1
    s_add_u32 s57, s57, 4096
    v_mfma_f32_16x16x32_bf16 v[68:71], v[124:127], v[184:187], v[68:71]
    ds_read_b64_tr_b16 v[108:109], v229 offset:40960
    v_mfma_f32_16x16x32_bf16 v[68:71], v[120:123], v[176:179], v[68:71]
    ds_read_b64_tr_b16 v[110:111], v229 offset:41984
    s_waitcnt vmcnt(6) lgkmcnt(8)
    s_setprio 3
    v_mfma_f32_16x16x32_bf16 v[72:75], v[48:51], v[176:179], v[72:75]
    ds_read_b64_tr_b16 v[112:113], v230 offset:32768
    v_mfma_f32_16x16x32_bf16 v[72:75], v[52:55], v[184:187], v[72:75]
    ds_read_b64_tr_b16 v[114:115], v230 offset:33792
    buffer_load_dwordx4 v[216:219], v242, s[20:23], s57 offen sc1
    v_mfma_f32_16x16x32_bf16 v[88:91], v[52:55], v[188:191], v[88:91]
    ds_read_b64_tr_b16 v[116:117], v230 offset:40960
    v_mfma_f32_16x16x32_bf16 v[88:91], v[48:51], v[180:183], v[88:91]
    ds_read_b64_tr_b16 v[118:119], v230 offset:41984
    v_mfma_f32_16x16x32_bf16 v[92:95], v[56:59], v[180:183], v[92:95]
    ds_read_b64_tr_b16 v[120:121], v231 offset:32768
    v_mfma_f32_16x16x32_bf16 v[92:95], v[60:63], v[188:191], v[92:95]
    ds_read_b64_tr_b16 v[122:123], v231 offset:33792
    buffer_load_dwordx4 v[232:235], v249, s[20:23], s57 offen sc1
    s_add_u32 s57, s57, 4096
    v_mfma_f32_16x16x32_bf16 v[76:79], v[60:63], v[184:187], v[76:79]
    ds_read_b64_tr_b16 v[124:125], v231 offset:40960
    v_mfma_f32_16x16x32_bf16 v[76:79], v[56:59], v[176:179], v[76:79]
    ds_read_b64_tr_b16 v[126:127], v231 offset:41984
    s_waitcnt vmcnt(4) lgkmcnt(8)
    s_setprio 3
    v_mfma_f32_16x16x32_bf16 v[64:67], v[96:99], v[192:195], v[64:67]
    ds_read_b64_tr_b16 v[48:49], v228 offset:49152
    v_mfma_f32_16x16x32_bf16 v[64:67], v[100:103], v[200:203], v[64:67]
    ds_read_b64_tr_b16 v[50:51], v228 offset:50176
    s_add_u32 s57, s59, 6
    s_and_b32 s57, s57, 7
    s_lshl_b32 s57, s57, 13
    s_add_u32 s57, s57, s52
    buffer_load_dwordx4 v[236:239], v242, s[20:23], s57 offen sc1
    v_mfma_f32_16x16x32_bf16 v[80:83], v[100:103], v[204:207], v[80:83]
    ds_read_b64_tr_b16 v[52:53], v228 offset:57344
    v_mfma_f32_16x16x32_bf16 v[80:83], v[96:99], v[196:199], v[80:83]
    ds_read_b64_tr_b16 v[54:55], v228 offset:58368
    v_mfma_f32_16x16x32_bf16 v[84:87], v[104:107], v[196:199], v[84:87]
    ds_read_b64_tr_b16 v[56:57], v229 offset:49152
    v_mfma_f32_16x16x32_bf16 v[84:87], v[108:111], v[204:207], v[84:87]
    ds_read_b64_tr_b16 v[58:59], v229 offset:50176
    buffer_load_dwordx4 v[244:247], v249, s[20:23], s57 offen sc1
    s_add_u32 s57, s57, 4096
    v_mfma_f32_16x16x32_bf16 v[68:71], v[108:111], v[200:203], v[68:71]
    ds_read_b64_tr_b16 v[60:61], v229 offset:57344
    v_mfma_f32_16x16x32_bf16 v[68:71], v[104:107], v[192:195], v[68:71]
    ds_read_b64_tr_b16 v[62:63], v229 offset:58368
    s_waitcnt vmcnt(6) lgkmcnt(8)
    s_setprio 3
    v_mfma_f32_16x16x32_bf16 v[72:75], v[112:115], v[192:195], v[72:75]
    ds_read_b64_tr_b16 v[96:97], v230 offset:49152
    v_mfma_f32_16x16x32_bf16 v[72:75], v[116:119], v[200:203], v[72:75]
    ds_read_b64_tr_b16 v[98:99], v230 offset:50176
    buffer_load_dwordx4 v[24:27], v242, s[20:23], s57 offen sc1
    v_mfma_f32_16x16x32_bf16 v[88:91], v[116:119], v[204:207], v[88:91]
    ds_read_b64_tr_b16 v[100:101], v230 offset:57344
    v_mfma_f32_16x16x32_bf16 v[88:91], v[112:115], v[196:199], v[88:91]
    ds_read_b64_tr_b16 v[102:103], v230 offset:58368
    v_mfma_f32_16x16x32_bf16 v[92:95], v[120:123], v[196:199], v[92:95]
    ds_read_b64_tr_b16 v[104:105], v231 offset:49152
    v_mfma_f32_16x16x32_bf16 v[92:95], v[124:127], v[204:207], v[92:95]
    ds_read_b64_tr_b16 v[106:107], v231 offset:50176
    buffer_load_dwordx4 v[28:31], v249, s[20:23], s57 offen sc1
    s_add_u32 s57, s57, 4096
    v_mfma_f32_16x16x32_bf16 v[76:79], v[124:127], v[200:203], v[76:79]
    ds_read_b64_tr_b16 v[108:109], v231 offset:57344
    v_mfma_f32_16x16x32_bf16 v[76:79], v[120:123], v[192:195], v[76:79]
    ds_read_b64_tr_b16 v[110:111], v231 offset:58368
    s_waitcnt vmcnt(4) lgkmcnt(8)
    s_setprio 3
    v_mfma_f32_16x16x32_bf16 v[64:67], v[48:51], v[208:211], v[64:67]
    ds_read_b64_tr_b16 v[112:113], v8 offset:0
    v_mfma_f32_16x16x32_bf16 v[64:67], v[52:55], v[216:219], v[64:67]
    ds_read_b64_tr_b16 v[114:115], v8 offset:1024
    s_add_u32 s57, s59, 7
    s_and_b32 s57, s57, 7
    s_lshl_b32 s57, s57, 13
    s_add_u32 s57, s57, s52
    buffer_load_dwordx4 v[32:35], v242, s[20:23], s57 offen sc1
    v_mfma_f32_16x16x32_bf16 v[80:83], v[52:55], v[232:235], v[80:83]
    ds_read_b64_tr_b16 v[116:117], v8 offset:8192
    v_mfma_f32_16x16x32_bf16 v[80:83], v[48:51], v[212:215], v[80:83]
    ds_read_b64_tr_b16 v[118:119], v8 offset:9216
    v_mfma_f32_16x16x32_bf16 v[84:87], v[56:59], v[212:215], v[84:87]
    ds_read_b64_tr_b16 v[120:121], v9 offset:0
    v_mfma_f32_16x16x32_bf16 v[84:87], v[60:63], v[232:235], v[84:87]
    ds_read_b64_tr_b16 v[122:123], v9 offset:1024
    buffer_load_dwordx4 v[36:39], v249, s[20:23], s57 offen sc1
    s_add_u32 s57, s57, 4096
    v_mfma_f32_16x16x32_bf16 v[68:71], v[60:63], v[216:219], v[68:71]
    ds_read_b64_tr_b16 v[124:125], v9 offset:8192
    v_mfma_f32_16x16x32_bf16 v[68:71], v[56:59], v[208:211], v[68:71]
    ds_read_b64_tr_b16 v[126:127], v9 offset:9216
    s_waitcnt vmcnt(6) lgkmcnt(8)
    s_setprio 3
    v_mfma_f32_16x16x32_bf16 v[72:75], v[96:99], v[208:211], v[72:75]
    ds_read_b64_tr_b16 v[48:49], v10 offset:0
    v_mfma_f32_16x16x32_bf16 v[72:75], v[100:103], v[216:219], v[72:75]
    ds_read_b64_tr_b16 v[50:51], v10 offset:1024
    buffer_load_dwordx4 v[40:43], v242, s[20:23], s57 offen sc1
    v_mfma_f32_16x16x32_bf16 v[88:91], v[100:103], v[232:235], v[88:91]
    ds_read_b64_tr_b16 v[52:53], v10 offset:8192
    v_mfma_f32_16x16x32_bf16 v[88:91], v[96:99], v[212:215], v[88:91]
    ds_read_b64_tr_b16 v[54:55], v10 offset:9216
    v_mfma_f32_16x16x32_bf16 v[92:95], v[104:107], v[212:215], v[92:95]
    ds_read_b64_tr_b16 v[56:57], v11 offset:0
    v_mfma_f32_16x16x32_bf16 v[92:95], v[108:111], v[232:235], v[92:95]
    ds_read_b64_tr_b16 v[58:59], v11 offset:1024
    buffer_load_dwordx4 v[44:47], v249, s[20:23], s57 offen sc1
    s_add_u32 s57, s57, 4096
    v_mfma_f32_16x16x32_bf16 v[76:79], v[108:111], v[216:219], v[76:79]
    ds_read_b64_tr_b16 v[60:61], v11 offset:8192
    v_mfma_f32_16x16x32_bf16 v[76:79], v[104:107], v[208:211], v[76:79]
    ds_read_b64_tr_b16 v[62:63], v11 offset:9216
    s_waitcnt vmcnt(4) lgkmcnt(8)
    s_setprio 3
    v_mfma_f32_16x16x32_bf16 v[64:67], v[112:115], v[236:239], v[64:67]
    ds_read_b64_tr_b16 v[96:97], v8 offset:16384
    v_mfma_f32_16x16x32_bf16 v[64:67], v[116:119], v[24:27], v[64:67]
    ds_read_b64_tr_b16 v[98:99], v8 offset:17408
    v_mfma_f32_16x16x32_bf16 v[80:83], v[116:119], v[28:31], v[80:83]
    ds_read_b64_tr_b16 v[100:101], v8 offset:24576
    v_mfma_f32_16x16x32_bf16 v[80:83], v[112:115], v[244:247], v[80:83]
    ds_read_b64_tr_b16 v[102:103], v8 offset:25600
    v_mfma_f32_16x16x32_bf16 v[84:87], v[120:123], v[244:247], v[84:87]
    ds_read_b64_tr_b16 v[104:105], v9 offset:16384
    v_mfma_f32_16x16x32_bf16 v[84:87], v[124:127], v[28:31], v[84:87]
    ds_read_b64_tr_b16 v[106:107], v9 offset:17408
    v_mfma_f32_16x16x32_bf16 v[68:71], v[124:127], v[24:27], v[68:71]
    ds_read_b64_tr_b16 v[108:109], v9 offset:24576
    v_mfma_f32_16x16x32_bf16 v[68:71], v[120:123], v[236:239], v[68:71]
    ds_read_b64_tr_b16 v[110:111], v9 offset:25600
    s_waitcnt vmcnt(4) lgkmcnt(8)
    s_setprio 2
    v_mfma_f32_16x16x32_bf16 v[72:75], v[48:51], v[236:239], v[72:75]
    ds_read_b64_tr_b16 v[112:113], v10 offset:16384
    v_mfma_f32_16x16x32_bf16 v[72:75], v[52:55], v[24:27], v[72:75]
    ds_read_b64_tr_b16 v[114:115], v10 offset:17408
    v_mfma_f32_16x16x32_bf16 v[88:91], v[52:55], v[28:31], v[88:91]
    ds_read_b64_tr_b16 v[116:117], v10 offset:24576
    v_mfma_f32_16x16x32_bf16 v[88:91], v[48:51], v[244:247], v[88:91]
    ds_read_b64_tr_b16 v[118:119], v10 offset:25600
    v_mfma_f32_16x16x32_bf16 v[92:95], v[56:59], v[244:247], v[92:95]
    ds_read_b64_tr_b16 v[120:121], v11 offset:16384
    v_mfma_f32_16x16x32_bf16 v[92:95], v[60:63], v[28:31], v[92:95]
    ds_read_b64_tr_b16 v[122:123], v11 offset:17408
    v_mfma_f32_16x16x32_bf16 v[76:79], v[60:63], v[24:27], v[76:79]
    ds_read_b64_tr_b16 v[124:125], v11 offset:24576
    v_mfma_f32_16x16x32_bf16 v[76:79], v[56:59], v[236:239], v[76:79]
    ds_read_b64_tr_b16 v[126:127], v11 offset:25600
    s_waitcnt vmcnt(0) lgkmcnt(8)
    s_setprio 1
    v_mfma_f32_16x16x32_bf16 v[80:83], v[96:99], v[36:39], v[80:83]
    v_add_u32 v5, 131072, v250
    v_mfma_f32_16x16x32_bf16 v[80:83], v[100:103], v[44:47], v[80:83]
    v_xor_b32 v6, 0x4000, v5
    v_mfma_f32_16x16x32_bf16 v[84:87], v[108:111], v[44:47], v[84:87]
    v_and_b32 v7, 1, v3
    v_mfma_f32_16x16x32_bf16 v[84:87], v[104:107], v[36:39], v[84:87]
    v_lshlrev_b32 v7, 5, v7
    s_waitcnt vmcnt(0) lgkmcnt(0)
    v_mfma_f32_16x16x32_bf16 v[88:91], v[112:115], v[36:39], v[88:91]
    v_lshl_add_u32 v7, v2, 11, v7
    v_mfma_f32_16x16x32_bf16 v[88:91], v[116:119], v[44:47], v[88:91]
    v_lshrrev_b32 v251, 1, v3
    v_mfma_f32_16x16x32_bf16 v[92:95], v[124:127], v[44:47], v[92:95]
    v_lshl_add_u32 v7, v251, 4, v7
    v_mfma_f32_16x16x32_bf16 v[92:95], v[120:123], v[36:39], v[92:95]
    s_lshl1_add_u32 s41, s66, s44
    v_mfma_f32_16x16x32_bf16 v[64:67], v[96:99], v[32:35], v[64:67]
    s_lshl_b32 s41, s41, 15
    v_mfma_f32_16x16x32_bf16 v[64:67], v[100:103], v[40:43], v[64:67]
    s_lshl_b32 s42, s65, 7
    v_mfma_f32_16x16x32_bf16 v[68:71], v[108:111], v[40:43], v[68:71]
    s_add_u32 s41, s41, s42
    v_mfma_f32_16x16x32_bf16 v[68:71], v[104:107], v[32:35], v[68:71]
    s_nop 0
    ds_write_b128 v5, v[80:83] offset:0
    v_mfma_f32_16x16x32_bf16 v[72:75], v[112:115], v[32:35], v[72:75]
    ds_write_b128 v5, v[84:87] offset:1024
    v_mfma_f32_16x16x32_bf16 v[72:75], v[116:119], v[40:43], v[72:75]
    ds_write_b128 v5, v[88:91] offset:2048
    v_mfma_f32_16x16x32_bf16 v[76:79], v[124:127], v[40:43], v[76:79]
    ds_write_b128 v5, v[92:95] offset:3072
    v_mfma_f32_16x16x32_bf16 v[76:79], v[120:123], v[32:35], v[76:79]
    s_waitcnt lgkmcnt(0)
    s_barrier
    ds_read_b128 v[96:99], v6 offset:0
    ds_read_b128 v[100:103], v6 offset:1024
    ds_read_b128 v[104:107], v6 offset:2048
    ds_read_b128 v[108:111], v6 offset:3072
    s_waitcnt lgkmcnt(3)
    v_pk_add_f32 v[96:97], v[96:97], v[64:65]
    v_pk_add_f32 v[98:99], v[98:99], v[66:67]
    s_waitcnt lgkmcnt(2)
    v_pk_add_f32 v[100:101], v[100:101], v[68:69]
    v_pk_add_f32 v[102:103], v[102:103], v[70:71]
    s_waitcnt lgkmcnt(1)
    v_pk_add_f32 v[104:105], v[104:105], v[72:73]
    v_pk_add_f32 v[106:107], v[106:107], v[74:75]
    s_waitcnt lgkmcnt(0)
    v_pk_add_f32 v[108:109], v[108:109], v[76:77]
    v_pk_add_f32 v[110:111], v[110:111], v[78:79]
    v_cvt_pk_bf16_f32 v112, v96, v97
    v_cvt_pk_bf16_f32 v113, v98, v99
    v_cvt_pk_bf16_f32 v114, v100, v101
    v_cvt_pk_bf16_f32 v115, v102, v103
    v_cvt_pk_bf16_f32 v116, v104, v105
    v_cvt_pk_bf16_f32 v117, v106, v107
    v_cvt_pk_bf16_f32 v118, v108, v109
    v_cvt_pk_bf16_f32 v119, v110, v111
    s_nop 0
    v_permlane16_swap_b32 v112, v114
    v_permlane16_swap_b32 v113, v115
    v_permlane16_swap_b32 v116, v118
    v_permlane16_swap_b32 v117, v119
    v_and_b32 v251, 8, v2
    v_mul_u32_u24 v251, 0x808, v251
    v_xor_b32 v7, v7, v251
    s_add_u32 s42, s41, 16384
    v_mov_b32 v96, v112
    v_mov_b32 v97, v113
    v_mov_b32 v98, v114
    v_mov_b32 v99, v115
    v_mov_b32_dpp v112, v116 row_ror:8 row_mask:0xf bank_mask:0xc
    v_mov_b32_dpp v113, v117 row_ror:8 row_mask:0xf bank_mask:0xc
    v_mov_b32_dpp v114, v118 row_ror:8 row_mask:0xf bank_mask:0xc
    v_mov_b32_dpp v115, v119 row_ror:8 row_mask:0xf bank_mask:0xc
    buffer_store_dwordx4 v[112:115], v7, s[32:35], s41 offen sc1
    v_mov_b32_dpp v116, v96 row_ror:8 row_mask:0xf bank_mask:0x3
    v_mov_b32_dpp v117, v97 row_ror:8 row_mask:0xf bank_mask:0x3
    v_mov_b32_dpp v118, v98 row_ror:8 row_mask:0xf bank_mask:0x3
    v_mov_b32_dpp v119, v99 row_ror:8 row_mask:0xf bank_mask:0x3
    buffer_store_dwordx4 v[116:119], v7, s[32:35], s42 offen sc1
K_fin:
K_end:
    s_endpgm
K_slowB:
    s_cmp_eq_u32 s54, 1
    s_cbranch_scc1 K_okB
    s_waitcnt lgkmcnt(0)
    s_nop 7
    v_mov_b32 v5, s47
    v_mov_b32 v6, 0
K_spB:
    s_lshl_b32 s52, s46, 6
    s_add_u32 s52, s52, s45
    s_lshl_b32 s52, s52, 12
    s_mov_b32 s53, 0
    v_mov_b32 v136, 0
    v_mov_b32 v137, 0
    v_mov_b32 v138, 0
    v_mov_b32 v139, 0
    v_mov_b32 v140, 0
    v_mov_b32 v141, 0
    v_mov_b32 v142, 0
    v_mov_b32 v143, 0
    v_mov_b32 v144, 0
    v_mov_b32 v145, 0
    v_mov_b32 v146, 0
    v_mov_b32 v147, 0
    v_mov_b32 v148, 0
    v_mov_b32 v149, 0
    v_mov_b32 v150, 0
    v_mov_b32 v151, 0
    v_mov_b32 v152, 0
    v_mov_b32 v153, 0
    v_mov_b32 v154, 0
    v_mov_b32 v155, 0
K_slB:
    buffer_load_dwordx4 v[204:207], v4, s[20:23], s52 offen offset:0 sc1
    buffer_load_dwordx4 v[208:211], v4, s[20:23], s52 offen offset:1024 sc1
    buffer_load_dwordx4 v[212:215], v4, s[20:23], s52 offen offset:2048 sc1
    buffer_load_dwordx4 v[216:219], v4, s[20:23], s52 offen offset:3072 sc1
    s_cmp_eq_u32 s53, 0
    s_cselect_b32 s42, 1.0, 0
    s_cmp_eq_u32 s53, 8
    s_cselect_b32 s43, 1.0, 0
    v_fma_f32 v188, v156, s42, v6
    v_fma_f32 v188, v172, s43, v188
    v_fma_f32 v189, v157, s42, v6
    v_fma_f32 v189, v173, s43, v189
    v_fma_f32 v190, v158, s42, v6
    v_fma_f32 v190, v174, s43, v190
    v_fma_f32 v191, v159, s42, v6
    v_fma_f32 v191, v175, s43, v191
    v_fma_f32 v192, v160, s42, v6
    v_fma_f32 v192, v176, s43, v192
    v_fma_f32 v193, v161, s42, v6
    v_fma_f32 v193, v177, s43, v193
    v_fma_f32 v194, v162, s42, v6
    v_fma_f32 v194, v178, s43, v194
    v_fma_f32 v195, v163, s42, v6
    v_fma_f32 v195, v179, s43, v195
    v_fma_f32 v196, v164, s42, v6
    v_fma_f32 v196, v180, s43, v196
    v_fma_f32 v197, v165, s42, v6
    v_fma_f32 v197, v181, s43, v197
    v_fma_f32 v198, v166, s42, v6
    v_fma_f32 v198, v182, s43, v198
    v_fma_f32 v199, v167, s42, v6
    v_fma_f32 v199, v183, s43, v199
    v_fma_f32 v200, v168, s42, v6
    v_fma_f32 v200, v184, s43, v200
    v_fma_f32 v201, v169, s42, v6
    v_fma_f32 v201, v185, s43, v201
    v_fma_f32 v202, v170, s42, v6
    v_fma_f32 v202, v186, s43, v202
    v_fma_f32 v203, v171, s42, v6
    v_fma_f32 v203, v187, s43, v203
    s_waitcnt vmcnt(0)
    s_nop 1
    v_mfma_f32_32x32x16_bf16 v[188:203], v[204:207], v[128:131], v[188:203]
    v_mfma_f32_32x32x16_bf16 v[188:203], v[208:211], v[132:135], v[188:203]
    s_nop 15
    s_cmp_eq_u32 s54, 1
    s_cbranch_scc1 K_s1B
    v_max3_f32 v5, v188, v189, v5
    v_max3_f32 v5, v190, v191, v5
    v_max3_f32 v5, v192, v193, v5
    v_max3_f32 v5, v194, v195, v5
    v_max3_f32 v5, v196, v197, v5
    v_max3_f32 v5, v198, v199, v5
    v_max3_f32 v5, v200, v201, v5
    v_max3_f32 v5, v202, v203, v5
    s_branch K_s2B
K_s1B:
    v_exp_f32 v188, v188
    v_exp_f32 v189, v189
    v_exp_f32 v190, v190
    v_exp_f32 v191, v191
    v_exp_f32 v192, v192
    v_exp_f32 v193, v193
    v_exp_f32 v194, v194
    v_exp_f32 v195, v195
    v_exp_f32 v196, v196
    v_exp_f32 v197, v197
    v_exp_f32 v198, v198
    v_exp_f32 v199, v199
    v_exp_f32 v200, v200
    v_exp_f32 v201, v201
    v_exp_f32 v202, v202
    v_exp_f32 v203, v203
    s_nop 1
    v_smfmac_f32_32x32x32_bf16 v[136:151], v[212:215], v[188:195], v224
    v_smfmac_f32_32x32x32_bf16 v[136:151], v[216:219], v[196:203], v224
    v_smfmac_f32_16x16x64_bf16 v[152:155], v[220:223], v[188:195], v224
    v_smfmac_f32_16x16x64_bf16 v[152:155], v[220:223], v[196:203], v224
    s_nop 15
K_s2B:
    s_add_u32 s53, s53, 1
    s_sub_u32 s52, s52, 4096
    s_min_u32 s42, s45, 8
    s_cmp_le_u32 s53, s42
    s_cbranch_scc1 K_slB
    s_cmp_eq_u32 s54, 1
    s_cbranch_scc1 K_doneB
    v_mov_b32 v6, v5
    s_nop 1
    v_permlane32_swap_b32 v6, v5
    s_nop 1
    v_max_f32 v5, v5, v6
    v_sub_f32 v6, 0, v5
    s_mov_b32 s54, 1
    s_branch K_spB
K_doneB:
    s_branch K_backB
K_slowA:
    s_cmp_eq_u32 s54, 1
    s_cbranch_scc1 K_okA
    s_waitcnt lgkmcnt(0)
    s_nop 7
    v_mov_b32 v5, s47
    v_mov_b32 v6, 0
K_spA:
    s_mov_b32 s52, 16777216
    s_mov_b32 s53, 0
    v_mov_b32 v24, 0
    v_mov_b32 v25, 0
    v_mov_b32 v26, 0
    v_mov_b32 v27, 0
    v_mov_b32 v28, 0
    v_mov_b32 v29, 0
    v_mov_b32 v30, 0
    v_mov_b32 v31, 0
    v_mov_b32 v32, 0
    v_mov_b32 v33, 0
    v_mov_b32 v34, 0
    v_mov_b32 v35, 0
    v_mov_b32 v36, 0
    v_mov_b32 v37, 0
    v_mov_b32 v38, 0
    v_mov_b32 v39, 0
    v_mov_b32 v56, 0
    v_mov_b32 v57, 0
    v_mov_b32 v58, 0
    v_mov_b32 v59, 0
K_slA:
    buffer_load_dwordx4 v[96:99], v4, s[20:23], s52 offen offset:0 sc1
    buffer_load_dwordx4 v[100:103], v4, s[20:23], s52 offen offset:1024 sc1
    buffer_load_dwordx4 v[112:115], v4, s[20:23], s52 offen offset:2048 sc1
    buffer_load_dwordx4 v[116:119], v4, s[20:23], s52 offen offset:3072 sc1
    v_mov_b32 v64, v6
    v_mov_b32 v65, v6
    v_mov_b32 v66, v6
    v_mov_b32 v67, v6
    v_mov_b32 v68, v6
    v_mov_b32 v69, v6
    v_mov_b32 v70, v6
    v_mov_b32 v71, v6
    v_mov_b32 v72, v6
    v_mov_b32 v73, v6
    v_mov_b32 v74, v6
    v_mov_b32 v75, v6
    v_mov_b32 v76, v6
    v_mov_b32 v77, v6
    v_mov_b32 v78, v6
    v_mov_b32 v79, v6
    s_waitcnt vmcnt(0)
    s_nop 1
    v_mfma_f32_32x32x16_bf16 v[64:79], v[96:99], v[8:11], v[64:79]
    v_mfma_f32_32x32x16_bf16 v[64:79], v[100:103], v[12:15], v[64:79]
    s_nop 15
    s_cmp_eq_u32 s54, 1
    s_cbranch_scc1 K_s1A
    v_max3_f32 v5, v64, v65, v5
    v_max3_f32 v5, v66, v67, v5
    v_max3_f32 v5, v68, v69, v5
    v_max3_f32 v5, v70, v71, v5
    v_max3_f32 v5, v72, v73, v5
    v_max3_f32 v5, v74, v75, v5
    v_max3_f32 v5, v76, v77, v5
    v_max3_f32 v5, v78, v79, v5
    s_branch K_s2A
K_s1A:
    v_exp_f32 v64, v64
    v_exp_f32 v65, v65
    v_exp_f32 v66, v66
    v_exp_f32 v67, v67
    v_exp_f32 v68, v68
    v_exp_f32 v69, v69
    v_exp_f32 v70, v70
    v_exp_f32 v71, v71
    v_exp_f32 v72, v72
    v_exp_f32 v73, v73
    v_exp_f32 v74, v74
    v_exp_f32 v75, v75
    v_exp_f32 v76, v76
    v_exp_f32 v77, v77
    v_exp_f32 v78, v78
    v_exp_f32 v79, v79
    s_nop 1
    v_smfmac_f32_32x32x32_bf16 v[24:39], v[112:115], v[64:71], v224
    v_smfmac_f32_32x32x32_bf16 v[24:39], v[116:119], v[72:79], v224
    v_smfmac_f32_16x16x64_bf16 v[56:59], v[220:223], v[64:71], v224
    v_smfmac_f32_16x16x64_bf16 v[56:59], v[220:223], v[72:79], v224
    s_nop 15
K_s2A:
    s_add_u32 s53, s53, 1
    s_add_u32 s52, s52, 4096
    s_cmp_lt_u32 s53, 64
    s_cbranch_scc1 K_slA
    s_cmp_eq_u32 s54, 1
    s_cbranch_scc1 K_doneA
    v_mov_b32 v6, v5
    s_nop 1
    v_permlane32_swap_b32 v6, v5
    s_nop 1
    v_max_f32 v5, v5, v6
    v_sub_f32 v6, 0, v5
    s_mov_b32 s54, 1
    s_branch K_spA
K_doneA:
    ds_read_b64_tr_b16 v[96:97], v228 offset:0
    ds_read_b64_tr_b16 v[98:99], v228 offset:1024
    ds_read_b64_tr_b16 v[100:101], v228 offset:8192
    ds_read_b64_tr_b16 v[102:103], v228 offset:9216
    ds_read_b64_tr_b16 v[104:105], v229 offset:0
    ds_read_b64_tr_b16 v[106:107], v229 offset:1024
    ds_read_b64_tr_b16 v[108:109], v229 offset:8192
    ds_read_b64_tr_b16 v[110:111], v229 offset:9216
    ds_read_b64_tr_b16 v[112:113], v230 offset:0
    ds_read_b64_tr_b16 v[114:115], v230 offset:1024
    ds_read_b64_tr_b16 v[116:117], v230 offset:8192
    ds_read_b64_tr_b16 v[118:119], v230 offset:9216
    ds_read_b64_tr_b16 v[120:121], v231 offset:0
    ds_read_b64_tr_b16 v[122:123], v231 offset:1024
    ds_read_b64_tr_b16 v[124:125], v231 offset:8192
    ds_read_b64_tr_b16 v[126:127], v231 offset:9216
    s_branch K_backA
K_ph0_0:
    s_barrier
    s_add_u32 m0, s52, 54272
    s_nop 0
    buffer_load_dwordx4 v13, s[8:11], s50 offen  lds
    s_add_u32 m0, s51, 52224
    s_movk_i32 s49, 128
    buffer_load_dwordx4 v11, s[4:7], s49 offen  lds
    s_add_u32 m0, s52, 55296
    s_add_u32 s50, s50, s48
    buffer_load_dwordx4 v12, s[8:11], s50 offen  lds
    s_add_u32 m0, s52, 56320
    s_nop 0
    buffer_load_dwordx4 v13, s[8:11], s50 offen  lds
    s_add_u32 m0, s51, 98304
    s_movk_i32 s49, 256
    buffer_load_dwordx4 v8, s[4:7], s49 offen  lds
    s_add_u32 m0, s52, 98304
    s_add_u32 s50, s50, s48
    buffer_load_dwordx4 v12, s[8:11], s50 offen  lds
    s_add_u32 m0, s52, 99328
    s_nop 0
    buffer_load_dwordx4 v13, s[8:11], s50 offen  lds
    s_add_u32 m0, s51, 99328
    s_movk_i32 s49, 256
    buffer_load_dwordx4 v9, s[4:7], s49 offen  lds
    s_add_u32 m0, s52, 100352
    s_add_u32 s50, s50, s48
    buffer_load_dwordx4 v12, s[8:11], s50 offen  lds
    s_add_u32 m0, s52, 101376
    s_nop 0
    buffer_load_dwordx4 v13, s[8:11], s50 offen  lds
    s_add_u32 m0, s51, 100352
    s_movk_i32 s49, 256
    buffer_load_dwordx4 v10, s[4:7], s49 offen  lds
    s_add_u32 m0, s52, 102400
    s_add_u32 s50, s50, s48
    buffer_load_dwordx4 v12, s[8:11], s50 offen  lds
    s_add_u32 m0, s52, 103424
    s_nop 0
    buffer_load_dwordx4 v13, s[8:11], s50 offen  lds
    s_add_u32 m0, s51, 101376
    s_movk_i32 s49, 256
    buffer_load_dwordx4 v11, s[4:7], s49 offen  lds
    s_add_u32 m0, s52, 104448
    s_add_u32 s50, s50, s48
    buffer_load_dwordx4 v12, s[8:11], s50 offen  lds
    s_add_u32 m0, s52, 105472
    s_nop 0
    buffer_load_dwordx4 v13, s[8:11], s50 offen  lds
    s_waitcnt vmcnt(12)
    s_barrier
    s_add_u32 m0, s51, 0
    s_movk_i32 s49, 384
    buffer_load_dwordx4 v8, s[4:7], s49 offen  lds
    s_add_u32 m0, s52, 0
    s_add_u32 s50, s50, s48
    buffer_load_dwordx4 v12, s[8:11], s50 offen  lds
    s_add_u32 m0, s52, 1024
    s_nop 0
    buffer_load_dwordx4 v13, s[8:11], s50 offen  lds
    s_add_u32 m0, s51, 1024
    s_movk_i32 s49, 384
    buffer_load_dwordx4 v9, s[4:7], s49 offen  lds
    s_add_u32 m0, s52, 2048
    s_add_u32 s50, s50, s48
    buffer_load_dwordx4 v12, s[8:11], s50 offen  lds
    s_add_u32 m0, s52, 3072
    s_nop 0
    buffer_load_dwordx4 v13, s[8:11], s50 offen  lds
    s_add_u32 m0, s51, 2048
    s_movk_i32 s49, 384
    buffer_load_dwordx4 v10, s[4:7], s49 offen  lds
    s_add_u32 m0, s52, 4096
    s_add_u32 s50, s50, s48
    buffer_load_dwordx4 v12, s[8:11], s50 offen  lds
    s_add_u32 m0, s52, 5120
    s_nop 0
    buffer_load_dwordx4 v13, s[8:11], s50 offen  lds
    s_add_u32 m0, s51, 3072
    s_movk_i32 s49, 384
    buffer_load_dwordx4 v11, s[4:7], s49 offen  lds
    s_add_u32 m0, s52, 6144
    s_add_u32 s50, s50, s48
    buffer_load_dwordx4 v12, s[8:11], s50 offen  lds
    s_add_u32 m0, s52, 7168
    s_nop 0
    buffer_load_dwordx4 v13, s[8:11], s50 offen  lds
    s_mul_i32 s40, s62, 320
    s_mov_b64 exec, 0xffff
    buffer_load_dword v255, v17, s[8:11], s40 offen
    s_mov_b64 exec, -1
    s_mov_b32 exec_hi, 0
    buffer_load_dword v255, v182, s[4:7], 0 offen offset:1024
    s_mov_b32 exec_hi, -1
    s_waitcnt vmcnt(14)
    s_barrier
    s_cmp_lg_u32 s61, 3
    s_cbranch_scc1 K_nf_1
    s_and_b32 s40, s37, 3
    s_lshl2_add_u32 s40, s36, s40
    s_lshl_b32 s40, s40, 5
    s_lshr_b32 s41, s37, 3
    s_add_u32 s40, s40, s41
    s_lshl_b32 s40, s40, 2
    s_add_u32 s40, s40, 17301512
    s_mov_b64 exec, 1
    buffer_store_dword v240, off, s[20:23], s40 sc1
    s_mov_b64 exec, -1
K_nf_1:
    s_add_u32 m0, s51, 49152
    s_movk_i32 s49, 512
    buffer_load_dwordx4 v8, s[4:7], s49 offen  lds
    s_add_u32 m0, s52, 49152
    s_add_u32 s50, s50, s48
    buffer_load_dwordx4 v12, s[8:11], s50 offen  lds
    s_add_u32 m0, s52, 50176
    s_nop 0
    buffer_load_dwordx4 v13, s[8:11], s50 offen  lds
    s_waitcnt vmcnt(5)
    s_barrier
    s_add_u32 m0, s51, 50176
    s_movk_i32 s49, 512
    buffer_load_dwordx4 v9, s[4:7], s49 offen  lds
    s_add_u32 m0, s52, 51200
    s_add_u32 s50, s50, s48
    buffer_load_dwordx4 v12, s[8:11], s50 offen  lds
    s_add_u32 m0, s52, 52224
    s_nop 0
    buffer_load_dwordx4 v13, s[8:11], s50 offen  lds
    s_add_u32 m0, s51, 51200
    s_movk_i32 s49, 512
    buffer_load_dwordx4 v10, s[4:7], s49 offen  lds
    s_add_u32 m0, s52, 53248
    s_add_u32 s50, s50, s48
    buffer_load_dwordx4 v12, s[8:11], s50 offen  lds
    s_add_u32 m0, s52, 54272
    s_nop 0
    buffer_load_dwordx4 v13, s[8:11], s50 offen  lds
    s_add_u32 m0, s51, 52224
    s_movk_i32 s49, 512
    buffer_load_dwordx4 v11, s[4:7], s49 offen  lds
    s_add_u32 m0, s52, 55296
    s_add_u32 s50, s50, s48
    buffer_load_dwordx4 v12, s[8:11], s50 offen  lds
    s_add_u32 m0, s52, 56320
    s_nop 0
    buffer_load_dwordx4 v13, s[8:11], s50 offen  lds
    s_add_u32 m0, s51, 98304
    s_movk_i32 s49, 640
    buffer_load_dwordx4 v8, s[4:7], s49 offen  lds
    s_add_u32 m0, s52, 98304
    s_add_u32 s50, s50, s48
    buffer_load_dwordx4 v12, s[8:11], s50 offen  lds
    s_add_u32 m0, s52, 99328
    s_nop 0
    buffer_load_dwordx4 v13, s[8:11], s50 offen  lds
    s_add_u32 m0, s51, 99328
    s_movk_i32 s49, 640
    buffer_load_dwordx4 v9, s[4:7], s49 offen  lds
    s_add_u32 m0, s52, 100352
    s_add_u32 s50, s50, s48
    buffer_load_dwordx4 v12, s[8:11], s50 offen  lds
    s_add_u32 m0, s52, 101376
    s_nop 0
    buffer_load_dwordx4 v13, s[8:11], s50 offen  lds
    s_add_u32 m0, s51, 100352
    s_movk_i32 s49, 640
    buffer_load_dwordx4 v10, s[4:7], s49 offen  lds
    s_add_u32 m0, s52, 102400
    s_add_u32 s50, s50, s48
    buffer_load_dwordx4 v12, s[8:11], s50 offen  lds
    s_waitcnt vmcnt(8)
    s_barrier
    s_add_u32 m0, s52, 103424
    s_nop 0
    buffer_load_dwordx4 v13, s[8:11], s50 offen  lds
    s_add_u32 m0, s51, 101376
    s_movk_i32 s49, 640
    buffer_load_dwordx4 v11, s[4:7], s49 offen  lds
    s_add_u32 m0, s52, 104448
    s_add_u32 s50, s50, s48
    buffer_load_dwordx4 v12, s[8:11], s50 offen  lds
    s_add_u32 m0, s52, 105472
    s_nop 0
    buffer_load_dwordx4 v13, s[8:11], s50 offen  lds
    s_add_u32 m0, s51, 0
    s_movk_i32 s49, 768
    buffer_load_dwordx4 v8, s[4:7], s49 offen  lds
    s_add_u32 m0, s52, 0
    s_add_u32 s50, s50, s48
    buffer_load_dwordx4 v12, s[8:11], s50 offen  lds
    s_add_u32 m0, s52, 1024
    s_nop 0
    buffer_load_dwordx4 v13, s[8:11], s50 offen  lds
    s_add_u32 m0, s51, 1024
    s_movk_i32 s49, 768
    buffer_load_dwordx4 v9, s[4:7], s49 offen  lds
    s_add_u32 m0, s52, 2048
    s_add_u32 s50, s50, s48
    buffer_load_dwordx4 v12, s[8:11], s50 offen  lds
    s_add_u32 m0, s52, 3072
    s_nop 0
    buffer_load_dwordx4 v13, s[8:11], s50 offen  lds
    s_add_u32 m0, s51, 2048
    s_movk_i32 s49, 768
    buffer_load_dwordx4 v10, s[4:7], s49 offen  lds
    s_add_u32 m0, s52, 4096
    s_add_u32 s50, s50, s48
    buffer_load_dwordx4 v12, s[8:11], s50 offen  lds
    s_add_u32 m0, s52, 5120
    s_nop 0
    buffer_load_dwordx4 v13, s[8:11], s50 offen  lds
    s_add_u32 m0, s51, 3072
    s_movk_i32 s49, 768
    buffer_load_dwordx4 v11, s[4:7], s49 offen  lds
    s_add_u32 m0, s52, 6144
    s_add_u32 s50, s50, s48
    buffer_load_dwordx4 v12, s[8:11], s50 offen  lds
    s_add_u32 m0, s52, 7168
    s_nop 0
    buffer_load_dwordx4 v13, s[8:11], s50 offen  lds
    s_waitcnt vmcnt(12)
    s_barrier
    s_add_u32 m0, s51, 49152
    s_movk_i32 s49, 896
    buffer_load_dwordx4 v8, s[4:7], s49 offen  lds
    s_add_u32 m0, s52, 49152
    s_add_u32 s50, s50, s48
    buffer_load_dwordx4 v12, s[8:11], s50 offen  lds
    s_add_u32 m0, s52, 50176
    s_nop 0
    buffer_load_dwordx4 v13, s[8:11], s50 offen  lds
    s_add_u32 m0, s51, 50176
    s_movk_i32 s49, 896
    buffer_load_dwordx4 v9, s[4:7], s49 offen  lds
    s_add_u32 m0, s52, 51200
    s_add_u32 s50, s50, s48
    buffer_load_dwordx4 v12, s[8:11], s50 offen  lds
    s_add_u32 m0, s52, 52224
    s_nop 0
    buffer_load_dwordx4 v13, s[8:11], s50 offen  lds
    s_add_u32 m0, s51, 51200
    s_movk_i32 s49, 896
    buffer_load_dwordx4 v10, s[4:7], s49 offen  lds
    s_add_u32 m0, s52, 53248
    s_add_u32 s50, s50, s48
    buffer_load_dwordx4 v12, s[8:11], s50 offen  lds
    s_add_u32 m0, s52, 54272
    s_nop 0
    buffer_load_dwordx4 v13, s[8:11], s50 offen  lds
    s_add_u32 m0, s51, 52224
    s_movk_i32 s49, 896
    buffer_load_dwordx4 v11, s[4:7], s49 offen  lds
    s_add_u32 m0, s52, 55296
    s_add_u32 s50, s50, s48
    buffer_load_dwordx4 v12, s[8:11], s50 offen  lds
    s_add_u32 m0, s52, 56320
    s_nop 0
    buffer_load_dwordx4 v13, s[8:11], s50 offen  lds
    s_mul_i32 s40, s62, 576
    s_mov_b64 exec, 0
    s_mov_b32 exec_lo, -1
    s_mov_b32 exec_hi, 0x0
    buffer_load_dword v255, v17, s[8:11], s40 offen
    s_mov_b64 exec, -1
    s_waitcnt vmcnt(13)
    s_barrier
    s_add_u32 m0, s51, 98304
    s_movk_i32 s49, 1024
    buffer_load_dwordx4 v8, s[4:7], s49 offen  lds
    s_add_u32 m0, s52, 98304
    s_add_u32 s50, s50, s48
    buffer_load_dwordx4 v12, s[8:11], s50 offen  lds
    s_add_u32 m0, s52, 99328
    s_nop 0
    buffer_load_dwordx4 v13, s[8:11], s50 offen  lds
    s_waitcnt vmcnt(4)
    s_barrier
    s_add_u32 m0, s51, 99328
    s_movk_i32 s49, 1024
    buffer_load_dwordx4 v9, s[4:7], s49 offen  lds
    s_add_u32 m0, s52, 100352
    s_add_u32 s50, s50, s48
    buffer_load_dwordx4 v12, s[8:11], s50 offen  lds
    s_add_u32 m0, s52, 101376
    s_nop 0
    buffer_load_dwordx4 v13, s[8:11], s50 offen  lds
    s_add_u32 m0, s51, 100352
    s_movk_i32 s49, 1024
    buffer_load_dwordx4 v10, s[4:7], s49 offen  lds
    s_add_u32 m0, s52, 102400
    s_add_u32 s50, s50, s48
    buffer_load_dwordx4 v12, s[8:11], s50 offen  lds
    s_add_u32 m0, s52, 103424
    s_nop 0
    buffer_load_dwordx4 v13, s[8:11], s50 offen  lds
    s_add_u32 m0, s51, 101376
    s_movk_i32 s49, 1024
    buffer_load_dwordx4 v11, s[4:7], s49 offen  lds
    s_add_u32 m0, s52, 104448
    s_add_u32 s50, s50, s48
    buffer_load_dwordx4 v12, s[8:11], s50 offen  lds
    s_add_u32 m0, s52, 105472
    s_nop 0
    buffer_load_dwordx4 v13, s[8:11], s50 offen  lds
    s_add_u32 m0, s51, 0
    s_movk_i32 s49, 1152
    buffer_load_dwordx4 v8, s[4:7], s49 offen  lds
    s_add_u32 m0, s52, 0
    s_add_u32 s50, s50, s48
    buffer_load_dwordx4 v12, s[8:11], s50 offen  lds
    s_add_u32 m0, s52, 1024
    s_nop 0
    buffer_load_dwordx4 v13, s[8:11], s50 offen  lds
    s_add_u32 m0, s51, 1024
    s_movk_i32 s49, 1152
    buffer_load_dwordx4 v9, s[4:7], s49 offen  lds
    s_add_u32 m0, s52, 2048
    s_add_u32 s50, s50, s48
    buffer_load_dwordx4 v12, s[8:11], s50 offen  lds
    s_add_u32 m0, s52, 3072
    s_nop 0
    buffer_load_dwordx4 v13, s[8:11], s50 offen  lds
    s_add_u32 m0, s51, 2048
    s_movk_i32 s49, 1152
    buffer_load_dwordx4 v10, s[4:7], s49 offen  lds
    s_add_u32 m0, s52, 4096
    s_add_u32 s50, s50, s48
    buffer_load_dwordx4 v12, s[8:11], s50 offen  lds
    s_waitcnt vmcnt(8)
    s_barrier
    s_add_u32 m0, s52, 5120
    s_nop 0
    buffer_load_dwordx4 v13, s[8:11], s50 offen  lds
    s_add_u32 m0, s51, 3072
    s_movk_i32 s49, 1152
    buffer_load_dwordx4 v11, s[4:7], s49 offen  lds
    s_add_u32 m0, s52, 6144
    s_add_u32 s50, s50, s48
    buffer_load_dwordx4 v12, s[8:11], s50 offen  lds
    s_add_u32 m0, s52, 7168
    s_nop 0
    buffer_load_dwordx4 v13, s[8:11], s50 offen  lds
    s_add_u32 m0, s51, 49152
    s_movk_i32 s49, 1280
    buffer_load_dwordx4 v8, s[4:7], s49 offen  lds
    s_add_u32 m0, s52, 49152
    s_add_u32 s50, s50, s48
    buffer_load_dwordx4 v12, s[8:11], s50 offen  lds
    s_add_u32 m0, s52, 50176
    s_nop 0
    buffer_load_dwordx4 v13, s[8:11], s50 offen  lds
    s_add_u32 m0, s51, 50176
    s_movk_i32 s49, 1280
    buffer_load_dwordx4 v9, s[4:7], s49 offen  lds
    s_add_u32 m0, s52, 51200
    s_add_u32 s50, s50, s48
    buffer_load_dwordx4 v12, s[8:11], s50 offen  lds
    s_add_u32 m0, s52, 52224
    s_nop 0
    buffer_load_dwordx4 v13, s[8:11], s50 offen  lds
    s_add_u32 m0, s51, 51200
    s_movk_i32 s49, 1280
    buffer_load_dwordx4 v10, s[4:7], s49 offen  lds
    s_add_u32 m0, s52, 53248
    s_add_u32 s50, s50, s48
    buffer_load_dwordx4 v12, s[8:11], s50 offen  lds
    s_add_u32 m0, s52, 54272
    s_nop 0
    buffer_load_dwordx4 v13, s[8:11], s50 offen  lds
    s_add_u32 m0, s51, 52224
    s_movk_i32 s49, 1280
    buffer_load_dwordx4 v11, s[4:7], s49 offen  lds
    s_add_u32 m0, s52, 55296
    s_add_u32 s50, s50, s48
    buffer_load_dwordx4 v12, s[8:11], s50 offen  lds
    s_add_u32 m0, s52, 56320
    s_nop 0
    buffer_load_dwordx4 v13, s[8:11], s50 offen  lds
    s_waitcnt vmcnt(12)
    s_barrier
    s_add_u32 m0, s51, 98304
    s_movk_i32 s49, 1408
    buffer_load_dwordx4 v8, s[4:7], s49 offen  lds
    s_add_u32 m0, s52, 98304
    s_add_u32 s50, s50, s48
    buffer_load_dwordx4 v12, s[8:11], s50 offen  lds
    s_add_u32 m0, s52, 99328
    s_nop 0
    buffer_load_dwordx4 v13, s[8:11], s50 offen  lds
    s_add_u32 m0, s51, 99328
    s_movk_i32 s49, 1408
    buffer_load_dwordx4 v9, s[4:7], s49 offen  lds
    s_add_u32 m0, s52, 100352
    s_add_u32 s50, s50, s48
    buffer_load_dwordx4 v12, s[8:11], s50 offen  lds
    s_add_u32 m0, s52, 101376
    s_nop 0
    buffer_load_dwordx4 v13, s[8:11], s50 offen  lds
    s_add_u32 m0, s51, 100352
    s_movk_i32 s49, 1408
    buffer_load_dwordx4 v10, s[4:7], s49 offen  lds
    s_add_u32 m0, s52, 102400
    s_add_u32 s50, s50, s48
    buffer_load_dwordx4 v12, s[8:11], s50 offen  lds
    s_add_u32 m0, s52, 103424
    s_nop 0
    buffer_load_dwordx4 v13, s[8:11], s50 offen  lds
    s_add_u32 m0, s51, 101376
    s_movk_i32 s49, 1408
    buffer_load_dwordx4 v11, s[4:7], s49 offen  lds
    s_add_u32 m0, s52, 104448
    s_add_u32 s50, s50, s48
    buffer_load_dwordx4 v12, s[8:11], s50 offen  lds
    s_add_u32 m0, s52, 105472
    s_nop 0
    buffer_load_dwordx4 v13, s[8:11], s50 offen  lds
    s_waitcnt vmcnt(12)
    s_barrier
    s_add_u32 m0, s51, 0
    s_movk_i32 s49, 1536
    buffer_load_dwordx4 v8, s[4:7], s49 offen  lds
    s_add_u32 m0, s52, 0
    s_add_u32 s50, s50, s48
    buffer_load_dwordx4 v12, s[8:11], s50 offen  lds
    s_add_u32 m0, s52, 1024
    s_nop 0
    buffer_load_dwordx4 v13, s[8:11], s50 offen  lds
    s_add_u32 m0, s51, 1024
    s_movk_i32 s49, 1536
    buffer_load_dwordx4 v9, s[4:7], s49 offen  lds
    s_add_u32 m0, s52, 2048
    s_add_u32 s50, s50, s48
    buffer_load_dwordx4 v12, s[8:11], s50 offen  lds
    s_add_u32 m0, s52, 3072
    s_nop 0
    buffer_load_dwordx4 v13, s[8:11], s50 offen  lds
    s_add_u32 m0, s51, 2048
    s_movk_i32 s49, 1536
    buffer_load_dwordx4 v10, s[4:7], s49 offen  lds
    s_add_u32 m0, s52, 4096
    s_add_u32 s50, s50, s48
    buffer_load_dwordx4 v12, s[8:11], s50 offen  lds
    s_add_u32 m0, s52, 5120
    s_nop 0
    buffer_load_dwordx4 v13, s[8:11], s50 offen  lds
    s_add_u32 m0, s51, 3072
    s_movk_i32 s49, 1536
    buffer_load_dwordx4 v11, s[4:7], s49 offen  lds
    s_add_u32 m0, s52, 6144
    s_add_u32 s50, s50, s48
    buffer_load_dwordx4 v12, s[8:11], s50 offen  lds
    s_add_u32 m0, s52, 7168
    s_nop 0
    buffer_load_dwordx4 v13, s[8:11], s50 offen  lds
    s_waitcnt vmcnt(12)
    s_barrier
    s_add_u32 m0, s51, 49152
    s_movk_i32 s49, 1664
    buffer_load_dwordx4 v8, s[4:7], s49 offen  lds
    s_add_u32 m0, s52, 49152
    s_add_u32 s50, s50, s48
    buffer_load_dwordx4 v12, s[8:11], s50 offen  lds
    s_add_u32 m0, s52, 50176
    s_nop 0
    buffer_load_dwordx4 v13, s[8:11], s50 offen  lds
    s_add_u32 m0, s51, 50176
    s_movk_i32 s49, 1664
    buffer_load_dwordx4 v9, s[4:7], s49 offen  lds
    s_add_u32 m0, s52, 51200
    s_add_u32 s50, s50, s48
    buffer_load_dwordx4 v12, s[8:11], s50 offen  lds
    s_add_u32 m0, s52, 52224
    s_nop 0
    buffer_load_dwordx4 v13, s[8:11], s50 offen  lds
    s_add_u32 m0, s51, 51200
    s_movk_i32 s49, 1664
    buffer_load_dwordx4 v10, s[4:7], s49 offen  lds
    s_add_u32 m0, s52, 53248
    s_add_u32 s50, s50, s48
    buffer_load_dwordx4 v12, s[8:11], s50 offen  lds
    s_add_u32 m0, s52, 54272
    s_nop 0
    buffer_load_dwordx4 v13, s[8:11], s50 offen  lds
    s_add_u32 m0, s51, 52224
    s_movk_i32 s49, 1664
    buffer_load_dwordx4 v11, s[4:7], s49 offen  lds
    s_add_u32 m0, s52, 55296
    s_add_u32 s50, s50, s48
    buffer_load_dwordx4 v12, s[8:11], s50 offen  lds
    s_add_u32 m0, s52, 56320
    s_nop 0
    buffer_load_dwordx4 v13, s[8:11], s50 offen  lds
    s_waitcnt vmcnt(12)
    s_barrier
    s_add_u32 m0, s51, 98304
    s_movk_i32 s49, 1792
    buffer_load_dwordx4 v8, s[4:7], s49 offen  lds
    s_add_u32 m0, s52, 98304
    s_add_u32 s50, s50, s48
    buffer_load_dwordx4 v12, s[8:11], s50 offen  lds
    s_add_u32 m0, s52, 99328
    s_nop 0
    buffer_load_dwordx4 v13, s[8:11], s50 offen  lds
    s_add_u32 m0, s51, 99328
    s_movk_i32 s49, 1792
    buffer_load_dwordx4 v9, s[4:7], s49 offen  lds
    s_add_u32 m0, s52, 100352
    s_add_u32 s50, s50, s48
    buffer_load_dwordx4 v12, s[8:11], s50 offen  lds
    s_add_u32 m0, s52, 101376
    s_nop 0
    buffer_load_dwordx4 v13, s[8:11], s50 offen  lds
    s_add_u32 m0, s51, 100352
    s_movk_i32 s49, 1792
    buffer_load_dwordx4 v10, s[4:7], s49 offen  lds
    s_add_u32 m0, s52, 102400
    s_add_u32 s50, s50, s48
    buffer_load_dwordx4 v12, s[8:11], s50 offen  lds
    s_add_u32 m0, s52, 103424
    s_nop 0
    buffer_load_dwordx4 v13, s[8:11], s50 offen  lds
    s_add_u32 m0, s51, 101376
    s_movk_i32 s49, 1792
    buffer_load_dwordx4 v11, s[4:7], s49 offen  lds
    s_add_u32 m0, s52, 104448
    s_add_u32 s50, s50, s48
    buffer_load_dwordx4 v12, s[8:11], s50 offen  lds
    s_add_u32 m0, s52, 105472
    s_nop 0
    buffer_load_dwordx4 v13, s[8:11], s50 offen  lds
    s_waitcnt vmcnt(12)
    s_barrier
    s_add_u32 m0, s51, 0
    s_movk_i32 s49, 1920
    buffer_load_dwordx4 v8, s[4:7], s49 offen  lds
    s_add_u32 m0, s52, 0
    s_add_u32 s50, s50, s48
    buffer_load_dwordx4 v12, s[8:11], s50 offen  lds
    s_add_u32 m0, s52, 1024
    s_nop 0
    buffer_load_dwordx4 v13, s[8:11], s50 offen  lds
    s_add_u32 m0, s51, 1024
    s_movk_i32 s49, 1920
    buffer_load_dwordx4 v9, s[4:7], s49 offen  lds
    s_add_u32 m0, s52, 2048
    s_add_u32 s50, s50, s48
    buffer_load_dwordx4 v12, s[8:11], s50 offen  lds
    s_add_u32 m0, s52, 3072
    s_nop 0
    buffer_load_dwordx4 v13, s[8:11], s50 offen  lds
    s_add_u32 m0, s51, 2048
    s_movk_i32 s49, 1920
    buffer_load_dwordx4 v10, s[4:7], s49 offen  lds
    s_add_u32 m0, s52, 4096
    s_add_u32 s50, s50, s48
    buffer_load_dwordx4 v12, s[8:11], s50 offen  lds
    s_add_u32 m0, s52, 5120
    s_nop 0
    buffer_load_dwordx4 v13, s[8:11], s50 offen  lds
    s_add_u32 m0, s51, 3072
    s_movk_i32 s49, 1920
    buffer_load_dwordx4 v11, s[4:7], s49 offen  lds
    s_add_u32 m0, s52, 6144
    s_add_u32 s50, s50, s48
    buffer_load_dwordx4 v12, s[8:11], s50 offen  lds
    s_add_u32 m0, s52, 7168
    s_nop 0
    buffer_load_dwordx4 v13, s[8:11], s50 offen  lds
    s_waitcnt vmcnt(12)
    s_branch K_phend
K_ph0_1:
    s_barrier
    s_add_u32 m0, s52, 54272
    s_nop 0
    buffer_load_dwordx4 v13, s[8:11], s50 offen  lds
    s_add_u32 m0, s51, 52224
    s_movk_i32 s49, 128
    buffer_load_dwordx4 v11, s[4:7], s49 offen  lds
    s_add_u32 m0, s52, 55296
    s_add_u32 s50, s50, s48
    buffer_load_dwordx4 v12, s[8:11], s50 offen  lds
    s_add_u32 m0, s52, 56320
    s_nop 0
    buffer_load_dwordx4 v13, s[8:11], s50 offen  lds
    s_add_u32 m0, s51, 98304
    s_movk_i32 s49, 256
    buffer_load_dwordx4 v8, s[4:7], s49 offen  lds
    s_add_u32 m0, s52, 98304
    s_add_u32 s50, s50, s48
    buffer_load_dwordx4 v12, s[8:11], s50 offen  lds
    s_add_u32 m0, s52, 99328
    s_nop 0
    buffer_load_dwordx4 v13, s[8:11], s50 offen  lds
    s_add_u32 m0, s51, 99328
    s_movk_i32 s49, 256
    buffer_load_dwordx4 v9, s[4:7], s49 offen  lds
    s_add_u32 m0, s52, 100352
    s_add_u32 s50, s50, s48
    buffer_load_dwordx4 v12, s[8:11], s50 offen  lds
    s_add_u32 m0, s52, 101376
    s_nop 0
    buffer_load_dwordx4 v13, s[8:11], s50 offen  lds
    s_add_u32 m0, s51, 100352
    s_movk_i32 s49, 256
    buffer_load_dwordx4 v10, s[4:7], s49 offen  lds
    s_add_u32 m0, s52, 102400
    s_add_u32 s50, s50, s48
    buffer_load_dwordx4 v12, s[8:11], s50 offen  lds
    s_add_u32 m0, s52, 103424
    s_nop 0
    buffer_load_dwordx4 v13, s[8:11], s50 offen  lds
    s_add_u32 m0, s51, 101376
    s_movk_i32 s49, 256
    buffer_load_dwordx4 v11, s[4:7], s49 offen  lds
    s_add_u32 m0, s52, 104448
    s_add_u32 s50, s50, s48
    buffer_load_dwordx4 v12, s[8:11], s50 offen  lds
    s_add_u32 m0, s52, 105472
    s_nop 0
    buffer_load_dwordx4 v13, s[8:11], s50 offen  lds
    s_waitcnt vmcnt(12)
    s_barrier
    s_add_u32 m0, s51, 0
    s_movk_i32 s49, 384
    buffer_load_dwordx4 v8, s[4:7], s49 offen  lds
    s_add_u32 m0, s52, 0
    s_add_u32 s50, s50, s48
    buffer_load_dwordx4 v12, s[8:11], s50 offen  lds
    s_add_u32 m0, s52, 1024
    s_nop 0
    buffer_load_dwordx4 v13, s[8:11], s50 offen  lds
    s_add_u32 m0, s51, 1024
    s_movk_i32 s49, 384
    buffer_load_dwordx4 v9, s[4:7], s49 offen  lds
    s_add_u32 m0, s52, 2048
    s_add_u32 s50, s50, s48
    buffer_load_dwordx4 v12, s[8:11], s50 offen  lds
    s_add_u32 m0, s52, 3072
    s_nop 0
    buffer_load_dwordx4 v13, s[8:11], s50 offen  lds
    s_add_u32 m0, s51, 2048
    s_movk_i32 s49, 384
    buffer_load_dwordx4 v10, s[4:7], s49 offen  lds
    s_add_u32 m0, s52, 4096
    s_add_u32 s50, s50, s48
    buffer_load_dwordx4 v12, s[8:11], s50 offen  lds
    s_add_u32 m0, s52, 5120
    s_nop 0
    buffer_load_dwordx4 v13, s[8:11], s50 offen  lds
    s_add_u32 m0, s51, 3072
    s_movk_i32 s49, 384
    buffer_load_dwordx4 v11, s[4:7], s49 offen  lds
    s_add_u32 m0, s52, 6144
    s_add_u32 s50, s50, s48
    buffer_load_dwordx4 v12, s[8:11], s50 offen  lds
    s_add_u32 m0, s52, 7168
    s_nop 0
    buffer_load_dwordx4 v13, s[8:11], s50 offen  lds
    s_waitcnt vmcnt(12)
    s_barrier
    s_cmp_lg_u32 s61, 3
    s_cbranch_scc1 K_nf_2
    s_and_b32 s40, s37, 3
    s_lshl2_add_u32 s40, s36, s40
    s_lshl_b32 s40, s40, 5
    s_lshr_b32 s41, s37, 3
    s_add_u32 s40, s40, s41
    s_lshl_b32 s40, s40, 2
    s_add_u32 s40, s40, 17301512
    s_mov_b64 exec, 1
    buffer_store_dword v240, off, s[20:23], s40 sc1
    s_mov_b64 exec, -1
K_nf_2:
    s_add_u32 m0, s51, 49152
    s_movk_i32 s49, 512
    buffer_load_dwordx4 v8, s[4:7], s49 offen  lds
    s_add_u32 m0, s52, 49152
    s_add_u32 s50, s50, s48
    buffer_load_dwordx4 v12, s[8:11], s50 offen  lds
    s_add_u32 m0, s52, 50176
    s_nop 0
    buffer_load_dwordx4 v13, s[8:11], s50 offen  lds
    s_add_u32 m0, s51, 50176
    s_movk_i32 s49, 512
    buffer_load_dwordx4 v9, s[4:7], s49 offen  lds
    s_add_u32 m0, s52, 51200
    s_add_u32 s50, s50, s48
    buffer_load_dwordx4 v12, s[8:11], s50 offen  lds
    s_add_u32 m0, s52, 52224
    s_nop 0
    buffer_load_dwordx4 v13, s[8:11], s50 offen  lds
    s_add_u32 m0, s51, 51200
    s_movk_i32 s49, 512
    buffer_load_dwordx4 v10, s[4:7], s49 offen  lds
    s_add_u32 m0, s52, 53248
    s_add_u32 s50, s50, s48
    buffer_load_dwordx4 v12, s[8:11], s50 offen  lds
    s_add_u32 m0, s52, 54272
    s_nop 0
    buffer_load_dwordx4 v13, s[8:11], s50 offen  lds
    s_add_u32 m0, s51, 52224
    s_movk_i32 s49, 512
    buffer_load_dwordx4 v11, s[4:7], s49 offen  lds
    s_add_u32 m0, s52, 55296
    s_add_u32 s50, s50, s48
    buffer_load_dwordx4 v12, s[8:11], s50 offen  lds
    s_add_u32 m0, s52, 56320
    s_nop 0
    buffer_load_dwordx4 v13, s[8:11], s50 offen  lds
    s_mul_i32 s40, s62, 384
    s_mov_b64 exec, 0xffff
    buffer_load_dword v255, v17, s[8:11], s40 offen
    s_mov_b64 exec, -1
    s_mov_b32 exec_hi, 0
    buffer_load_dword v255, v182, s[4:7], 0 offen offset:1024
    s_mov_b32 exec_hi, -1
    s_waitcnt vmcnt(14)
    s_barrier
    s_add_u32 m0, s51, 98304
    s_movk_i32 s49, 640
    buffer_load_dwordx4 v8, s[4:7], s49 offen  lds
    s_add_u32 m0, s52, 98304
    s_add_u32 s50, s50, s48
    buffer_load_dwordx4 v12, s[8:11], s50 offen  lds
    s_add_u32 m0, s52, 99328
    s_nop 0
    buffer_load_dwordx4 v13, s[8:11], s50 offen  lds
    s_waitcnt vmcnt(5)
    s_barrier
    s_add_u32 m0, s51, 99328
    s_movk_i32 s49, 640
    buffer_load_dwordx4 v9, s[4:7], s49 offen  lds
    s_add_u32 m0, s52, 100352
    s_add_u32 s50, s50, s48
    buffer_load_dwordx4 v12, s[8:11], s50 offen  lds
    s_add_u32 m0, s52, 101376
    s_nop 0
    buffer_load_dwordx4 v13, s[8:11], s50 offen  lds
    s_add_u32 m0, s51, 100352
    s_movk_i32 s49, 640
    buffer_load_dwordx4 v10, s[4:7], s49 offen  lds
    s_add_u32 m0, s52, 102400
    s_add_u32 s50, s50, s48
    buffer_load_dwordx4 v12, s[8:11], s50 offen  lds
    s_add_u32 m0, s52, 103424
    s_nop 0
    buffer_load_dwordx4 v13, s[8:11], s50 offen  lds
    s_add_u32 m0, s51, 101376
    s_movk_i32 s49, 640
    buffer_load_dwordx4 v11, s[4:7], s49 offen  lds
    s_add_u32 m0, s52, 104448
    s_add_u32 s50, s50, s48
    buffer_load_dwordx4 v12, s[8:11], s50 offen  lds
    s_add_u32 m0, s52, 105472
    s_nop 0
    buffer_load_dwordx4 v13, s[8:11], s50 offen  lds
    s_add_u32 m0, s51, 0
    s_movk_i32 s49, 768
    buffer_load_dwordx4 v8, s[4:7], s49 offen  lds
    s_add_u32 m0, s52, 0
    s_add_u32 s50, s50, s48
    buffer_load_dwordx4 v12, s[8:11], s50 offen  lds
    s_add_u32 m0, s52, 1024
    s_nop 0
    buffer_load_dwordx4 v13, s[8:11], s50 offen  lds
    s_add_u32 m0, s51, 1024
    s_movk_i32 s49, 768
    buffer_load_dwordx4 v9, s[4:7], s49 offen  lds
    s_add_u32 m0, s52, 2048
    s_add_u32 s50, s50, s48
    buffer_load_dwordx4 v12, s[8:11], s50 offen  lds
    s_add_u32 m0, s52, 3072
    s_nop 0
    buffer_load_dwordx4 v13, s[8:11], s50 offen  lds
    s_add_u32 m0, s51, 2048
    s_movk_i32 s49, 768
    buffer_load_dwordx4 v10, s[4:7], s49 offen  lds
    s_add_u32 m0, s52, 4096
    s_add_u32 s50, s50, s48
    buffer_load_dwordx4 v12, s[8:11], s50 offen  lds
    s_waitcnt vmcnt(8)
    s_barrier
    s_add_u32 m0, s52, 5120
    s_nop 0
    buffer_load_dwordx4 v13, s[8:11], s50 offen  lds
    s_add_u32 m0, s51, 3072
    s_movk_i32 s49, 768
    buffer_load_dwordx4 v11, s[4:7], s49 offen  lds
    s_add_u32 m0, s52, 6144
    s_add_u32 s50, s50, s48
    buffer_load_dwordx4 v12, s[8:11], s50 offen  lds
    s_add_u32 m0, s52, 7168
    s_nop 0
    buffer_load_dwordx4 v13, s[8:11], s50 offen  lds
    s_add_u32 m0, s51, 49152
    s_movk_i32 s49, 896
    buffer_load_dwordx4 v8, s[4:7], s49 offen  lds
    s_add_u32 m0, s52, 49152
    s_add_u32 s50, s50, s48
    buffer_load_dwordx4 v12, s[8:11], s50 offen  lds
    s_add_u32 m0, s52, 50176
    s_nop 0
    buffer_load_dwordx4 v13, s[8:11], s50 offen  lds
    s_add_u32 m0, s51, 50176
    s_movk_i32 s49, 896
    buffer_load_dwordx4 v9, s[4:7], s49 offen  lds
    s_add_u32 m0, s52, 51200
    s_add_u32 s50, s50, s48
    buffer_load_dwordx4 v12, s[8:11], s50 offen  lds
    s_add_u32 m0, s52, 52224
    s_nop 0
    buffer_load_dwordx4 v13, s[8:11], s50 offen  lds
    s_add_u32 m0, s51, 51200
    s_movk_i32 s49, 896
    buffer_load_dwordx4 v10, s[4:7], s49 offen  lds
    s_add_u32 m0, s52, 53248
    s_add_u32 s50, s50, s48
    buffer_load_dwordx4 v12, s[8:11], s50 offen  lds
    s_add_u32 m0, s52, 54272
    s_nop 0
    buffer_load_dwordx4 v13, s[8:11], s50 offen  lds
    s_add_u32 m0, s51, 52224
    s_movk_i32 s49, 896
    buffer_load_dwordx4 v11, s[4:7], s49 offen  lds
    s_add_u32 m0, s52, 55296
    s_add_u32 s50, s50, s48
    buffer_load_dwordx4 v12, s[8:11], s50 offen  lds
    s_add_u32 m0, s52, 56320
    s_nop 0
    buffer_load_dwordx4 v13, s[8:11], s50 offen  lds
    s_waitcnt vmcnt(12)
    s_barrier
    s_add_u32 m0, s51, 98304
    s_movk_i32 s49, 1024
    buffer_load_dwordx4 v8, s[4:7], s49 offen  lds
    s_add_u32 m0, s52, 98304
    s_add_u32 s50, s50, s48
    buffer_load_dwordx4 v12, s[8:11], s50 offen  lds
    s_add_u32 m0, s52, 99328
    s_nop 0
    buffer_load_dwordx4 v13, s[8:11], s50 offen  lds
    s_add_u32 m0, s51, 99328
    s_movk_i32 s49, 1024
    buffer_load_dwordx4 v9, s[4:7], s49 offen  lds
    s_add_u32 m0, s52, 100352
    s_add_u32 s50, s50, s48
    buffer_load_dwordx4 v12, s[8:11], s50 offen  lds
    s_add_u32 m0, s52, 101376
    s_nop 0
    buffer_load_dwordx4 v13, s[8:11], s50 offen  lds
    s_add_u32 m0, s51, 100352
    s_movk_i32 s49, 1024
    buffer_load_dwordx4 v10, s[4:7], s49 offen  lds
    s_add_u32 m0, s52, 102400
    s_add_u32 s50, s50, s48
    buffer_load_dwordx4 v12, s[8:11], s50 offen  lds
    s_add_u32 m0, s52, 103424
    s_nop 0
    buffer_load_dwordx4 v13, s[8:11], s50 offen  lds
    s_add_u32 m0, s51, 101376
    s_movk_i32 s49, 1024
    buffer_load_dwordx4 v11, s[4:7], s49 offen  lds
    s_add_u32 m0, s52, 104448
    s_add_u32 s50, s50, s48
    buffer_load_dwordx4 v12, s[8:11], s50 offen  lds
    s_add_u32 m0, s52, 105472
    s_nop 0
    buffer_load_dwordx4 v13, s[8:11], s50 offen  lds
    s_mul_i32 s40, s62, 640
    s_mov_b64 exec, 0
    s_mov_b32 exec_lo, -1
    s_mov_b32 exec_hi, 0x0
    buffer_load_dword v255, v17, s[8:11], s40 offen
    s_mov_b64 exec, -1
    s_waitcnt vmcnt(13)
    s_barrier
    s_add_u32 m0, s51, 0
    s_movk_i32 s49, 1152
    buffer_load_dwordx4 v8, s[4:7], s49 offen  lds
    s_add_u32 m0, s52, 0
    s_add_u32 s50, s50, s48
    buffer_load_dwordx4 v12, s[8:11], s50 offen  lds
    s_add_u32 m0, s52, 1024
    s_nop 0
    buffer_load_dwordx4 v13, s[8:11], s50 offen  lds
    s_waitcnt vmcnt(4)
    s_barrier
    s_add_u32 m0, s51, 1024
    s_movk_i32 s49, 1152
    buffer_load_dwordx4 v9, s[4:7], s49 offen  lds
    s_add_u32 m0, s52, 2048
    s_add_u32 s50, s50, s48
    buffer_load_dwordx4 v12, s[8:11], s50 offen  lds
    s_add_u32 m0, s52, 3072
    s_nop 0
    buffer_load_dwordx4 v13, s[8:11], s50 offen  lds
    s_add_u32 m0, s51, 2048
    s_movk_i32 s49, 1152
    buffer_load_dwordx4 v10, s[4:7], s49 offen  lds
    s_add_u32 m0, s52, 4096
    s_add_u32 s50, s50, s48
    buffer_load_dwordx4 v12, s[8:11], s50 offen  lds
    s_add_u32 m0, s52, 5120
    s_nop 0
    buffer_load_dwordx4 v13, s[8:11], s50 offen  lds
    s_add_u32 m0, s51, 3072
    s_movk_i32 s49, 1152
    buffer_load_dwordx4 v11, s[4:7], s49 offen  lds
    s_add_u32 m0, s52, 6144
    s_add_u32 s50, s50, s48
    buffer_load_dwordx4 v12, s[8:11], s50 offen  lds
    s_add_u32 m0, s52, 7168
    s_nop 0
    buffer_load_dwordx4 v13, s[8:11], s50 offen  lds
    s_add_u32 m0, s51, 49152
    s_movk_i32 s49, 1280
    buffer_load_dwordx4 v8, s[4:7], s49 offen  lds
    s_add_u32 m0, s52, 49152
    s_add_u32 s50, s50, s48
    buffer_load_dwordx4 v12, s[8:11], s50 offen  lds
    s_add_u32 m0, s52, 50176
    s_nop 0
    buffer_load_dwordx4 v13, s[8:11], s50 offen  lds
    s_add_u32 m0, s51, 50176
    s_movk_i32 s49, 1280
    buffer_load_dwordx4 v9, s[4:7], s49 offen  lds
    s_add_u32 m0, s52, 51200
    s_add_u32 s50, s50, s48
    buffer_load_dwordx4 v12, s[8:11], s50 offen  lds
    s_add_u32 m0, s52, 52224
    s_nop 0
    buffer_load_dwordx4 v13, s[8:11], s50 offen  lds
    s_add_u32 m0, s51, 51200
    s_movk_i32 s49, 1280
    buffer_load_dwordx4 v10, s[4:7], s49 offen  lds
    s_add_u32 m0, s52, 53248
    s_add_u32 s50, s50, s48
    buffer_load_dwordx4 v12, s[8:11], s50 offen  lds
    s_waitcnt vmcnt(8)
    s_barrier
    s_add_u32 m0, s52, 54272
    s_nop 0
    buffer_load_dwordx4 v13, s[8:11], s50 offen  lds
    s_add_u32 m0, s51, 52224
    s_movk_i32 s49, 1280
    buffer_load_dwordx4 v11, s[4:7], s49 offen  lds
    s_add_u32 m0, s52, 55296
    s_add_u32 s50, s50, s48
    buffer_load_dwordx4 v12, s[8:11], s50 offen  lds
    s_add_u32 m0, s52, 56320
    s_nop 0
    buffer_load_dwordx4 v13, s[8:11], s50 offen  lds
    s_add_u32 m0, s51, 98304
    s_movk_i32 s49, 1408
    buffer_load_dwordx4 v8, s[4:7], s49 offen  lds
    s_add_u32 m0, s52, 98304
    s_add_u32 s50, s50, s48
    buffer_load_dwordx4 v12, s[8:11], s50 offen  lds
    s_add_u32 m0, s52, 99328
    s_nop 0
    buffer_load_dwordx4 v13, s[8:11], s50 offen  lds
    s_add_u32 m0, s51, 99328
    s_movk_i32 s49, 1408
    buffer_load_dwordx4 v9, s[4:7], s49 offen  lds
    s_add_u32 m0, s52, 100352
    s_add_u32 s50, s50, s48
    buffer_load_dwordx4 v12, s[8:11], s50 offen  lds
    s_add_u32 m0, s52, 101376
    s_nop 0
    buffer_load_dwordx4 v13, s[8:11], s50 offen  lds
    s_add_u32 m0, s51, 100352
    s_movk_i32 s49, 1408
    buffer_load_dwordx4 v10, s[4:7], s49 offen  lds
    s_add_u32 m0, s52, 102400
    s_add_u32 s50, s50, s48
    buffer_load_dwordx4 v12, s[8:11], s50 offen  lds
    s_add_u32 m0, s52, 103424
    s_nop 0
    buffer_load_dwordx4 v13, s[8:11], s50 offen  lds
    s_add_u32 m0, s51, 101376
    s_movk_i32 s49, 1408
    buffer_load_dwordx4 v11, s[4:7], s49 offen  lds
    s_add_u32 m0, s52, 104448
    s_add_u32 s50, s50, s48
    buffer_load_dwordx4 v12, s[8:11], s50 offen  lds
    s_add_u32 m0, s52, 105472
    s_nop 0
    buffer_load_dwordx4 v13, s[8:11], s50 offen  lds
    s_waitcnt vmcnt(12)
    s_barrier
    s_add_u32 m0, s51, 0
    s_movk_i32 s49, 1536
    buffer_load_dwordx4 v8, s[4:7], s49 offen  lds
    s_add_u32 m0, s52, 0
    s_add_u32 s50, s50, s48
    buffer_load_dwordx4 v12, s[8:11], s50 offen  lds
    s_add_u32 m0, s52, 1024
    s_nop 0
    buffer_load_dwordx4 v13, s[8:11], s50 offen  lds
    s_add_u32 m0, s51, 1024
    s_movk_i32 s49, 1536
    buffer_load_dwordx4 v9, s[4:7], s49 offen  lds
    s_add_u32 m0, s52, 2048
    s_add_u32 s50, s50, s48
    buffer_load_dwordx4 v12, s[8:11], s50 offen  lds
    s_add_u32 m0, s52, 3072
    s_nop 0
    buffer_load_dwordx4 v13, s[8:11], s50 offen  lds
    s_add_u32 m0, s51, 2048
    s_movk_i32 s49, 1536
    buffer_load_dwordx4 v10, s[4:7], s49 offen  lds
    s_add_u32 m0, s52, 4096
    s_add_u32 s50, s50, s48
    buffer_load_dwordx4 v12, s[8:11], s50 offen  lds
    s_add_u32 m0, s52, 5120
    s_nop 0
    buffer_load_dwordx4 v13, s[8:11], s50 offen  lds
    s_add_u32 m0, s51, 3072
    s_movk_i32 s49, 1536
    buffer_load_dwordx4 v11, s[4:7], s49 offen  lds
    s_add_u32 m0, s52, 6144
    s_add_u32 s50, s50, s48
    buffer_load_dwordx4 v12, s[8:11], s50 offen  lds
    s_add_u32 m0, s52, 7168
    s_nop 0
    buffer_load_dwordx4 v13, s[8:11], s50 offen  lds
    s_waitcnt vmcnt(12)
    s_barrier
    s_add_u32 m0, s51, 49152
    s_movk_i32 s49, 1664
    buffer_load_dwordx4 v8, s[4:7], s49 offen  lds
    s_add_u32 m0, s52, 49152
    s_add_u32 s50, s50, s48
    buffer_load_dwordx4 v12, s[8:11], s50 offen  lds
    s_add_u32 m0, s52, 50176
    s_nop 0
    buffer_load_dwordx4 v13, s[8:11], s50 offen  lds
    s_add_u32 m0, s51, 50176
    s_movk_i32 s49, 1664
    buffer_load_dwordx4 v9, s[4:7], s49 offen  lds
    s_add_u32 m0, s52, 51200
    s_add_u32 s50, s50, s48
    buffer_load_dwordx4 v12, s[8:11], s50 offen  lds
    s_add_u32 m0, s52, 52224
    s_nop 0
    buffer_load_dwordx4 v13, s[8:11], s50 offen  lds
    s_add_u32 m0, s51, 51200
    s_movk_i32 s49, 1664
    buffer_load_dwordx4 v10, s[4:7], s49 offen  lds
    s_add_u32 m0, s52, 53248
    s_add_u32 s50, s50, s48
    buffer_load_dwordx4 v12, s[8:11], s50 offen  lds
    s_add_u32 m0, s52, 54272
    s_nop 0
    buffer_load_dwordx4 v13, s[8:11], s50 offen  lds
    s_add_u32 m0, s51, 52224
    s_movk_i32 s49, 1664
    buffer_load_dwordx4 v11, s[4:7], s49 offen  lds
    s_add_u32 m0, s52, 55296
    s_add_u32 s50, s50, s48
    buffer_load_dwordx4 v12, s[8:11], s50 offen  lds
    s_add_u32 m0, s52, 56320
    s_nop 0
    buffer_load_dwordx4 v13, s[8:11], s50 offen  lds
    s_waitcnt vmcnt(12)
    s_barrier
    s_add_u32 m0, s51, 98304
    s_movk_i32 s49, 1792
    buffer_load_dwordx4 v8, s[4:7], s49 offen  lds
    s_add_u32 m0, s52, 98304
    s_add_u32 s50, s50, s48
    buffer_load_dwordx4 v12, s[8:11], s50 offen  lds
    s_add_u32 m0, s52, 99328
    s_nop 0
    buffer_load_dwordx4 v13, s[8:11], s50 offen  lds
    s_add_u32 m0, s51, 99328
    s_movk_i32 s49, 1792
    buffer_load_dwordx4 v9, s[4:7], s49 offen  lds
    s_add_u32 m0, s52, 100352
    s_add_u32 s50, s50, s48
    buffer_load_dwordx4 v12, s[8:11], s50 offen  lds
    s_add_u32 m0, s52, 101376
    s_nop 0
    buffer_load_dwordx4 v13, s[8:11], s50 offen  lds
    s_add_u32 m0, s51, 100352
    s_movk_i32 s49, 1792
    buffer_load_dwordx4 v10, s[4:7], s49 offen  lds
    s_add_u32 m0, s52, 102400
    s_add_u32 s50, s50, s48
    buffer_load_dwordx4 v12, s[8:11], s50 offen  lds
    s_add_u32 m0, s52, 103424
    s_nop 0
    buffer_load_dwordx4 v13, s[8:11], s50 offen  lds
    s_add_u32 m0, s51, 101376
    s_movk_i32 s49, 1792
    buffer_load_dwordx4 v11, s[4:7], s49 offen  lds
    s_add_u32 m0, s52, 104448
    s_add_u32 s50, s50, s48
    buffer_load_dwordx4 v12, s[8:11], s50 offen  lds
    s_add_u32 m0, s52, 105472
    s_nop 0
    buffer_load_dwordx4 v13, s[8:11], s50 offen  lds
    s_waitcnt vmcnt(12)
    s_barrier
    s_add_u32 m0, s51, 0
    s_movk_i32 s49, 1920
    buffer_load_dwordx4 v8, s[4:7], s49 offen  lds
    s_add_u32 m0, s52, 0
    s_add_u32 s50, s50, s48
    buffer_load_dwordx4 v12, s[8:11], s50 offen  lds
    s_add_u32 m0, s52, 1024
    s_nop 0
    buffer_load_dwordx4 v13, s[8:11], s50 offen  lds
    s_add_u32 m0, s51, 1024
    s_movk_i32 s49, 1920
    buffer_load_dwordx4 v9, s[4:7], s49 offen  lds
    s_add_u32 m0, s52, 2048
    s_add_u32 s50, s50, s48
    buffer_load_dwordx4 v12, s[8:11], s50 offen  lds
    s_add_u32 m0, s52, 3072
    s_nop 0
    buffer_load_dwordx4 v13, s[8:11], s50 offen  lds
    s_add_u32 m0, s51, 2048
    s_movk_i32 s49, 1920
    buffer_load_dwordx4 v10, s[4:7], s49 offen  lds
    s_add_u32 m0, s52, 4096
    s_add_u32 s50, s50, s48
    buffer_load_dwordx4 v12, s[8:11], s50 offen  lds
    s_add_u32 m0, s52, 5120
    s_nop 0
    buffer_load_dwordx4 v13, s[8:11], s50 offen  lds
    s_add_u32 m0, s51, 3072
    s_movk_i32 s49, 1920
    buffer_load_dwordx4 v11, s[4:7], s49 offen  lds
    s_add_u32 m0, s52, 6144
    s_add_u32 s50, s50, s48
    buffer_load_dwordx4 v12, s[8:11], s50 offen  lds
    s_add_u32 m0, s52, 7168
    s_nop 0
    buffer_load_dwordx4 v13, s[8:11], s50 offen  lds
    s_waitcnt vmcnt(12)
    s_branch K_phend
K_ph0_2:
    s_barrier
    s_add_u32 m0, s52, 54272
    s_nop 0
    buffer_load_dwordx4 v13, s[8:11], s50 offen  lds
    s_add_u32 m0, s51, 52224
    s_movk_i32 s49, 128
    buffer_load_dwordx4 v11, s[4:7], s49 offen  lds
    s_add_u32 m0, s52, 55296
    s_add_u32 s50, s50, s48
    buffer_load_dwordx4 v12, s[8:11], s50 offen  lds
    s_add_u32 m0, s52, 56320
    s_nop 0
    buffer_load_dwordx4 v13, s[8:11], s50 offen  lds
    s_add_u32 m0, s51, 98304
    s_movk_i32 s49, 256
    buffer_load_dwordx4 v8, s[4:7], s49 offen  lds
    s_add_u32 m0, s52, 98304
    s_add_u32 s50, s50, s48
    buffer_load_dwordx4 v12, s[8:11], s50 offen  lds
    s_add_u32 m0, s52, 99328
    s_nop 0
    buffer_load_dwordx4 v13, s[8:11], s50 offen  lds
    s_add_u32 m0, s51, 99328
    s_movk_i32 s49, 256
    buffer_load_dwordx4 v9, s[4:7], s49 offen  lds
    s_add_u32 m0, s52, 100352
    s_add_u32 s50, s50, s48
    buffer_load_dwordx4 v12, s[8:11], s50 offen  lds
    s_add_u32 m0, s52, 101376
    s_nop 0
    buffer_load_dwordx4 v13, s[8:11], s50 offen  lds
    s_add_u32 m0, s51, 100352
    s_movk_i32 s49, 256
    buffer_load_dwordx4 v10, s[4:7], s49 offen  lds
    s_add_u32 m0, s52, 102400
    s_add_u32 s50, s50, s48
    buffer_load_dwordx4 v12, s[8:11], s50 offen  lds
    s_add_u32 m0, s52, 103424
    s_nop 0
    buffer_load_dwordx4 v13, s[8:11], s50 offen  lds
    s_add_u32 m0, s51, 101376
    s_movk_i32 s49, 256
    buffer_load_dwordx4 v11, s[4:7], s49 offen  lds
    s_add_u32 m0, s52, 104448
    s_add_u32 s50, s50, s48
    buffer_load_dwordx4 v12, s[8:11], s50 offen  lds
    s_add_u32 m0, s52, 105472
    s_nop 0
    buffer_load_dwordx4 v13, s[8:11], s50 offen  lds
    s_waitcnt vmcnt(12)
    s_barrier
    s_add_u32 m0, s51, 0
    s_movk_i32 s49, 384
    buffer_load_dwordx4 v8, s[4:7], s49 offen  lds
    s_add_u32 m0, s52, 0
    s_add_u32 s50, s50, s48
    buffer_load_dwordx4 v12, s[8:11], s50 offen  lds
    s_add_u32 m0, s52, 1024
    s_nop 0
    buffer_load_dwordx4 v13, s[8:11], s50 offen  lds
    s_add_u32 m0, s51, 1024
    s_movk_i32 s49, 384
    buffer_load_dwordx4 v9, s[4:7], s49 offen  lds
    s_add_u32 m0, s52, 2048
    s_add_u32 s50, s50, s48
    buffer_load_dwordx4 v12, s[8:11], s50 offen  lds
    s_add_u32 m0, s52, 3072
    s_nop 0
    buffer_load_dwordx4 v13, s[8:11], s50 offen  lds
    s_add_u32 m0, s51, 2048
    s_movk_i32 s49, 384
    buffer_load_dwordx4 v10, s[4:7], s49 offen  lds
    s_add_u32 m0, s52, 4096
    s_add_u32 s50, s50, s48
    buffer_load_dwordx4 v12, s[8:11], s50 offen  lds
    s_add_u32 m0, s52, 5120
    s_nop 0
    buffer_load_dwordx4 v13, s[8:11], s50 offen  lds
    s_add_u32 m0, s51, 3072
    s_movk_i32 s49, 384
    buffer_load_dwordx4 v11, s[4:7], s49 offen  lds
    s_add_u32 m0, s52, 6144
    s_add_u32 s50, s50, s48
    buffer_load_dwordx4 v12, s[8:11], s50 offen  lds
    s_add_u32 m0, s52, 7168
    s_nop 0
    buffer_load_dwordx4 v13, s[8:11], s50 offen  lds
    s_waitcnt vmcnt(12)
    s_barrier
    s_cmp_lg_u32 s61, 3
    s_cbranch_scc1 K_nf_3
    s_and_b32 s40, s37, 3
    s_lshl2_add_u32 s40, s36, s40
    s_lshl_b32 s40, s40, 5
    s_lshr_b32 s41, s37, 3
    s_add_u32 s40, s40, s41
    s_lshl_b32 s40, s40, 2
    s_add_u32 s40, s40, 17301512
    s_mov_b64 exec, 1
    buffer_store_dword v240, off, s[20:23], s40 sc1
    s_mov_b64 exec, -1
K_nf_3:
    s_add_u32 m0, s51, 49152
    s_movk_i32 s49, 512
    buffer_load_dwordx4 v8, s[4:7], s49 offen  lds
    s_add_u32 m0, s52, 49152
    s_add_u32 s50, s50, s48
    buffer_load_dwordx4 v12, s[8:11], s50 offen  lds
    s_add_u32 m0, s52, 50176
    s_nop 0
    buffer_load_dwordx4 v13, s[8:11], s50 offen  lds
    s_add_u32 m0, s51, 50176
    s_movk_i32 s49, 512
    buffer_load_dwordx4 v9, s[4:7], s49 offen  lds
    s_add_u32 m0, s52, 51200
    s_add_u32 s50, s50, s48
    buffer_load_dwordx4 v12, s[8:11], s50 offen  lds
    s_add_u32 m0, s52, 52224
    s_nop 0
    buffer_load_dwordx4 v13, s[8:11], s50 offen  lds
    s_add_u32 m0, s51, 51200
    s_movk_i32 s49, 512
    buffer_load_dwordx4 v10, s[4:7], s49 offen  lds
    s_add_u32 m0, s52, 53248
    s_add_u32 s50, s50, s48
    buffer_load_dwordx4 v12, s[8:11], s50 offen  lds
    s_add_u32 m0, s52, 54272
    s_nop 0
    buffer_load_dwordx4 v13, s[8:11], s50 offen  lds
    s_add_u32 m0, s51, 52224
    s_movk_i32 s49, 512
    buffer_load_dwordx4 v11, s[4:7], s49 offen  lds
    s_add_u32 m0, s52, 55296
    s_add_u32 s50, s50, s48
    buffer_load_dwordx4 v12, s[8:11], s50 offen  lds
    s_add_u32 m0, s52, 56320
    s_nop 0
    buffer_load_dwordx4 v13, s[8:11], s50 offen  lds
    s_waitcnt vmcnt(12)
    s_barrier
    s_add_u32 m0, s51, 98304
    s_movk_i32 s49, 640
    buffer_load_dwordx4 v8, s[4:7], s49 offen  lds
    s_add_u32 m0, s52, 98304
    s_add_u32 s50, s50, s48
    buffer_load_dwordx4 v12, s[8:11], s50 offen  lds
    s_add_u32 m0, s52, 99328
    s_nop 0
    buffer_load_dwordx4 v13, s[8:11], s50 offen  lds
    s_add_u32 m0, s51, 99328
    s_movk_i32 s49, 640
    buffer_load_dwordx4 v9, s[4:7], s49 offen  lds
    s_add_u32 m0, s52, 100352
    s_add_u32 s50, s50, s48
    buffer_load_dwordx4 v12, s[8:11], s50 offen  lds
    s_add_u32 m0, s52, 101376
    s_nop 0
    buffer_load_dwordx4 v13, s[8:11], s50 offen  lds
    s_add_u32 m0, s51, 100352
    s_movk_i32 s49, 640
    buffer_load_dwordx4 v10, s[4:7], s49 offen  lds
    s_add_u32 m0, s52, 102400
    s_add_u32 s50, s50, s48
    buffer_load_dwordx4 v12, s[8:11], s50 offen  lds
    s_add_u32 m0, s52, 103424
    s_nop 0
    buffer_load_dwordx4 v13, s[8:11], s50 offen  lds
    s_add_u32 m0, s51, 101376
    s_movk_i32 s49, 640
    buffer_load_dwordx4 v11, s[4:7], s49 offen  lds
    s_add_u32 m0, s52, 104448
    s_add_u32 s50, s50, s48
    buffer_load_dwordx4 v12, s[8:11], s50 offen  lds
    s_add_u32 m0, s52, 105472
    s_nop 0
    buffer_load_dwordx4 v13, s[8:11], s50 offen  lds
    s_mul_i32 s40, s62, 448
    s_mov_b64 exec, 0xffff
    buffer_load_dword v255, v17, s[8:11], s40 offen
    s_mov_b64 exec, -1
    s_mov_b32 exec_hi, 0
    buffer_load_dword v255, v182, s[4:7], 0 offen offset:1024
    s_mov_b32 exec_hi, -1
    s_waitcnt vmcnt(14)
    s_barrier
    s_add_u32 m0, s51, 0
    s_movk_i32 s49, 768
    buffer_load_dwordx4 v8, s[4:7], s49 offen  lds
    s_add_u32 m0, s52, 0
    s_add_u32 s50, s50, s48
    buffer_load_dwordx4 v12, s[8:11], s50 offen  lds
    s_add_u32 m0, s52, 1024
    s_nop 0
    buffer_load_dwordx4 v13, s[8:11], s50 offen  lds
    s_waitcnt vmcnt(5)
    s_barrier
    s_add_u32 m0, s51, 1024
    s_movk_i32 s49, 768
    buffer_load_dwordx4 v9, s[4:7], s49 offen  lds
    s_add_u32 m0, s52, 2048
    s_add_u32 s50, s50, s48
    buffer_load_dwordx4 v12, s[8:11], s50 offen  lds
    s_add_u32 m0, s52, 3072
    s_nop 0
    buffer_load_dwordx4 v13, s[8:11], s50 offen  lds
    s_add_u32 m0, s51, 2048
    s_movk_i32 s49, 768
    buffer_load_dwordx4 v10, s[4:7], s49 offen  lds
    s_add_u32 m0, s52, 4096
    s_add_u32 s50, s50, s48
    buffer_load_dwordx4 v12, s[8:11], s50 offen  lds
    s_add_u32 m0, s52, 5120
    s_nop 0
    buffer_load_dwordx4 v13, s[8:11], s50 offen  lds
    s_add_u32 m0, s51, 3072
    s_movk_i32 s49, 768
    buffer_load_dwordx4 v11, s[4:7], s49 offen  lds
    s_add_u32 m0, s52, 6144
    s_add_u32 s50, s50, s48
    buffer_load_dwordx4 v12, s[8:11], s50 offen  lds
    s_add_u32 m0, s52, 7168
    s_nop 0
    buffer_load_dwordx4 v13, s[8:11], s50 offen  lds
    s_add_u32 m0, s51, 49152
    s_movk_i32 s49, 896
    buffer_load_dwordx4 v8, s[4:7], s49 offen  lds
    s_add_u32 m0, s52, 49152
    s_add_u32 s50, s50, s48
    buffer_load_dwordx4 v12, s[8:11], s50 offen  lds
    s_add_u32 m0, s52, 50176
    s_nop 0
    buffer_load_dwordx4 v13, s[8:11], s50 offen  lds
    s_add_u32 m0, s51, 50176
    s_movk_i32 s49, 896
    buffer_load_dwordx4 v9, s[4:7], s49 offen  lds
    s_add_u32 m0, s52, 51200
    s_add_u32 s50, s50, s48
    buffer_load_dwordx4 v12, s[8:11], s50 offen  lds
    s_add_u32 m0, s52, 52224
    s_nop 0
    buffer_load_dwordx4 v13, s[8:11], s50 offen  lds
    s_add_u32 m0, s51, 51200
    s_movk_i32 s49, 896
    buffer_load_dwordx4 v10, s[4:7], s49 offen  lds
    s_add_u32 m0, s52, 53248
    s_add_u32 s50, s50, s48
    buffer_load_dwordx4 v12, s[8:11], s50 offen  lds
    s_waitcnt vmcnt(8)
    s_barrier
    s_add_u32 m0, s52, 54272
    s_nop 0
    buffer_load_dwordx4 v13, s[8:11], s50 offen  lds
    s_add_u32 m0, s51, 52224
    s_movk_i32 s49, 896
    buffer_load_dwordx4 v11, s[4:7], s49 offen  lds
    s_add_u32 m0, s52, 55296
    s_add_u32 s50, s50, s48
    buffer_load_dwordx4 v12, s[8:11], s50 offen  lds
    s_add_u32 m0, s52, 56320
    s_nop 0
    buffer_load_dwordx4 v13, s[8:11], s50 offen  lds
    s_add_u32 m0, s51, 98304
    s_movk_i32 s49, 1024
    buffer_load_dwordx4 v8, s[4:7], s49 offen  lds
    s_add_u32 m0, s52, 98304
    s_add_u32 s50, s50, s48
    buffer_load_dwordx4 v12, s[8:11], s50 offen  lds
    s_add_u32 m0, s52, 99328
    s_nop 0
    buffer_load_dwordx4 v13, s[8:11], s50 offen  lds
    s_add_u32 m0, s51, 99328
    s_movk_i32 s49, 1024
    buffer_load_dwordx4 v9, s[4:7], s49 offen  lds
    s_add_u32 m0, s52, 100352
    s_add_u32 s50, s50, s48
    buffer_load_dwordx4 v12, s[8:11], s50 offen  lds
    s_add_u32 m0, s52, 101376
    s_nop 0
    buffer_load_dwordx4 v13, s[8:11], s50 offen  lds
    s_add_u32 m0, s51, 100352
    s_movk_i32 s49, 1024
    buffer_load_dwordx4 v10, s[4:7], s49 offen  lds
    s_add_u32 m0, s52, 102400
    s_add_u32 s50, s50, s48
    buffer_load_dwordx4 v12, s[8:11], s50 offen  lds
    s_add_u32 m0, s52, 103424
    s_nop 0
    buffer_load_dwordx4 v13, s[8:11], s50 offen  lds
    s_add_u32 m0, s51, 101376
    s_movk_i32 s49, 1024
    buffer_load_dwordx4 v11, s[4:7], s49 offen  lds
    s_add_u32 m0, s52, 104448
    s_add_u32 s50, s50, s48
    buffer_load_dwordx4 v12, s[8:11], s50 offen  lds
    s_add_u32 m0, s52, 105472
    s_nop 0
    buffer_load_dwordx4 v13, s[8:11], s50 offen  lds
    s_waitcnt vmcnt(12)
    s_barrier
    s_add_u32 m0, s51, 0
    s_movk_i32 s49, 1152
    buffer_load_dwordx4 v8, s[4:7], s49 offen  lds
    s_add_u32 m0, s52, 0
    s_add_u32 s50, s50, s48
    buffer_load_dwordx4 v12, s[8:11], s50 offen  lds
    s_add_u32 m0, s52, 1024
    s_nop 0
    buffer_load_dwordx4 v13, s[8:11], s50 offen  lds
    s_add_u32 m0, s51, 1024
    s_movk_i32 s49, 1152
    buffer_load_dwordx4 v9, s[4:7], s49 offen  lds
    s_add_u32 m0, s52, 2048
    s_add_u32 s50, s50, s48
    buffer_load_dwordx4 v12, s[8:11], s50 offen  lds
    s_add_u32 m0, s52, 3072
    s_nop 0
    buffer_load_dwordx4 v13, s[8:11], s50 offen  lds
    s_add_u32 m0, s51, 2048
    s_movk_i32 s49, 1152
    buffer_load_dwordx4 v10, s[4:7], s49 offen  lds
    s_add_u32 m0, s52, 4096
    s_add_u32 s50, s50, s48
    buffer_load_dwordx4 v12, s[8:11], s50 offen  lds
    s_add_u32 m0, s52, 5120
    s_nop 0
    buffer_load_dwordx4 v13, s[8:11], s50 offen  lds
    s_add_u32 m0, s51, 3072
    s_movk_i32 s49, 1152
    buffer_load_dwordx4 v11, s[4:7], s49 offen  lds
    s_add_u32 m0, s52, 6144
    s_add_u32 s50, s50, s48
    buffer_load_dwordx4 v12, s[8:11], s50 offen  lds
    s_add_u32 m0, s52, 7168
    s_nop 0
    buffer_load_dwordx4 v13, s[8:11], s50 offen  lds
    s_mul_i32 s40, s62, 704
    s_mov_b64 exec, 0
    s_mov_b32 exec_lo, -1
    s_mov_b32 exec_hi, 0x0
    buffer_load_dword v255, v17, s[8:11], s40 offen
    s_mov_b64 exec, -1
    s_waitcnt vmcnt(13)
    s_barrier
    s_add_u32 m0, s51, 49152
    s_movk_i32 s49, 1280
    buffer_load_dwordx4 v8, s[4:7], s49 offen  lds
    s_add_u32 m0, s52, 49152
    s_add_u32 s50, s50, s48
    buffer_load_dwordx4 v12, s[8:11], s50 offen  lds
    s_add_u32 m0, s52, 50176
    s_nop 0
    buffer_load_dwordx4 v13, s[8:11], s50 offen  lds
    s_waitcnt vmcnt(4)
    s_barrier
    s_add_u32 m0, s51, 50176
    s_movk_i32 s49, 1280
    buffer_load_dwordx4 v9, s[4:7], s49 offen  lds
    s_add_u32 m0, s52, 51200
    s_add_u32 s50, s50, s48
    buffer_load_dwordx4 v12, s[8:11], s50 offen  lds
    s_add_u32 m0, s52, 52224
    s_nop 0
    buffer_load_dwordx4 v13, s[8:11], s50 offen  lds
    s_add_u32 m0, s51, 51200
    s_movk_i32 s49, 1280
    buffer_load_dwordx4 v10, s[4:7], s49 offen  lds
    s_add_u32 m0, s52, 53248
    s_add_u32 s50, s50, s48
    buffer_load_dwordx4 v12, s[8:11], s50 offen  lds
    s_add_u32 m0, s52, 54272
    s_nop 0
    buffer_load_dwordx4 v13, s[8:11], s50 offen  lds
    s_add_u32 m0, s51, 52224
    s_movk_i32 s49, 1280
    buffer_load_dwordx4 v11, s[4:7], s49 offen  lds
    s_add_u32 m0, s52, 55296
    s_add_u32 s50, s50, s48
    buffer_load_dwordx4 v12, s[8:11], s50 offen  lds
    s_add_u32 m0, s52, 56320
    s_nop 0
    buffer_load_dwordx4 v13, s[8:11], s50 offen  lds
    s_add_u32 m0, s51, 98304
    s_movk_i32 s49, 1408
    buffer_load_dwordx4 v8, s[4:7], s49 offen  lds
    s_add_u32 m0, s52, 98304
    s_add_u32 s50, s50, s48
    buffer_load_dwordx4 v12, s[8:11], s50 offen  lds
    s_add_u32 m0, s52, 99328
    s_nop 0
    buffer_load_dwordx4 v13, s[8:11], s50 offen  lds
    s_add_u32 m0, s51, 99328
    s_movk_i32 s49, 1408
    buffer_load_dwordx4 v9, s[4:7], s49 offen  lds
    s_add_u32 m0, s52, 100352
    s_add_u32 s50, s50, s48
    buffer_load_dwordx4 v12, s[8:11], s50 offen  lds
    s_add_u32 m0, s52, 101376
    s_nop 0
    buffer_load_dwordx4 v13, s[8:11], s50 offen  lds
    s_add_u32 m0, s51, 100352
    s_movk_i32 s49, 1408
    buffer_load_dwordx4 v10, s[4:7], s49 offen  lds
    s_add_u32 m0, s52, 102400
    s_add_u32 s50, s50, s48
    buffer_load_dwordx4 v12, s[8:11], s50 offen  lds
    s_waitcnt vmcnt(8)
    s_barrier
    s_add_u32 m0, s52, 103424
    s_nop 0
    buffer_load_dwordx4 v13, s[8:11], s50 offen  lds
    s_add_u32 m0, s51, 101376
    s_movk_i32 s49, 1408
    buffer_load_dwordx4 v11, s[4:7], s49 offen  lds
    s_add_u32 m0, s52, 104448
    s_add_u32 s50, s50, s48
    buffer_load_dwordx4 v12, s[8:11], s50 offen  lds
    s_add_u32 m0, s52, 105472
    s_nop 0
    buffer_load_dwordx4 v13, s[8:11], s50 offen  lds
    s_add_u32 m0, s51, 0
    s_movk_i32 s49, 1536
    buffer_load_dwordx4 v8, s[4:7], s49 offen  lds
    s_add_u32 m0, s52, 0
    s_add_u32 s50, s50, s48
    buffer_load_dwordx4 v12, s[8:11], s50 offen  lds
    s_add_u32 m0, s52, 1024
    s_nop 0
    buffer_load_dwordx4 v13, s[8:11], s50 offen  lds
    s_add_u32 m0, s51, 1024
    s_movk_i32 s49, 1536
    buffer_load_dwordx4 v9, s[4:7], s49 offen  lds
    s_add_u32 m0, s52, 2048
    s_add_u32 s50, s50, s48
    buffer_load_dwordx4 v12, s[8:11], s50 offen  lds
    s_add_u32 m0, s52, 3072
    s_nop 0
    buffer_load_dwordx4 v13, s[8:11], s50 offen  lds
    s_add_u32 m0, s51, 2048
    s_movk_i32 s49, 1536
    buffer_load_dwordx4 v10, s[4:7], s49 offen  lds
    s_add_u32 m0, s52, 4096
    s_add_u32 s50, s50, s48
    buffer_load_dwordx4 v12, s[8:11], s50 offen  lds
    s_add_u32 m0, s52, 5120
    s_nop 0
    buffer_load_dwordx4 v13, s[8:11], s50 offen  lds
    s_add_u32 m0, s51, 3072
    s_movk_i32 s49, 1536
    buffer_load_dwordx4 v11, s[4:7], s49 offen  lds
    s_add_u32 m0, s52, 6144
    s_add_u32 s50, s50, s48
    buffer_load_dwordx4 v12, s[8:11], s50 offen  lds
    s_add_u32 m0, s52, 7168
    s_nop 0
    buffer_load_dwordx4 v13, s[8:11], s50 offen  lds
    s_waitcnt vmcnt(12)
    s_barrier
    s_add_u32 m0, s51, 49152
    s_movk_i32 s49, 1664
    buffer_load_dwordx4 v8, s[4:7], s49 offen  lds
    s_add_u32 m0, s52, 49152
    s_add_u32 s50, s50, s48
    buffer_load_dwordx4 v12, s[8:11], s50 offen  lds
    s_add_u32 m0, s52, 50176
    s_nop 0
    buffer_load_dwordx4 v13, s[8:11], s50 offen  lds
    s_add_u32 m0, s51, 50176
    s_movk_i32 s49, 1664
    buffer_load_dwordx4 v9, s[4:7], s49 offen  lds
    s_add_u32 m0, s52, 51200
    s_add_u32 s50, s50, s48
    buffer_load_dwordx4 v12, s[8:11], s50 offen  lds
    s_add_u32 m0, s52, 52224
    s_nop 0
    buffer_load_dwordx4 v13, s[8:11], s50 offen  lds
    s_add_u32 m0, s51, 51200
    s_movk_i32 s49, 1664
    buffer_load_dwordx4 v10, s[4:7], s49 offen  lds
    s_add_u32 m0, s52, 53248
    s_add_u32 s50, s50, s48
    buffer_load_dwordx4 v12, s[8:11], s50 offen  lds
    s_add_u32 m0, s52, 54272
    s_nop 0
    buffer_load_dwordx4 v13, s[8:11], s50 offen  lds
    s_add_u32 m0, s51, 52224
    s_movk_i32 s49, 1664
    buffer_load_dwordx4 v11, s[4:7], s49 offen  lds
    s_add_u32 m0, s52, 55296
    s_add_u32 s50, s50, s48
    buffer_load_dwordx4 v12, s[8:11], s50 offen  lds
    s_add_u32 m0, s52, 56320
    s_nop 0
    buffer_load_dwordx4 v13, s[8:11], s50 offen  lds
    s_waitcnt vmcnt(12)
    s_barrier
    s_add_u32 m0, s51, 98304
    s_movk_i32 s49, 1792
    buffer_load_dwordx4 v8, s[4:7], s49 offen  lds
    s_add_u32 m0, s52, 98304
    s_add_u32 s50, s50, s48
    buffer_load_dwordx4 v12, s[8:11], s50 offen  lds
    s_add_u32 m0, s52, 99328
    s_nop 0
    buffer_load_dwordx4 v13, s[8:11], s50 offen  lds
    s_add_u32 m0, s51, 99328
    s_movk_i32 s49, 1792
    buffer_load_dwordx4 v9, s[4:7], s49 offen  lds
    s_add_u32 m0, s52, 100352
    s_add_u32 s50, s50, s48
    buffer_load_dwordx4 v12, s[8:11], s50 offen  lds
    s_add_u32 m0, s52, 101376
    s_nop 0
    buffer_load_dwordx4 v13, s[8:11], s50 offen  lds
    s_add_u32 m0, s51, 100352
    s_movk_i32 s49, 1792
    buffer_load_dwordx4 v10, s[4:7], s49 offen  lds
    s_add_u32 m0, s52, 102400
    s_add_u32 s50, s50, s48
    buffer_load_dwordx4 v12, s[8:11], s50 offen  lds
    s_add_u32 m0, s52, 103424
    s_nop 0
    buffer_load_dwordx4 v13, s[8:11], s50 offen  lds
    s_add_u32 m0, s51, 101376
    s_movk_i32 s49, 1792
    buffer_load_dwordx4 v11, s[4:7], s49 offen  lds
    s_add_u32 m0, s52, 104448
    s_add_u32 s50, s50, s48
    buffer_load_dwordx4 v12, s[8:11], s50 offen  lds
    s_add_u32 m0, s52, 105472
    s_nop 0
    buffer_load_dwordx4 v13, s[8:11], s50 offen  lds
    s_waitcnt vmcnt(12)
    s_barrier
    s_add_u32 m0, s51, 0
    s_movk_i32 s49, 1920
    buffer_load_dwordx4 v8, s[4:7], s49 offen  lds
    s_add_u32 m0, s52, 0
    s_add_u32 s50, s50, s48
    buffer_load_dwordx4 v12, s[8:11], s50 offen  lds
    s_add_u32 m0, s52, 1024
    s_nop 0
    buffer_load_dwordx4 v13, s[8:11], s50 offen  lds
    s_add_u32 m0, s51, 1024
    s_movk_i32 s49, 1920
    buffer_load_dwordx4 v9, s[4:7], s49 offen  lds
    s_add_u32 m0, s52, 2048
    s_add_u32 s50, s50, s48
    buffer_load_dwordx4 v12, s[8:11], s50 offen  lds
    s_add_u32 m0, s52, 3072
    s_nop 0
    buffer_load_dwordx4 v13, s[8:11], s50 offen  lds
    s_add_u32 m0, s51, 2048
    s_movk_i32 s49, 1920
    buffer_load_dwordx4 v10, s[4:7], s49 offen  lds
    s_add_u32 m0, s52, 4096
    s_add_u32 s50, s50, s48
    buffer_load_dwordx4 v12, s[8:11], s50 offen  lds
    s_add_u32 m0, s52, 5120
    s_nop 0
    buffer_load_dwordx4 v13, s[8:11], s50 offen  lds
    s_add_u32 m0, s51, 3072
    s_movk_i32 s49, 1920
    buffer_load_dwordx4 v11, s[4:7], s49 offen  lds
    s_add_u32 m0, s52, 6144
    s_add_u32 s50, s50, s48
    buffer_load_dwordx4 v12, s[8:11], s50 offen  lds
    s_add_u32 m0, s52, 7168
    s_nop 0
    buffer_load_dwordx4 v13, s[8:11], s50 offen  lds
    s_waitcnt vmcnt(12)
    s_branch K_phend
K_ph0_3:
    s_barrier
    s_add_u32 m0, s52, 54272
    s_nop 0
    buffer_load_dwordx4 v13, s[8:11], s50 offen  lds
    s_add_u32 m0, s51, 52224
    s_movk_i32 s49, 128
    buffer_load_dwordx4 v11, s[4:7], s49 offen  lds
    s_add_u32 m0, s52, 55296
    s_add_u32 s50, s50, s48
    buffer_load_dwordx4 v12, s[8:11], s50 offen  lds
    s_add_u32 m0, s52, 56320
    s_nop 0
    buffer_load_dwordx4 v13, s[8:11], s50 offen  lds
    s_add_u32 m0, s51, 98304
    s_movk_i32 s49, 256
    buffer_load_dwordx4 v8, s[4:7], s49 offen  lds
    s_add_u32 m0, s52, 98304
    s_add_u32 s50, s50, s48
    buffer_load_dwordx4 v12, s[8:11], s50 offen  lds
    s_add_u32 m0, s52, 99328
    s_nop 0
    buffer_load_dwordx4 v13, s[8:11], s50 offen  lds
    s_add_u32 m0, s51, 99328
    s_movk_i32 s49, 256
    buffer_load_dwordx4 v9, s[4:7], s49 offen  lds
    s_add_u32 m0, s52, 100352
    s_add_u32 s50, s50, s48
    buffer_load_dwordx4 v12, s[8:11], s50 offen  lds
    s_add_u32 m0, s52, 101376
    s_nop 0
    buffer_load_dwordx4 v13, s[8:11], s50 offen  lds
    s_add_u32 m0, s51, 100352
    s_movk_i32 s49, 256
    buffer_load_dwordx4 v10, s[4:7], s49 offen  lds
    s_add_u32 m0, s52, 102400
    s_add_u32 s50, s50, s48
    buffer_load_dwordx4 v12, s[8:11], s50 offen  lds
    s_add_u32 m0, s52, 103424
    s_nop 0
    buffer_load_dwordx4 v13, s[8:11], s50 offen  lds
    s_add_u32 m0, s51, 101376
    s_movk_i32 s49, 256
    buffer_load_dwordx4 v11, s[4:7], s49 offen  lds
    s_add_u32 m0, s52, 104448
    s_add_u32 s50, s50, s48
    buffer_load_dwordx4 v12, s[8:11], s50 offen  lds
    s_add_u32 m0, s52, 105472
    s_nop 0
    buffer_load_dwordx4 v13, s[8:11], s50 offen  lds
    s_waitcnt vmcnt(12)
    s_barrier
    s_add_u32 m0, s51, 0
    s_movk_i32 s49, 384
    buffer_load_dwordx4 v8, s[4:7], s49 offen  lds
    s_add_u32 m0, s52, 0
    s_add_u32 s50, s50, s48
    buffer_load_dwordx4 v12, s[8:11], s50 offen  lds
    s_add_u32 m0, s52, 1024
    s_nop 0
    buffer_load_dwordx4 v13, s[8:11], s50 offen  lds
    s_add_u32 m0, s51, 1024
    s_movk_i32 s49, 384
    buffer_load_dwordx4 v9, s[4:7], s49 offen  lds
    s_add_u32 m0, s52, 2048
    s_add_u32 s50, s50, s48
    buffer_load_dwordx4 v12, s[8:11], s50 offen  lds
    s_add_u32 m0, s52, 3072
    s_nop 0
    buffer_load_dwordx4 v13, s[8:11], s50 offen  lds
    s_add_u32 m0, s51, 2048
    s_movk_i32 s49, 384
    buffer_load_dwordx4 v10, s[4:7], s49 offen  lds
    s_add_u32 m0, s52, 4096
    s_add_u32 s50, s50, s48
    buffer_load_dwordx4 v12, s[8:11], s50 offen  lds
    s_add_u32 m0, s52, 5120
    s_nop 0
    buffer_load_dwordx4 v13, s[8:11], s50 offen  lds
    s_add_u32 m0, s51, 3072
    s_movk_i32 s49, 384
    buffer_load_dwordx4 v11, s[4:7], s49 offen  lds
    s_add_u32 m0, s52, 6144
    s_add_u32 s50, s50, s48
    buffer_load_dwordx4 v12, s[8:11], s50 offen  lds
    s_add_u32 m0, s52, 7168
    s_nop 0
    buffer_load_dwordx4 v13, s[8:11], s50 offen  lds
    s_waitcnt vmcnt(12)
    s_barrier
    s_cmp_lg_u32 s61, 3
    s_cbranch_scc1 K_nf_4
    s_and_b32 s40, s37, 3
    s_lshl2_add_u32 s40, s36, s40
    s_lshl_b32 s40, s40, 5
    s_lshr_b32 s41, s37, 3
    s_add_u32 s40, s40, s41
    s_lshl_b32 s40, s40, 2
    s_add_u32 s40, s40, 17301512
    s_mov_b64 exec, 1
    buffer_store_dword v240, off, s[20:23], s40 sc1
    s_mov_b64 exec, -1
K_nf_4:
    s_add_u32 m0, s51, 49152
    s_movk_i32 s49, 512
    buffer_load_dwordx4 v8, s[4:7], s49 offen  lds
    s_add_u32 m0, s52, 49152
    s_add_u32 s50, s50, s48
    buffer_load_dwordx4 v12, s[8:11], s50 offen  lds
    s_add_u32 m0, s52, 50176
    s_nop 0
    buffer_load_dwordx4 v13, s[8:11], s50 offen  lds
    s_add_u32 m0, s51, 50176
    s_movk_i32 s49, 512
    buffer_load_dwordx4 v9, s[4:7], s49 offen  lds
    s_add_u32 m0, s52, 51200
    s_add_u32 s50, s50, s48
    buffer_load_dwordx4 v12, s[8:11], s50 offen  lds
    s_add_u32 m0, s52, 52224
    s_nop 0
    buffer_load_dwordx4 v13, s[8:11], s50 offen  lds
    s_add_u32 m0, s51, 51200
    s_movk_i32 s49, 512
    buffer_load_dwordx4 v10, s[4:7], s49 offen  lds
    s_add_u32 m0, s52, 53248
    s_add_u32 s50, s50, s48
    buffer_load_dwordx4 v12, s[8:11], s50 offen  lds
    s_add_u32 m0, s52, 54272
    s_nop 0
    buffer_load_dwordx4 v13, s[8:11], s50 offen  lds
    s_add_u32 m0, s51, 52224
    s_movk_i32 s49, 512
    buffer_load_dwordx4 v11, s[4:7], s49 offen  lds
    s_add_u32 m0, s52, 55296
    s_add_u32 s50, s50, s48
    buffer_load_dwordx4 v12, s[8:11], s50 offen  lds
    s_add_u32 m0, s52, 56320
    s_nop 0
    buffer_load_dwordx4 v13, s[8:11], s50 offen  lds
    s_waitcnt vmcnt(12)
    s_barrier
    s_add_u32 m0, s51, 98304
    s_movk_i32 s49, 640
    buffer_load_dwordx4 v8, s[4:7], s49 offen  lds
    s_add_u32 m0, s52, 98304
    s_add_u32 s50, s50, s48
    buffer_load_dwordx4 v12, s[8:11], s50 offen  lds
    s_add_u32 m0, s52, 99328
    s_nop 0
    buffer_load_dwordx4 v13, s[8:11], s50 offen  lds
    s_add_u32 m0, s51, 99328
    s_movk_i32 s49, 640
    buffer_load_dwordx4 v9, s[4:7], s49 offen  lds
    s_add_u32 m0, s52, 100352
    s_add_u32 s50, s50, s48
    buffer_load_dwordx4 v12, s[8:11], s50 offen  lds
    s_add_u32 m0, s52, 101376
    s_nop 0
    buffer_load_dwordx4 v13, s[8:11], s50 offen  lds
    s_add_u32 m0, s51, 100352
    s_movk_i32 s49, 640
    buffer_load_dwordx4 v10, s[4:7], s49 offen  lds
    s_add_u32 m0, s52, 102400
    s_add_u32 s50, s50, s48
    buffer_load_dwordx4 v12, s[8:11], s50 offen  lds
    s_add_u32 m0, s52, 103424
    s_nop 0
    buffer_load_dwordx4 v13, s[8:11], s50 offen  lds
    s_add_u32 m0, s51, 101376
    s_movk_i32 s49, 640
    buffer_load_dwordx4 v11, s[4:7], s49 offen  lds
    s_add_u32 m0, s52, 104448
    s_add_u32 s50, s50, s48
    buffer_load_dwordx4 v12, s[8:11], s50 offen  lds
    s_add_u32 m0, s52, 105472
    s_nop 0
    buffer_load_dwordx4 v13, s[8:11], s50 offen  lds
    s_waitcnt vmcnt(12)
    s_barrier
    s_add_u32 m0, s51, 0
    s_movk_i32 s49, 768
    buffer_load_dwordx4 v8, s[4:7], s49 offen  lds
    s_add_u32 m0, s52, 0
    s_add_u32 s50, s50, s48
    buffer_load_dwordx4 v12, s[8:11], s50 offen  lds
    s_add_u32 m0, s52, 1024
    s_nop 0
    buffer_load_dwordx4 v13, s[8:11], s50 offen  lds
    s_add_u32 m0, s51, 1024
    s_movk_i32 s49, 768
    buffer_load_dwordx4 v9, s[4:7], s49 offen  lds
    s_add_u32 m0, s52, 2048
    s_add_u32 s50, s50, s48
    buffer_load_dwordx4 v12, s[8:11], s50 offen  lds
    s_add_u32 m0, s52, 3072
    s_nop 0
    buffer_load_dwordx4 v13, s[8:11], s50 offen  lds
    s_add_u32 m0, s51, 2048
    s_movk_i32 s49, 768
    buffer_load_dwordx4 v10, s[4:7], s49 offen  lds
    s_add_u32 m0, s52, 4096
    s_add_u32 s50, s50, s48
    buffer_load_dwordx4 v12, s[8:11], s50 offen  lds
    s_add_u32 m0, s52, 5120
    s_nop 0
    buffer_load_dwordx4 v13, s[8:11], s50 offen  lds
    s_add_u32 m0, s51, 3072
    s_movk_i32 s49, 768
    buffer_load_dwordx4 v11, s[4:7], s49 offen  lds
    s_add_u32 m0, s52, 6144
    s_add_u32 s50, s50, s48
    buffer_load_dwordx4 v12, s[8:11], s50 offen  lds
    s_add_u32 m0, s52, 7168
    s_nop 0
    buffer_load_dwordx4 v13, s[8:11], s50 offen  lds
    s_mul_i32 s40, s62, 512
    s_mov_b64 exec, 0xffff
    buffer_load_dword v255, v17, s[8:11], s40 offen
    s_mov_b64 exec, -1
    s_mov_b32 exec_hi, 0
    buffer_load_dword v255, v182, s[4:7], 0 offen offset:1024
    s_mov_b32 exec_hi, -1
    s_waitcnt vmcnt(14)
    s_barrier
    s_add_u32 m0, s51, 49152
    s_movk_i32 s49, 896
    buffer_load_dwordx4 v8, s[4:7], s49 offen  lds
    s_add_u32 m0, s52, 49152
    s_add_u32 s50, s50, s48
    buffer_load_dwordx4 v12, s[8:11], s50 offen  lds
    s_add_u32 m0, s52, 50176
    s_nop 0
    buffer_load_dwordx4 v13, s[8:11], s50 offen  lds
    s_waitcnt vmcnt(5)
    s_barrier
    s_add_u32 m0, s51, 50176
    s_movk_i32 s49, 896
    buffer_load_dwordx4 v9, s[4:7], s49 offen  lds
    s_add_u32 m0, s52, 51200
    s_add_u32 s50, s50, s48
    buffer_load_dwordx4 v12, s[8:11], s50 offen  lds
    s_add_u32 m0, s52, 52224
    s_nop 0
    buffer_load_dwordx4 v13, s[8:11], s50 offen  lds
    s_add_u32 m0, s51, 51200
    s_movk_i32 s49, 896
    buffer_load_dwordx4 v10, s[4:7], s49 offen  lds
    s_add_u32 m0, s52, 53248
    s_add_u32 s50, s50, s48
    buffer_load_dwordx4 v12, s[8:11], s50 offen  lds
    s_add_u32 m0, s52, 54272
    s_nop 0
    buffer_load_dwordx4 v13, s[8:11], s50 offen  lds
    s_add_u32 m0, s51, 52224
    s_movk_i32 s49, 896
    buffer_load_dwordx4 v11, s[4:7], s49 offen  lds
    s_add_u32 m0, s52, 55296
    s_add_u32 s50, s50, s48
    buffer_load_dwordx4 v12, s[8:11], s50 offen  lds
    s_add_u32 m0, s52, 56320
    s_nop 0
    buffer_load_dwordx4 v13, s[8:11], s50 offen  lds
    s_add_u32 m0, s51, 98304
    s_movk_i32 s49, 1024
    buffer_load_dwordx4 v8, s[4:7], s49 offen  lds
    s_add_u32 m0, s52, 98304
    s_add_u32 s50, s50, s48
    buffer_load_dwordx4 v12, s[8:11], s50 offen  lds
    s_add_u32 m0, s52, 99328
    s_nop 0
    buffer_load_dwordx4 v13, s[8:11], s50 offen  lds
    s_add_u32 m0, s51, 99328
    s_movk_i32 s49, 1024
    buffer_load_dwordx4 v9, s[4:7], s49 offen  lds
    s_add_u32 m0, s52, 100352
    s_add_u32 s50, s50, s48
    buffer_load_dwordx4 v12, s[8:11], s50 offen  lds
    s_add_u32 m0, s52, 101376
    s_nop 0
    buffer_load_dwordx4 v13, s[8:11], s50 offen  lds
    s_add_u32 m0, s51, 100352
    s_movk_i32 s49, 1024
    buffer_load_dwordx4 v10, s[4:7], s49 offen  lds
    s_add_u32 m0, s52, 102400
    s_add_u32 s50, s50, s48
    buffer_load_dwordx4 v12, s[8:11], s50 offen  lds
    s_waitcnt vmcnt(8)
    s_barrier
    s_add_u32 m0, s52, 103424
    s_nop 0
    buffer_load_dwordx4 v13, s[8:11], s50 offen  lds
    s_add_u32 m0, s51, 101376
    s_movk_i32 s49, 1024
    buffer_load_dwordx4 v11, s[4:7], s49 offen  lds
    s_add_u32 m0, s52, 104448
    s_add_u32 s50, s50, s48
    buffer_load_dwordx4 v12, s[8:11], s50 offen  lds
    s_add_u32 m0, s52, 105472
    s_nop 0
    buffer_load_dwordx4 v13, s[8:11], s50 offen  lds
    s_add_u32 m0, s51, 0
    s_movk_i32 s49, 1152
    buffer_load_dwordx4 v8, s[4:7], s49 offen  lds
    s_add_u32 m0, s52, 0
    s_add_u32 s50, s50, s48
    buffer_load_dwordx4 v12, s[8:11], s50 offen  lds
    s_add_u32 m0, s52, 1024
    s_nop 0
    buffer_load_dwordx4 v13, s[8:11], s50 offen  lds
    s_add_u32 m0, s51, 1024
    s_movk_i32 s49, 1152
    buffer_load_dwordx4 v9, s[4:7], s49 offen  lds
    s_add_u32 m0, s52, 2048
    s_add_u32 s50, s50, s48
    buffer_load_dwordx4 v12, s[8:11], s50 offen  lds
    s_add_u32 m0, s52, 3072
    s_nop 0
    buffer_load_dwordx4 v13, s[8:11], s50 offen  lds
    s_add_u32 m0, s51, 2048
    s_movk_i32 s49, 1152
    buffer_load_dwordx4 v10, s[4:7], s49 offen  lds
    s_add_u32 m0, s52, 4096
    s_add_u32 s50, s50, s48
    buffer_load_dwordx4 v12, s[8:11], s50 offen  lds
    s_add_u32 m0, s52, 5120
    s_nop 0
    buffer_load_dwordx4 v13, s[8:11], s50 offen  lds
    s_add_u32 m0, s51, 3072
    s_movk_i32 s49, 1152
    buffer_load_dwordx4 v11, s[4:7], s49 offen  lds
    s_add_u32 m0, s52, 6144
    s_add_u32 s50, s50, s48
    buffer_load_dwordx4 v12, s[8:11], s50 offen  lds
    s_add_u32 m0, s52, 7168
    s_nop 0
    buffer_load_dwordx4 v13, s[8:11], s50 offen  lds
    s_waitcnt vmcnt(12)
    s_barrier
    s_add_u32 m0, s51, 49152
    s_movk_i32 s49, 1280
    buffer_load_dwordx4 v8, s[4:7], s49 offen  lds
    s_add_u32 m0, s52, 49152
    s_add_u32 s50, s50, s48
    buffer_load_dwordx4 v12, s[8:11], s50 offen  lds
    s_add_u32 m0, s52, 50176
    s_nop 0
    buffer_load_dwordx4 v13, s[8:11], s50 offen  lds
    s_add_u32 m0, s51, 50176
    s_movk_i32 s49, 1280
    buffer_load_dwordx4 v9, s[4:7], s49 offen  lds
    s_add_u32 m0, s52, 51200
    s_add_u32 s50, s50, s48
    buffer_load_dwordx4 v12, s[8:11], s50 offen  lds
    s_add_u32 m0, s52, 52224
    s_nop 0
    buffer_load_dwordx4 v13, s[8:11], s50 offen  lds
    s_add_u32 m0, s51, 51200
    s_movk_i32 s49, 1280
    buffer_load_dwordx4 v10, s[4:7], s49 offen  lds
    s_add_u32 m0, s52, 53248
    s_add_u32 s50, s50, s48
    buffer_load_dwordx4 v12, s[8:11], s50 offen  lds
    s_add_u32 m0, s52, 54272
    s_nop 0
    buffer_load_dwordx4 v13, s[8:11], s50 offen  lds
    s_add_u32 m0, s51, 52224
    s_movk_i32 s49, 1280
    buffer_load_dwordx4 v11, s[4:7], s49 offen  lds
    s_add_u32 m0, s52, 55296
    s_add_u32 s50, s50, s48
    buffer_load_dwordx4 v12, s[8:11], s50 offen  lds
    s_add_u32 m0, s52, 56320
    s_nop 0
    buffer_load_dwordx4 v13, s[8:11], s50 offen  lds
    s_mul_i32 s40, s62, 768
    s_mov_b64 exec, 0
    s_mov_b32 exec_lo, -1
    s_mov_b32 exec_hi, 0x0
    buffer_load_dword v255, v17, s[8:11], s40 offen
    s_mov_b64 exec, -1
    s_waitcnt vmcnt(13)
    s_barrier
    s_add_u32 m0, s51, 98304
    s_movk_i32 s49, 1408
    buffer_load_dwordx4 v8, s[4:7], s49 offen  lds
    s_add_u32 m0, s52, 98304
    s_add_u32 s50, s50, s48
    buffer_load_dwordx4 v12, s[8:11], s50 offen  lds
    s_add_u32 m0, s52, 99328
    s_nop 0
    buffer_load_dwordx4 v13, s[8:11], s50 offen  lds
    s_waitcnt vmcnt(4)
    s_barrier
    s_add_u32 m0, s51, 99328
    s_movk_i32 s49, 1408
    buffer_load_dwordx4 v9, s[4:7], s49 offen  lds
    s_add_u32 m0, s52, 100352
    s_add_u32 s50, s50, s48
    buffer_load_dwordx4 v12, s[8:11], s50 offen  lds
    s_add_u32 m0, s52, 101376
    s_nop 0
    buffer_load_dwordx4 v13, s[8:11], s50 offen  lds
    s_add_u32 m0, s51, 100352
    s_movk_i32 s49, 1408
    buffer_load_dwordx4 v10, s[4:7], s49 offen  lds
    s_add_u32 m0, s52, 102400
    s_add_u32 s50, s50, s48
    buffer_load_dwordx4 v12, s[8:11], s50 offen  lds
    s_add_u32 m0, s52, 103424
    s_nop 0
    buffer_load_dwordx4 v13, s[8:11], s50 offen  lds
    s_add_u32 m0, s51, 101376
    s_movk_i32 s49, 1408
    buffer_load_dwordx4 v11, s[4:7], s49 offen  lds
    s_add_u32 m0, s52, 104448
    s_add_u32 s50, s50, s48
    buffer_load_dwordx4 v12, s[8:11], s50 offen  lds
    s_add_u32 m0, s52, 105472
    s_nop 0
    buffer_load_dwordx4 v13, s[8:11], s50 offen  lds
    s_add_u32 m0, s51, 0
    s_movk_i32 s49, 1536
    buffer_load_dwordx4 v8, s[4:7], s49 offen  lds
    s_add_u32 m0, s52, 0
    s_add_u32 s50, s50, s48
    buffer_load_dwordx4 v12, s[8:11], s50 offen  lds
    s_add_u32 m0, s52, 1024
    s_nop 0
    buffer_load_dwordx4 v13, s[8:11], s50 offen  lds
    s_add_u32 m0, s51, 1024
    s_movk_i32 s49, 1536
    buffer_load_dwordx4 v9, s[4:7], s49 offen  lds
    s_add_u32 m0, s52, 2048
    s_add_u32 s50, s50, s48
    buffer_load_dwordx4 v12, s[8:11], s50 offen  lds
    s_add_u32 m0, s52, 3072
    s_nop 0
    buffer_load_dwordx4 v13, s[8:11], s50 offen  lds
    s_add_u32 m0, s51, 2048
    s_movk_i32 s49, 1536
    buffer_load_dwordx4 v10, s[4:7], s49 offen  lds
    s_add_u32 m0, s52, 4096
    s_add_u32 s50, s50, s48
    buffer_load_dwordx4 v12, s[8:11], s50 offen  lds
    s_waitcnt vmcnt(8)
    s_barrier
    s_add_u32 m0, s52, 5120
    s_nop 0
    buffer_load_dwordx4 v13, s[8:11], s50 offen  lds
    s_add_u32 m0, s51, 3072
    s_movk_i32 s49, 1536
    buffer_load_dwordx4 v11, s[4:7], s49 offen  lds
    s_add_u32 m0, s52, 6144
    s_add_u32 s50, s50, s48
    buffer_load_dwordx4 v12, s[8:11], s50 offen  lds
    s_add_u32 m0, s52, 7168
    s_nop 0
    buffer_load_dwordx4 v13, s[8:11], s50 offen  lds
    s_add_u32 m0, s51, 49152
    s_movk_i32 s49, 1664
    buffer_load_dwordx4 v8, s[4:7], s49 offen  lds
    s_add_u32 m0, s52, 49152
    s_add_u32 s50, s50, s48
    buffer_load_dwordx4 v12, s[8:11], s50 offen  lds
    s_add_u32 m0, s52, 50176
    s_nop 0
    buffer_load_dwordx4 v13, s[8:11], s50 offen  lds
    s_add_u32 m0, s51, 50176
    s_movk_i32 s49, 1664
    buffer_load_dwordx4 v9, s[4:7], s49 offen  lds
    s_add_u32 m0, s52, 51200
    s_add_u32 s50, s50, s48
    buffer_load_dwordx4 v12, s[8:11], s50 offen  lds
    s_add_u32 m0, s52, 52224
    s_nop 0
    buffer_load_dwordx4 v13, s[8:11], s50 offen  lds
    s_add_u32 m0, s51, 51200
    s_movk_i32 s49, 1664
    buffer_load_dwordx4 v10, s[4:7], s49 offen  lds
    s_add_u32 m0, s52, 53248
    s_add_u32 s50, s50, s48
    buffer_load_dwordx4 v12, s[8:11], s50 offen  lds
    s_add_u32 m0, s52, 54272
    s_nop 0
    buffer_load_dwordx4 v13, s[8:11], s50 offen  lds
    s_add_u32 m0, s51, 52224
    s_movk_i32 s49, 1664
    buffer_load_dwordx4 v11, s[4:7], s49 offen  lds
    s_add_u32 m0, s52, 55296
    s_add_u32 s50, s50, s48
    buffer_load_dwordx4 v12, s[8:11], s50 offen  lds
    s_add_u32 m0, s52, 56320
    s_nop 0
    buffer_load_dwordx4 v13, s[8:11], s50 offen  lds
    s_waitcnt vmcnt(12)
    s_barrier
    s_add_u32 m0, s51, 98304
    s_movk_i32 s49, 1792
    buffer_load_dwordx4 v8, s[4:7], s49 offen  lds
    s_add_u32 m0, s52, 98304
    s_add_u32 s50, s50, s48
    buffer_load_dwordx4 v12, s[8:11], s50 offen  lds
    s_add_u32 m0, s52, 99328
    s_nop 0
    buffer_load_dwordx4 v13, s[8:11], s50 offen  lds
    s_add_u32 m0, s51, 99328
    s_movk_i32 s49, 1792
    buffer_load_dwordx4 v9, s[4:7], s49 offen  lds
    s_add_u32 m0, s52, 100352
    s_add_u32 s50, s50, s48
    buffer_load_dwordx4 v12, s[8:11], s50 offen  lds
    s_add_u32 m0, s52, 101376
    s_nop 0
    buffer_load_dwordx4 v13, s[8:11], s50 offen  lds
    s_add_u32 m0, s51, 100352
    s_movk_i32 s49, 1792
    buffer_load_dwordx4 v10, s[4:7], s49 offen  lds
    s_add_u32 m0, s52, 102400
    s_add_u32 s50, s50, s48
    buffer_load_dwordx4 v12, s[8:11], s50 offen  lds
    s_add_u32 m0, s52, 103424
    s_nop 0
    buffer_load_dwordx4 v13, s[8:11], s50 offen  lds
    s_add_u32 m0, s51, 101376
    s_movk_i32 s49, 1792
    buffer_load_dwordx4 v11, s[4:7], s49 offen  lds
    s_add_u32 m0, s52, 104448
    s_add_u32 s50, s50, s48
    buffer_load_dwordx4 v12, s[8:11], s50 offen  lds
    s_add_u32 m0, s52, 105472
    s_nop 0
    buffer_load_dwordx4 v13, s[8:11], s50 offen  lds
    s_waitcnt vmcnt(12)
    s_barrier
    s_add_u32 m0, s51, 0
    s_movk_i32 s49, 1920
    buffer_load_dwordx4 v8, s[4:7], s49 offen  lds
    s_add_u32 m0, s52, 0
    s_add_u32 s50, s50, s48
    buffer_load_dwordx4 v12, s[8:11], s50 offen  lds
    s_add_u32 m0, s52, 1024
    s_nop 0
    buffer_load_dwordx4 v13, s[8:11], s50 offen  lds
    s_add_u32 m0, s51, 1024
    s_movk_i32 s49, 1920
    buffer_load_dwordx4 v9, s[4:7], s49 offen  lds
    s_add_u32 m0, s52, 2048
    s_add_u32 s50, s50, s48
    buffer_load_dwordx4 v12, s[8:11], s50 offen  lds
    s_add_u32 m0, s52, 3072
    s_nop 0
    buffer_load_dwordx4 v13, s[8:11], s50 offen  lds
    s_add_u32 m0, s51, 2048
    s_movk_i32 s49, 1920
    buffer_load_dwordx4 v10, s[4:7], s49 offen  lds
    s_add_u32 m0, s52, 4096
    s_add_u32 s50, s50, s48
    buffer_load_dwordx4 v12, s[8:11], s50 offen  lds
    s_add_u32 m0, s52, 5120
    s_nop 0
    buffer_load_dwordx4 v13, s[8:11], s50 offen  lds
    s_add_u32 m0, s51, 3072
    s_movk_i32 s49, 1920
    buffer_load_dwordx4 v11, s[4:7], s49 offen  lds
    s_add_u32 m0, s52, 6144
    s_add_u32 s50, s50, s48
    buffer_load_dwordx4 v12, s[8:11], s50 offen  lds
    s_add_u32 m0, s52, 7168
    s_nop 0
    buffer_load_dwordx4 v13, s[8:11], s50 offen  lds
    s_waitcnt vmcnt(12)
    s_branch K_phend
K_sd:
    s_cmp_eq_u32 s40, 1
    s_cbranch_scc1 K_ph1_1
    s_cmp_eq_u32 s40, 2
    s_cbranch_scc1 K_ph1_2
    s_cmp_eq_u32 s40, 3
    s_cbranch_scc1 K_ph1_3
K_ph1_0:
    s_barrier
    s_cmp_lg_u32 s61, 0
    s_cbranch_scc1 K_rr_5
    ds_read_b128 v[20:23], v188 offset:0
    ds_read_b128 v[24:27], v189 offset:0
    ds_read_b128 v[28:31], v190 offset:0
    ds_read_b128 v[32:35], v191 offset:0
K_rr_5:
    s_add_u32 m0, s52, 54272
    s_nop 0
    buffer_load_dwordx4 v13, s[8:11], s50 offen  lds
    s_add_u32 m0, s51, 52224
    s_movk_i32 s49, 128
    buffer_load_dwordx4 v11, s[4:7], s49 offen  lds
    s_add_u32 m0, s52, 55296
    s_add_u32 s50, s50, s48
    buffer_load_dwordx4 v12, s[8:11], s50 offen  lds
    s_add_u32 m0, s52, 56320
    s_nop 0
    buffer_load_dwordx4 v13, s[8:11], s50 offen  lds
    s_waitcnt lgkmcnt(0)
    buffer_load_dwordx4 v[184:187], v15, s[16:19], 0 offen
    s_mov_b32 m0, s60
    s_add_u32 s53, s51, 0
    buffer_load_dwordx4 v4, s[12:15], s53 offen offset:0 lds
    buffer_load_dwordx4 v4, s[12:15], s53 offen offset:1024 lds
    s_add_u32 m0, s51, 98304
    s_movk_i32 s49, 256
    buffer_load_dwordx4 v8, s[4:7], s49 offen  lds
    s_add_u32 m0, s52, 98304
    s_add_u32 s50, s50, s48
    buffer_load_dwordx4 v12, s[8:11], s50 offen  lds
    s_add_u32 m0, s52, 99328
    s_nop 0
    buffer_load_dwordx4 v13, s[8:11], s50 offen  lds
    s_add_u32 m0, s51, 99328
    s_movk_i32 s49, 256
    buffer_load_dwordx4 v9, s[4:7], s49 offen  lds
    s_add_u32 m0, s52, 100352
    s_add_u32 s50, s50, s48
    buffer_load_dwordx4 v12, s[8:11], s50 offen  lds
    s_add_u32 m0, s52, 101376
    s_nop 0
    buffer_load_dwordx4 v13, s[8:11], s50 offen  lds
    s_add_u32 m0, s51, 100352
    s_movk_i32 s49, 256
    buffer_load_dwordx4 v10, s[4:7], s49 offen  lds
    s_add_u32 m0, s52, 102400
    s_add_u32 s50, s50, s48
    buffer_load_dwordx4 v12, s[8:11], s50 offen  lds
    s_add_u32 m0, s52, 103424
    s_nop 0
    buffer_load_dwordx4 v13, s[8:11], s50 offen  lds
    s_add_u32 m0, s51, 101376
    s_movk_i32 s49, 256
    buffer_load_dwordx4 v11, s[4:7], s49 offen  lds
    s_waitcnt vmcnt(13)
    s_barrier
    s_waitcnt vmcnt(10)
    ds_read_b64_tr_b16 v[84:85], v16 offset:0
    ds_read_b64_tr_b16 v[86:87], v16 offset:256
    ds_read_b64_tr_b16 v[88:89], v16 offset:32
    ds_read_b64_tr_b16 v[90:91], v16 offset:288
    s_cmp_lg_u32 s61, 1
    s_cbranch_scc1 K_rr_6
    ds_read_b128 v[20:23], v188 offset:49152
    ds_read_b128 v[24:27], v189 offset:49152
    ds_read_b128 v[28:31], v190 offset:49152
    ds_read_b128 v[32:35], v191 offset:49152
K_rr_6:
    s_add_u32 m0, s52, 104448
    s_add_u32 s50, s50, s48
    buffer_load_dwordx4 v12, s[8:11], s50 offen  lds
    s_add_u32 m0, s52, 105472
    s_nop 0
    buffer_load_dwordx4 v13, s[8:11], s50 offen  lds
    s_waitcnt lgkmcnt(0)
    s_mov_b32 m0, s60
    s_add_u32 s53, s51, 2048
    buffer_load_dwordx4 v4, s[12:15], s53 offen offset:0 lds
    buffer_load_dwordx4 v4, s[12:15], s53 offen offset:1024 lds
    s_add_u32 m0, s51, 0
    s_movk_i32 s49, 384
    buffer_load_dwordx4 v8, s[4:7], s49 offen  lds
    s_add_u32 m0, s52, 0
    s_add_u32 s50, s50, s48
    buffer_load_dwordx4 v12, s[8:11], s50 offen  lds
    s_add_u32 m0, s52, 1024
    s_nop 0
    buffer_load_dwordx4 v13, s[8:11], s50 offen  lds
    s_add_u32 m0, s51, 1024
    s_movk_i32 s49, 384
    buffer_load_dwordx4 v9, s[4:7], s49 offen  lds
    s_add_u32 m0, s52, 2048
    s_add_u32 s50, s50, s48
    buffer_load_dwordx4 v12, s[8:11], s50 offen  lds
    s_add_u32 m0, s52, 3072
    s_nop 0
    buffer_load_dwordx4 v13, s[8:11], s50 offen  lds
    s_add_u32 m0, s51, 2048
    s_movk_i32 s49, 384
    buffer_load_dwordx4 v10, s[4:7], s49 offen  lds
    s_add_u32 m0, s52, 4096
    s_add_u32 s50, s50, s48
    buffer_load_dwordx4 v12, s[8:11], s50 offen  lds
    s_add_u32 m0, s52, 5120
    s_nop 0
    buffer_load_dwordx4 v13, s[8:11], s50 offen  lds
    s_add_u32 m0, s51, 3072
    s_movk_i32 s49, 384
    buffer_load_dwordx4 v11, s[4:7], s49 offen  lds
    s_add_u32 m0, s52, 6144
    s_add_u32 s50, s50, s48
    buffer_load_dwordx4 v12, s[8:11], s50 offen  lds
    s_add_u32 m0, s52, 7168
    s_nop 0
    buffer_load_dwordx4 v13, s[8:11], s50 offen  lds
    s_mul_i32 s40, s62, 320
    s_mov_b64 exec, 0xffff
    buffer_load_dword v255, v17, s[8:11], s40 offen
    s_mov_b64 exec, -1
    s_waitcnt vmcnt(15)
    s_barrier
    s_waitcnt vmcnt(13)
    ds_read_b64_tr_b16 v[92:93], v16 offset:0
    ds_read_b64_tr_b16 v[94:95], v16 offset:256
    ds_read_b64_tr_b16 v[96:97], v16 offset:32
    ds_read_b64_tr_b16 v[98:99], v16 offset:288
    s_cmp_lg_u32 s61, 2
    s_cbranch_scc1 K_rr_7
    v_add_u32 v192, 98304, v188
    ds_read_b128 v[20:23], v192
    v_add_u32 v193, 98304, v189
    ds_read_b128 v[24:27], v193
    v_add_u32 v194, 98304, v190
    ds_read_b128 v[28:31], v194
    v_add_u32 v195, 98304, v191
    ds_read_b128 v[32:35], v195
K_rr_7:
    s_add_u32 m0, s51, 49152
    s_movk_i32 s49, 512
    buffer_load_dwordx4 v8, s[4:7], s49 offen  lds
    s_add_u32 m0, s52, 49152
    s_add_u32 s50, s50, s48
    buffer_load_dwordx4 v12, s[8:11], s50 offen  lds
    s_waitcnt lgkmcnt(0)
    s_mov_b32 m0, s60
    s_add_u32 s53, s51, 32768
    buffer_load_dwordx4 v4, s[12:15], s53 offen offset:0 lds
    buffer_load_dwordx4 v4, s[12:15], s53 offen offset:1024 lds
    s_add_u32 m0, s52, 50176
    s_nop 0
    buffer_load_dwordx4 v13, s[8:11], s50 offen  lds
    s_add_u32 m0, s51, 50176
    s_movk_i32 s49, 512
    buffer_load_dwordx4 v9, s[4:7], s49 offen  lds
    s_add_u32 m0, s52, 51200
    s_add_u32 s50, s50, s48
    buffer_load_dwordx4 v12, s[8:11], s50 offen  lds
    s_add_u32 m0, s52, 52224
    s_nop 0
    buffer_load_dwordx4 v13, s[8:11], s50 offen  lds
    s_add_u32 m0, s51, 51200
    s_movk_i32 s49, 512
    buffer_load_dwordx4 v10, s[4:7], s49 offen  lds
    s_add_u32 m0, s52, 53248
    s_add_u32 s50, s50, s48
    buffer_load_dwordx4 v12, s[8:11], s50 offen  lds
    s_add_u32 m0, s52, 54272
    s_nop 0
    buffer_load_dwordx4 v13, s[8:11], s50 offen  lds
    s_add_u32 m0, s51, 52224
    s_movk_i32 s49, 512
    buffer_load_dwordx4 v11, s[4:7], s49 offen  lds
    s_add_u32 m0, s52, 55296
    s_add_u32 s50, s50, s48
    buffer_load_dwordx4 v12, s[8:11], s50 offen  lds
    s_add_u32 m0, s52, 56320
    s_nop 0
    buffer_load_dwordx4 v13, s[8:11], s50 offen  lds
    s_waitcnt vmcnt(15)
    s_barrier
    s_waitcnt vmcnt(10)
    ds_read_b64_tr_b16 v[116:117], v16 offset:0
    ds_read_b64_tr_b16 v[118:119], v16 offset:256
    ds_read_b64_tr_b16 v[120:121], v16 offset:32
    ds_read_b64_tr_b16 v[122:123], v16 offset:288
    s_cmp_lg_u32 s61, 3
    s_cbranch_scc1 K_rr_8
    ds_read_b128 v[20:23], v188 offset:0
    ds_read_b128 v[24:27], v189 offset:0
    ds_read_b128 v[28:31], v190 offset:0
    ds_read_b128 v[32:35], v191 offset:0
K_rr_8:
    s_add_u32 m0, s51, 98304
    s_movk_i32 s49, 640
    buffer_load_dwordx4 v8, s[4:7], s49 offen  lds
    s_add_u32 m0, s52, 98304
    s_add_u32 s50, s50, s48
    buffer_load_dwordx4 v12, s[8:11], s50 offen  lds
    s_waitcnt lgkmcnt(0)
    s_mov_b32 m0, s60
    s_add_u32 s53, s51, 34816
    buffer_load_dwordx4 v4, s[12:15], s53 offen offset:0 lds
    buffer_load_dwordx4 v4, s[12:15], s53 offen offset:1024 lds
    s_add_u32 m0, s52, 99328
    s_nop 0
    buffer_load_dwordx4 v13, s[8:11], s50 offen  lds
    s_add_u32 m0, s51, 99328
    s_movk_i32 s49, 640
    buffer_load_dwordx4 v9, s[4:7], s49 offen  lds
    s_add_u32 m0, s52, 100352
    s_add_u32 s50, s50, s48
    buffer_load_dwordx4 v12, s[8:11], s50 offen  lds
    s_add_u32 m0, s52, 101376
    s_nop 0
    buffer_load_dwordx4 v13, s[8:11], s50 offen  lds
    s_add_u32 m0, s51, 100352
    s_movk_i32 s49, 640
    buffer_load_dwordx4 v10, s[4:7], s49 offen  lds
    s_add_u32 m0, s52, 102400
    s_add_u32 s50, s50, s48
    buffer_load_dwordx4 v12, s[8:11], s50 offen  lds
    s_add_u32 m0, s52, 103424
    s_nop 0
    buffer_load_dwordx4 v13, s[8:11], s50 offen  lds
    s_add_u32 m0, s51, 101376
    s_movk_i32 s49, 640
    buffer_load_dwordx4 v11, s[4:7], s49 offen  lds
    s_add_u32 m0, s52, 104448
    s_add_u32 s50, s50, s48
    buffer_load_dwordx4 v12, s[8:11], s50 offen  lds
    s_add_u32 m0, s52, 105472
    s_nop 0
    buffer_load_dwordx4 v13, s[8:11], s50 offen  lds
    s_waitcnt vmcnt(14)
    s_barrier
    s_waitcnt vmcnt(10)
    ds_read_b64_tr_b16 v[124:125], v16 offset:0
    ds_read_b64_tr_b16 v[126:127], v16 offset:256
    ds_read_b64_tr_b16 v[128:129], v16 offset:32
    ds_read_b64_tr_b16 v[130:131], v16 offset:288
    s_cmp_lg_u32 s61, 0
    s_cbranch_scc1 K_rr_9
    ds_read_b128 v[36:39], v188 offset:49152
    ds_read_b128 v[40:43], v189 offset:49152
    ds_read_b128 v[44:47], v190 offset:49152
    ds_read_b128 v[48:51], v191 offset:49152
K_rr_9:
    s_add_u32 m0, s51, 0
    s_movk_i32 s49, 768
    buffer_load_dwordx4 v8, s[4:7], s49 offen  lds
    s_add_u32 m0, s52, 0
    s_add_u32 s50, s50, s48
    buffer_load_dwordx4 v12, s[8:11], s50 offen  lds
    s_waitcnt lgkmcnt(0)
    s_mov_b32 m0, s60
    s_add_u32 s53, s51, 16384
    buffer_load_dwordx4 v4, s[12:15], s53 offen offset:0 lds
    buffer_load_dwordx4 v4, s[12:15], s53 offen offset:1024 lds
    s_add_u32 m0, s60, 2048
    s_mov_b32 s49, 1024
    buffer_load_dwordx4 v14, s[4:7], s49 offen lds
    s_add_u32 m0, s60, 3072
    s_nop 0
    buffer_load_dwordx4 v19, s[4:7], s49 offen lds
    v_mov_b32_dpp v172, v184 row_newbcast:0 row_mask:0xf bank_mask:0xf
    v_mov_b32_dpp v173, v185 row_newbcast:0 row_mask:0xf bank_mask:0xf
    v_mov_b32_dpp v174, v186 row_newbcast:0 row_mask:0xf bank_mask:0xf
    v_mov_b32_dpp v175, v187 row_newbcast:0 row_mask:0xf bank_mask:0xf
    v_mov_b32_dpp v176, v184 row_newbcast:1 row_mask:0xf bank_mask:0xf
    v_mov_b32_dpp v177, v185 row_newbcast:1 row_mask:0xf bank_mask:0xf
    v_mov_b32_dpp v178, v186 row_newbcast:1 row_mask:0xf bank_mask:0xf
    v_mov_b32_dpp v179, v187 row_newbcast:1 row_mask:0xf bank_mask:0xf
    s_bitcmp1_b32 s37, 3
    s_cbranch_scc1 K_sv_10
    v_mfma_f32_16x16x32_bf16 v[148:151], v[84:87], v[20:23], v[148:151]
    v_mfma_f32_16x16x32_bf16 v[152:155], v[88:91], v[20:23], v[152:155]
    v_mfma_f32_16x16x32_bf16 v[160:163], v[84:87], v[24:27], v[160:163]
    v_mfma_f32_16x16x32_bf16 v[164:167], v[88:91], v[24:27], v[164:167]
    v_mfma_f32_16x16x32_bf16 v[156:159], v[172:175], v[20:23], v[156:159]
    v_mfma_f32_16x16x32_bf16 v[148:151], v[92:95], v[28:31], v[148:151]
    v_mfma_f32_16x16x32_bf16 v[152:155], v[96:99], v[28:31], v[152:155]
    v_mfma_f32_16x16x32_bf16 v[160:163], v[92:95], v[32:35], v[160:163]
    v_mfma_f32_16x16x32_bf16 v[164:167], v[96:99], v[32:35], v[164:167]
    v_mfma_f32_16x16x32_bf16 v[156:159], v[176:179], v[28:31], v[156:159]
    s_branch K_se_11
K_sv_10:
    v_mfma_f32_16x16x32_bf16 v[148:151], v[20:23], v[84:87], v[148:151]
    v_mfma_f32_16x16x32_bf16 v[152:155], v[20:23], v[88:91], v[152:155]
    v_mfma_f32_16x16x32_bf16 v[160:163], v[24:27], v[84:87], v[160:163]
    v_mfma_f32_16x16x32_bf16 v[164:167], v[24:27], v[88:91], v[164:167]
    v_mfma_f32_16x16x32_bf16 v[168:171], v[172:175], v[24:27], v[168:171]
    v_mfma_f32_16x16x32_bf16 v[148:151], v[28:31], v[92:95], v[148:151]
    v_mfma_f32_16x16x32_bf16 v[152:155], v[28:31], v[96:99], v[152:155]
    v_mfma_f32_16x16x32_bf16 v[160:163], v[32:35], v[92:95], v[160:163]
    v_mfma_f32_16x16x32_bf16 v[164:167], v[32:35], v[96:99], v[164:167]
    v_mfma_f32_16x16x32_bf16 v[168:171], v[176:179], v[32:35], v[168:171]
K_se_11:
    s_add_u32 m0, s52, 1024
    s_nop 0
    buffer_load_dwordx4 v13, s[8:11], s50 offen  lds
    s_add_u32 m0, s51, 1024
    s_movk_i32 s49, 768
    buffer_load_dwordx4 v9, s[4:7], s49 offen  lds
    s_add_u32 m0, s52, 2048
    s_add_u32 s50, s50, s48
    buffer_load_dwordx4 v12, s[8:11], s50 offen  lds
    s_add_u32 m0, s52, 3072
    s_nop 0
    buffer_load_dwordx4 v13, s[8:11], s50 offen  lds
    s_add_u32 m0, s51, 2048
    s_movk_i32 s49, 768
    buffer_load_dwordx4 v10, s[4:7], s49 offen  lds
    s_add_u32 m0, s52, 4096
    s_add_u32 s50, s50, s48
    buffer_load_dwordx4 v12, s[8:11], s50 offen  lds
    s_add_u32 m0, s52, 5120
    s_nop 0
    buffer_load_dwordx4 v13, s[8:11], s50 offen  lds
    s_add_u32 m0, s51, 3072
    s_movk_i32 s49, 768
    buffer_load_dwordx4 v11, s[4:7], s49 offen  lds
    s_add_u32 m0, s52, 6144
    s_add_u32 s50, s50, s48
    buffer_load_dwordx4 v12, s[8:11], s50 offen  lds
    s_add_u32 m0, s52, 7168
    s_nop 0
    buffer_load_dwordx4 v13, s[8:11], s50 offen  lds
    s_waitcnt vmcnt(16)
    s_barrier
    s_waitcnt vmcnt(10)
    ds_read_b64_tr_b16 v[100:101], v16 offset:0
    ds_read_b64_tr_b16 v[102:103], v16 offset:256
    ds_read_b64_tr_b16 v[104:105], v16 offset:32
    ds_read_b64_tr_b16 v[106:107], v16 offset:288
    ds_read_b128 v[52:55], v180
    ds_read_b128 v[60:63], v181
    s_cmp_lg_u32 s61, 1
    s_cbranch_scc1 K_rr_12
    v_add_u32 v192, 98304, v188
    ds_read_b128 v[36:39], v192
    v_add_u32 v193, 98304, v189
    ds_read_b128 v[40:43], v193
    v_add_u32 v194, 98304, v190
    ds_read_b128 v[44:47], v194
    v_add_u32 v195, 98304, v191
    ds_read_b128 v[48:51], v195
K_rr_12:
    s_add_u32 m0, s51, 49152
    s_movk_i32 s49, 896
    buffer_load_dwordx4 v8, s[4:7], s49 offen  lds
    s_add_u32 m0, s52, 49152
    s_add_u32 s50, s50, s48
    buffer_load_dwordx4 v12, s[8:11], s50 offen  lds
    s_waitcnt lgkmcnt(0)
    s_mov_b32 m0, s60
    s_add_u32 s53, s51, 18432
    buffer_load_dwordx4 v4, s[12:15], s53 offen offset:0 lds
    buffer_load_dwordx4 v4, s[12:15], s53 offen offset:1024 lds
    s_add_u32 m0, s60, 2048
    s_mov_b32 s49, 33792
    buffer_load_dwordx4 v14, s[4:7], s49 offen lds
    s_add_u32 m0, s60, 3072
    s_nop 0
    buffer_load_dwordx4 v19, s[4:7], s49 offen lds
    s_add_u32 m0, s52, 50176
    s_nop 0
    buffer_load_dwordx4 v13, s[8:11], s50 offen  lds
    s_add_u32 m0, s51, 50176
    s_movk_i32 s49, 896
    buffer_load_dwordx4 v9, s[4:7], s49 offen  lds
    s_add_u32 m0, s52, 51200
    s_add_u32 s50, s50, s48
    buffer_load_dwordx4 v12, s[8:11], s50 offen  lds
    s_add_u32 m0, s52, 52224
    s_nop 0
    buffer_load_dwordx4 v13, s[8:11], s50 offen  lds
    s_add_u32 m0, s51, 51200
    s_movk_i32 s49, 896
    buffer_load_dwordx4 v10, s[4:7], s49 offen  lds
    s_add_u32 m0, s52, 53248
    s_add_u32 s50, s50, s48
    buffer_load_dwordx4 v12, s[8:11], s50 offen  lds
    s_add_u32 m0, s52, 54272
    s_nop 0
    buffer_load_dwordx4 v13, s[8:11], s50 offen  lds
    s_add_u32 m0, s51, 52224
    s_movk_i32 s49, 896
    buffer_load_dwordx4 v11, s[4:7], s49 offen  lds
    s_add_u32 m0, s52, 55296
    s_add_u32 s50, s50, s48
    buffer_load_dwordx4 v12, s[8:11], s50 offen  lds
    s_add_u32 m0, s52, 56320
    s_nop 0
    buffer_load_dwordx4 v13, s[8:11], s50 offen  lds
    s_mul_i32 s40, s62, 576
    s_mov_b64 exec, 0
    s_mov_b32 exec_lo, -1
    s_mov_b32 exec_hi, 0x0
    buffer_load_dword v255, v17, s[8:11], s40 offen
    s_mov_b64 exec, -1
    s_waitcnt vmcnt(17)
    s_barrier
    s_waitcnt vmcnt(11)
    ds_read_b64_tr_b16 v[108:109], v16 offset:0
    ds_read_b64_tr_b16 v[110:111], v16 offset:256
    ds_read_b64_tr_b16 v[112:113], v16 offset:32
    ds_read_b64_tr_b16 v[114:115], v16 offset:288
    ds_read_b128 v[56:59], v180
    ds_read_b128 v[64:67], v181
    s_cmp_lg_u32 s61, 2
    s_cbranch_scc1 K_rr_13
    ds_read_b128 v[36:39], v188 offset:0
    ds_read_b128 v[40:43], v189 offset:0
    ds_read_b128 v[44:47], v190 offset:0
    ds_read_b128 v[48:51], v191 offset:0
K_rr_13:
    s_add_u32 m0, s51, 98304
    s_movk_i32 s49, 1024
    buffer_load_dwordx4 v8, s[4:7], s49 offen  lds
    s_add_u32 m0, s52, 98304
    s_add_u32 s50, s50, s48
    buffer_load_dwordx4 v12, s[8:11], s50 offen  lds
    s_waitcnt lgkmcnt(0)
    s_mov_b32 m0, s60
    s_add_u32 s53, s51, 49152
    buffer_load_dwordx4 v4, s[12:15], s53 offen offset:0 lds
    buffer_load_dwordx4 v4, s[12:15], s53 offen offset:1024 lds
    s_add_u32 m0, s60, 2048
    s_mov_b32 s49, 1536
    buffer_load_dwordx4 v14, s[4:7], s49 offen lds
    s_add_u32 m0, s60, 3072
    s_nop 0
    buffer_load_dwordx4 v19, s[4:7], s49 offen lds
    v_mov_b32_dpp v172, v184 row_newbcast:4 row_mask:0xf bank_mask:0xf
    v_mov_b32_dpp v173, v185 row_newbcast:4 row_mask:0xf bank_mask:0xf
    v_mov_b32_dpp v174, v186 row_newbcast:4 row_mask:0xf bank_mask:0xf
    v_mov_b32_dpp v175, v187 row_newbcast:4 row_mask:0xf bank_mask:0xf
    v_mov_b32_dpp v176, v184 row_newbcast:5 row_mask:0xf bank_mask:0xf
    v_mov_b32_dpp v177, v185 row_newbcast:5 row_mask:0xf bank_mask:0xf
    v_mov_b32_dpp v178, v186 row_newbcast:5 row_mask:0xf bank_mask:0xf
    v_mov_b32_dpp v179, v187 row_newbcast:5 row_mask:0xf bank_mask:0xf
    s_bitcmp1_b32 s37, 3
    s_cbranch_scc1 K_sv_14
    v_mfma_f32_16x16x32_bf16 v[148:151], v[116:119], v[52:55], v[148:151]
    v_mfma_f32_16x16x32_bf16 v[152:155], v[120:123], v[52:55], v[152:155]
    v_mfma_f32_16x16x32_bf16 v[160:163], v[116:119], v[56:59], v[160:163]
    v_mfma_f32_16x16x32_bf16 v[164:167], v[120:123], v[56:59], v[164:167]
    v_mfma_f32_16x16x32_bf16 v[156:159], v[172:175], v[52:55], v[156:159]
    v_mfma_f32_16x16x32_bf16 v[148:151], v[124:127], v[60:63], v[148:151]
    v_mfma_f32_16x16x32_bf16 v[152:155], v[128:131], v[60:63], v[152:155]
    v_mfma_f32_16x16x32_bf16 v[160:163], v[124:127], v[64:67], v[160:163]
    v_mfma_f32_16x16x32_bf16 v[164:167], v[128:131], v[64:67], v[164:167]
    v_mfma_f32_16x16x32_bf16 v[156:159], v[176:179], v[60:63], v[156:159]
    s_branch K_se_15
K_sv_14:
    v_mfma_f32_16x16x32_bf16 v[148:151], v[52:55], v[116:119], v[148:151]
    v_mfma_f32_16x16x32_bf16 v[152:155], v[52:55], v[120:123], v[152:155]
    v_mfma_f32_16x16x32_bf16 v[160:163], v[56:59], v[116:119], v[160:163]
    v_mfma_f32_16x16x32_bf16 v[164:167], v[56:59], v[120:123], v[164:167]
    v_mfma_f32_16x16x32_bf16 v[168:171], v[172:175], v[56:59], v[168:171]
    v_mfma_f32_16x16x32_bf16 v[148:151], v[60:63], v[124:127], v[148:151]
    v_mfma_f32_16x16x32_bf16 v[152:155], v[60:63], v[128:131], v[152:155]
    v_mfma_f32_16x16x32_bf16 v[160:163], v[64:67], v[124:127], v[160:163]
    v_mfma_f32_16x16x32_bf16 v[164:167], v[64:67], v[128:131], v[164:167]
    v_mfma_f32_16x16x32_bf16 v[168:171], v[176:179], v[64:67], v[168:171]
K_se_15:
    s_add_u32 m0, s52, 99328
    s_nop 0
    buffer_load_dwordx4 v13, s[8:11], s50 offen  lds
    s_add_u32 m0, s51, 99328
    s_movk_i32 s49, 1024
    buffer_load_dwordx4 v9, s[4:7], s49 offen  lds
    s_add_u32 m0, s52, 100352
    s_add_u32 s50, s50, s48
    buffer_load_dwordx4 v12, s[8:11], s50 offen  lds
    s_add_u32 m0, s52, 101376
    s_nop 0
    buffer_load_dwordx4 v13, s[8:11], s50 offen  lds
    s_add_u32 m0, s51, 100352
    s_movk_i32 s49, 1024
    buffer_load_dwordx4 v10, s[4:7], s49 offen  lds
    s_add_u32 m0, s52, 102400
    s_add_u32 s50, s50, s48
    buffer_load_dwordx4 v12, s[8:11], s50 offen  lds
    s_add_u32 m0, s52, 103424
    s_nop 0
    buffer_load_dwordx4 v13, s[8:11], s50 offen  lds
    s_add_u32 m0, s51, 101376
    s_movk_i32 s49, 1024
    buffer_load_dwordx4 v11, s[4:7], s49 offen  lds
    s_add_u32 m0, s52, 104448
    s_add_u32 s50, s50, s48
    buffer_load_dwordx4 v12, s[8:11], s50 offen  lds
    s_add_u32 m0, s52, 105472
    s_nop 0
    buffer_load_dwordx4 v13, s[8:11], s50 offen  lds
    s_waitcnt vmcnt(17)
    s_barrier
    s_waitcnt vmcnt(10)
    ds_read_b64_tr_b16 v[132:133], v16 offset:0
    ds_read_b64_tr_b16 v[134:135], v16 offset:256
    ds_read_b64_tr_b16 v[136:137], v16 offset:32
    ds_read_b64_tr_b16 v[138:139], v16 offset:288
    ds_read_b128 v[68:71], v180
    ds_read_b128 v[76:79], v181
    s_cmp_lg_u32 s61, 3
    s_cbranch_scc1 K_rr_16
    ds_read_b128 v[36:39], v188 offset:49152
    ds_read_b128 v[40:43], v189 offset:49152
    ds_read_b128 v[44:47], v190 offset:49152
    ds_read_b128 v[48:51], v191 offset:49152
K_rr_16:
    s_add_u32 m0, s51, 0
    s_movk_i32 s49, 1152
    buffer_load_dwordx4 v8, s[4:7], s49 offen  lds
    s_add_u32 m0, s52, 0
    s_add_u32 s50, s50, s48
    buffer_load_dwordx4 v12, s[8:11], s50 offen  lds
    s_waitcnt lgkmcnt(0)
    s_mov_b32 m0, s60
    s_add_u32 s53, s51, 51200
    buffer_load_dwordx4 v4, s[12:15], s53 offen offset:0 lds
    buffer_load_dwordx4 v4, s[12:15], s53 offen offset:1024 lds
    s_add_u32 m0, s60, 2048
    s_mov_b32 s49, 34304
    buffer_load_dwordx4 v14, s[4:7], s49 offen lds
    s_add_u32 m0, s60, 3072
    s_nop 0
    buffer_load_dwordx4 v19, s[4:7], s49 offen lds
    s_add_u32 m0, s52, 1024
    s_nop 0
    buffer_load_dwordx4 v13, s[8:11], s50 offen  lds
    s_add_u32 m0, s51, 1024
    s_movk_i32 s49, 1152
    buffer_load_dwordx4 v9, s[4:7], s49 offen  lds
    s_add_u32 m0, s52, 2048
    s_add_u32 s50, s50, s48
    buffer_load_dwordx4 v12, s[8:11], s50 offen  lds
    s_add_u32 m0, s52, 3072
    s_nop 0
    buffer_load_dwordx4 v13, s[8:11], s50 offen  lds
    s_add_u32 m0, s51, 2048
    s_movk_i32 s49, 1152
    buffer_load_dwordx4 v10, s[4:7], s49 offen  lds
    s_add_u32 m0, s52, 4096
    s_add_u32 s50, s50, s48
    buffer_load_dwordx4 v12, s[8:11], s50 offen  lds
    s_add_u32 m0, s52, 5120
    s_nop 0
    buffer_load_dwordx4 v13, s[8:11], s50 offen  lds
    s_add_u32 m0, s51, 3072
    s_movk_i32 s49, 1152
    buffer_load_dwordx4 v11, s[4:7], s49 offen  lds
    s_add_u32 m0, s52, 6144
    s_add_u32 s50, s50, s48
    buffer_load_dwordx4 v12, s[8:11], s50 offen  lds
    s_add_u32 m0, s52, 7168
    s_nop 0
    buffer_load_dwordx4 v13, s[8:11], s50 offen  lds
    s_waitcnt vmcnt(16)
    s_barrier
    s_waitcnt vmcnt(10)
    ds_read_b64_tr_b16 v[140:141], v16 offset:0
    ds_read_b64_tr_b16 v[142:143], v16 offset:256
    ds_read_b64_tr_b16 v[144:145], v16 offset:32
    ds_read_b64_tr_b16 v[146:147], v16 offset:288
    ds_read_b128 v[72:75], v180
    ds_read_b128 v[80:83], v181
    s_add_u32 m0, s51, 49152
    s_movk_i32 s49, 1280
    buffer_load_dwordx4 v8, s[4:7], s49 offen  lds
    s_add_u32 m0, s52, 49152
    s_add_u32 s50, s50, s48
    buffer_load_dwordx4 v12, s[8:11], s50 offen  lds
    s_waitcnt lgkmcnt(0)
    v_mov_b32_dpp v172, v184 row_newbcast:2 row_mask:0xf bank_mask:0xf
    v_mov_b32_dpp v173, v185 row_newbcast:2 row_mask:0xf bank_mask:0xf
    v_mov_b32_dpp v174, v186 row_newbcast:2 row_mask:0xf bank_mask:0xf
    v_mov_b32_dpp v175, v187 row_newbcast:2 row_mask:0xf bank_mask:0xf
    v_mov_b32_dpp v176, v184 row_newbcast:3 row_mask:0xf bank_mask:0xf
    v_mov_b32_dpp v177, v185 row_newbcast:3 row_mask:0xf bank_mask:0xf
    v_mov_b32_dpp v178, v186 row_newbcast:3 row_mask:0xf bank_mask:0xf
    v_mov_b32_dpp v179, v187 row_newbcast:3 row_mask:0xf bank_mask:0xf
    s_bitcmp1_b32 s37, 3
    s_cbranch_scc1 K_sv_17
    v_mfma_f32_16x16x32_bf16 v[148:151], v[100:103], v[36:39], v[148:151]
    v_mfma_f32_16x16x32_bf16 v[152:155], v[104:107], v[36:39], v[152:155]
    v_mfma_f32_16x16x32_bf16 v[160:163], v[100:103], v[40:43], v[160:163]
    v_mfma_f32_16x16x32_bf16 v[164:167], v[104:107], v[40:43], v[164:167]
    v_mfma_f32_16x16x32_bf16 v[156:159], v[172:175], v[36:39], v[156:159]
    v_mfma_f32_16x16x32_bf16 v[148:151], v[108:111], v[44:47], v[148:151]
    v_mfma_f32_16x16x32_bf16 v[152:155], v[112:115], v[44:47], v[152:155]
    v_mfma_f32_16x16x32_bf16 v[160:163], v[108:111], v[48:51], v[160:163]
    v_mfma_f32_16x16x32_bf16 v[164:167], v[112:115], v[48:51], v[164:167]
    v_mfma_f32_16x16x32_bf16 v[156:159], v[176:179], v[44:47], v[156:159]
    s_branch K_se_18
K_sv_17:
    v_mfma_f32_16x16x32_bf16 v[148:151], v[36:39], v[100:103], v[148:151]
    v_mfma_f32_16x16x32_bf16 v[152:155], v[36:39], v[104:107], v[152:155]
    v_mfma_f32_16x16x32_bf16 v[160:163], v[40:43], v[100:103], v[160:163]
    v_mfma_f32_16x16x32_bf16 v[164:167], v[40:43], v[104:107], v[164:167]
    v_mfma_f32_16x16x32_bf16 v[168:171], v[172:175], v[40:43], v[168:171]
    v_mfma_f32_16x16x32_bf16 v[148:151], v[44:47], v[108:111], v[148:151]
    v_mfma_f32_16x16x32_bf16 v[152:155], v[44:47], v[112:115], v[152:155]
    v_mfma_f32_16x16x32_bf16 v[160:163], v[48:51], v[108:111], v[160:163]
    v_mfma_f32_16x16x32_bf16 v[164:167], v[48:51], v[112:115], v[164:167]
    v_mfma_f32_16x16x32_bf16 v[168:171], v[176:179], v[48:51], v[168:171]
K_se_18:
    s_add_u32 m0, s52, 50176
    s_nop 0
    buffer_load_dwordx4 v13, s[8:11], s50 offen  lds
    s_add_u32 m0, s51, 50176
    s_movk_i32 s49, 1280
    buffer_load_dwordx4 v9, s[4:7], s49 offen  lds
    s_add_u32 m0, s52, 51200
    s_add_u32 s50, s50, s48
    buffer_load_dwordx4 v12, s[8:11], s50 offen  lds
    v_mov_b32_dpp v172, v184 row_newbcast:6 row_mask:0xf bank_mask:0xf
    v_mov_b32_dpp v173, v185 row_newbcast:6 row_mask:0xf bank_mask:0xf
    v_mov_b32_dpp v174, v186 row_newbcast:6 row_mask:0xf bank_mask:0xf
    v_mov_b32_dpp v175, v187 row_newbcast:6 row_mask:0xf bank_mask:0xf
    v_mov_b32_dpp v176, v184 row_newbcast:7 row_mask:0xf bank_mask:0xf
    v_mov_b32_dpp v177, v185 row_newbcast:7 row_mask:0xf bank_mask:0xf
    v_mov_b32_dpp v178, v186 row_newbcast:7 row_mask:0xf bank_mask:0xf
    v_mov_b32_dpp v179, v187 row_newbcast:7 row_mask:0xf bank_mask:0xf
    s_bitcmp1_b32 s37, 3
    s_cbranch_scc1 K_sv_19
    v_mfma_f32_16x16x32_bf16 v[148:151], v[132:135], v[68:71], v[148:151]
    v_mfma_f32_16x16x32_bf16 v[152:155], v[136:139], v[68:71], v[152:155]
    v_mfma_f32_16x16x32_bf16 v[160:163], v[132:135], v[72:75], v[160:163]
    v_mfma_f32_16x16x32_bf16 v[164:167], v[136:139], v[72:75], v[164:167]
    v_mfma_f32_16x16x32_bf16 v[156:159], v[172:175], v[68:71], v[156:159]
    v_mfma_f32_16x16x32_bf16 v[148:151], v[140:143], v[76:79], v[148:151]
    v_mfma_f32_16x16x32_bf16 v[152:155], v[144:147], v[76:79], v[152:155]
    v_mfma_f32_16x16x32_bf16 v[160:163], v[140:143], v[80:83], v[160:163]
    v_mfma_f32_16x16x32_bf16 v[164:167], v[144:147], v[80:83], v[164:167]
    v_mfma_f32_16x16x32_bf16 v[156:159], v[176:179], v[76:79], v[156:159]
    s_branch K_se_20
K_sv_19:
    v_mfma_f32_16x16x32_bf16 v[148:151], v[68:71], v[132:135], v[148:151]
    v_mfma_f32_16x16x32_bf16 v[152:155], v[68:71], v[136:139], v[152:155]
    v_mfma_f32_16x16x32_bf16 v[160:163], v[72:75], v[132:135], v[160:163]
    v_mfma_f32_16x16x32_bf16 v[164:167], v[72:75], v[136:139], v[164:167]
    v_mfma_f32_16x16x32_bf16 v[168:171], v[172:175], v[72:75], v[168:171]
    v_mfma_f32_16x16x32_bf16 v[148:151], v[76:79], v[140:143], v[148:151]
    v_mfma_f32_16x16x32_bf16 v[152:155], v[76:79], v[144:147], v[152:155]
    v_mfma_f32_16x16x32_bf16 v[160:163], v[80:83], v[140:143], v[160:163]
    v_mfma_f32_16x16x32_bf16 v[164:167], v[80:83], v[144:147], v[164:167]
    v_mfma_f32_16x16x32_bf16 v[168:171], v[176:179], v[80:83], v[168:171]
K_se_20:
    s_add_u32 m0, s52, 52224
    s_nop 0
    buffer_load_dwordx4 v13, s[8:11], s50 offen  lds
    s_add_u32 m0, s51, 51200
    s_movk_i32 s49, 1280
    buffer_load_dwordx4 v10, s[4:7], s49 offen  lds
    s_add_u32 m0, s52, 53248
    s_add_u32 s50, s50, s48
    buffer_load_dwordx4 v12, s[8:11], s50 offen  lds
    s_add_u32 m0, s52, 54272
    s_nop 0
    buffer_load_dwordx4 v13, s[8:11], s50 offen  lds
    s_add_u32 m0, s51, 52224
    s_movk_i32 s49, 1280
    buffer_load_dwordx4 v11, s[4:7], s49 offen  lds
    s_add_u32 m0, s52, 55296
    s_add_u32 s50, s50, s48
    buffer_load_dwordx4 v12, s[8:11], s50 offen  lds
    s_add_u32 m0, s52, 56320
    s_nop 0
    buffer_load_dwordx4 v13, s[8:11], s50 offen  lds
    s_waitcnt vmcnt(12)
    s_barrier
    s_cmp_eq_u32 s61, 0
    s_cbranch_scc1 K_pw_21
    ds_write_b128 v196, v[148:151] offset:0
    ds_write_b128 v196, v[152:155] offset:1024
    ds_write_b32 v197, v156 offset:2048
K_pw_21:
    s_cmp_eq_u32 s61, 1
    s_cbranch_scc1 K_pw_22
    ds_write_b128 v196, v[160:163] offset:6912
    ds_write_b128 v196, v[164:167] offset:7936
    ds_write_b32 v197, v168 offset:8960
K_pw_22:
    s_add_u32 m0, s51, 98304
    s_movk_i32 s49, 1408
    buffer_load_dwordx4 v8, s[4:7], s49 offen  lds
    s_add_u32 m0, s52, 98304
    s_add_u32 s50, s50, s48
    buffer_load_dwordx4 v12, s[8:11], s50 offen  lds
    s_add_u32 m0, s52, 99328
    s_nop 0
    buffer_load_dwordx4 v13, s[8:11], s50 offen  lds
    s_add_u32 m0, s51, 99328
    s_movk_i32 s49, 1408
    buffer_load_dwordx4 v9, s[4:7], s49 offen  lds
    s_add_u32 m0, s52, 100352
    s_add_u32 s50, s50, s48
    buffer_load_dwordx4 v12, s[8:11], s50 offen  lds
    s_add_u32 m0, s52, 101376
    s_nop 0
    buffer_load_dwordx4 v13, s[8:11], s50 offen  lds
    s_add_u32 m0, s51, 100352
    s_movk_i32 s49, 1408
    buffer_load_dwordx4 v10, s[4:7], s49 offen  lds
    s_add_u32 m0, s52, 102400
    s_add_u32 s50, s50, s48
    buffer_load_dwordx4 v12, s[8:11], s50 offen  lds
    s_add_u32 m0, s52, 103424
    s_nop 0
    buffer_load_dwordx4 v13, s[8:11], s50 offen  lds
    s_add_u32 m0, s51, 101376
    s_movk_i32 s49, 1408
    buffer_load_dwordx4 v11, s[4:7], s49 offen  lds
    s_add_u32 m0, s52, 104448
    s_add_u32 s50, s50, s48
    buffer_load_dwordx4 v12, s[8:11], s50 offen  lds
    s_add_u32 m0, s52, 105472
    s_nop 0
    buffer_load_dwordx4 v13, s[8:11], s50 offen  lds
    s_waitcnt lgkmcnt(0)
    s_waitcnt vmcnt(12)
    s_barrier
    ds_read_b128 v[20:23], v198 offset:0
    ds_read_b128 v[24:27], v198 offset:1024
    ds_read_b32 v28, v199 offset:2048
    ds_read_b128 v[32:35], v198 offset:2304
    ds_read_b128 v[36:39], v198 offset:3328
    ds_read_b32 v40, v199 offset:4352
    ds_read_b128 v[44:47], v198 offset:4608
    ds_read_b128 v[48:51], v198 offset:5632
    ds_read_b32 v52, v199 offset:6656
    s_add_u32 m0, s51, 0
    s_movk_i32 s49, 1536
    buffer_load_dwordx4 v8, s[4:7], s49 offen  lds
    s_add_u32 m0, s52, 0
    s_add_u32 s50, s50, s48
    buffer_load_dwordx4 v12, s[8:11], s50 offen  lds
    s_cmp_gt_u32 s61, 1
    s_cbranch_scc1 K_pe_24
    s_cmp_eq_u32 s61, 0
    s_cbranch_scc1 K_p0_25
    v_mov_b32 v148, v160
    v_mov_b32 v149, v161
    v_mov_b32 v150, v162
    v_mov_b32 v151, v163
    v_mov_b32 v152, v164
    v_mov_b32 v153, v165
    v_mov_b32 v154, v166
    v_mov_b32 v155, v167
    v_mov_b32 v156, v168
K_p0_25:
    s_and_b32 s40, s37, 3
    s_lshl2_add_u32 s40, s36, s40
    s_lshl_b32 s41, s40, 12
    s_add_u32 s41, s41, 16777216
    s_lshl1_add_u32 s40, s40, s61
    s_waitcnt lgkmcnt(0)
    v_add_f32 v148, v148, v20
    v_add_f32 v149, v149, v21
    v_add_f32 v150, v150, v22
    v_add_f32 v151, v151, v23
    v_add_f32 v152, v152, v24
    v_add_f32 v153, v153, v25
    v_add_f32 v154, v154, v26
    v_add_f32 v155, v155, v27
    v_add_f32 v156, v156, v28
    v_add_f32 v148, v148, v32
    v_add_f32 v149, v149, v33
    v_add_f32 v150, v150, v34
    v_add_f32 v151, v151, v35
    v_add_f32 v152, v152, v36
    v_add_f32 v153, v153, v37
    v_add_f32 v154, v154, v38
    v_add_f32 v155, v155, v39
    v_add_f32 v156, v156, v40
    v_add_f32 v148, v148, v44
    v_add_f32 v149, v149, v45
    v_add_f32 v150, v150, v46
    v_add_f32 v151, v151, v47
    v_add_f32 v152, v152, v48
    v_add_f32 v153, v153, v49
    v_add_f32 v154, v154, v50
    v_add_f32 v155, v155, v51
    v_add_f32 v156, v156, v52
    s_lshr_b32 s42, s37, 3
    s_cmp_lg_u32 s42, s61
    s_cbranch_scc1 K_pg_26
    v_mul_f32 v156, 0xbfb8aa3b, v156
    v_exp_f32 v156, v156
    s_lshl_b32 s40, s40, 6
    v_add_f32 v156, 1.0, v156
    v_rcp_f32 v156, v156
    s_add_u32 s40, s40, 17039360
    s_mov_b64 exec, 0xffff
    buffer_store_dword v156, v243, s[20:23], s40 offen sc1
    s_mov_b64 exec, -1
K_pg_26:
    s_bitcmp1_b32 s37, 3
    s_cbranch_scc1 K_pv_23
    v_mul_f32 v148, 0x3e8293ee, v148
    v_mul_f32 v149, 0x3e8293ee, v149
    v_mul_f32 v150, 0x3e8293ee, v150
    v_mul_f32 v151, 0x3e8293ee, v151
    v_mul_f32 v152, 0x3e8293ee, v152
    v_mul_f32 v153, 0x3e8293ee, v153
    v_mul_f32 v154, 0x3e8293ee, v154
    v_mul_f32 v155, 0x3e8293ee, v155
    v_cvt_pk_bf16_f32 v172, v148, v149
    v_cvt_pk_bf16_f32 v173, v150, v151
    v_cvt_pk_bf16_f32 v174, v152, v153
    v_cvt_pk_bf16_f32 v175, v154, v155
    v_lshlrev_b32 v5, 9, v3
    v_lshl_add_u32 v5, v2, 4, v5
    s_lshl_b32 s42, s61, 8
    s_add_u32 s41, s41, s42
    buffer_store_dwordx4 v[172:175], v5, s[20:23], s41 offen sc1
    s_branch K_pe_24
K_pv_23:
    v_cvt_pk_bf16_f32 v172, v148, v149
    v_cvt_pk_bf16_f32 v173, v150, v151
    v_cvt_pk_bf16_f32 v174, v152, v153
    v_cvt_pk_bf16_f32 v175, v154, v155
    v_lshrrev_b32 v5, 1, v3
    v_lshlrev_b32 v5, 9, v5
    v_lshl_add_u32 v5, v2, 4, v5
    v_and_b32 v6, 1, v3
    v_lshl_add_u32 v5, v6, 3, v5
    s_lshl_b32 s42, s61, 10
    s_add_u32 s41, s41, s42
    buffer_store_dwordx2 v[172:173], v5, s[20:23], s41 offen offset:2048 sc1
    buffer_store_dwordx2 v[174:175], v5, s[20:23], s41 offen offset:2304 sc1
K_pe_24:
    s_add_u32 m0, s52, 1024
    s_nop 0
    buffer_load_dwordx4 v13, s[8:11], s50 offen  lds
    s_add_u32 m0, s51, 1024
    s_movk_i32 s49, 1536
    buffer_load_dwordx4 v9, s[4:7], s49 offen  lds
    s_add_u32 m0, s52, 2048
    s_add_u32 s50, s50, s48
    buffer_load_dwordx4 v12, s[8:11], s50 offen  lds
    s_add_u32 m0, s52, 3072
    s_nop 0
    buffer_load_dwordx4 v13, s[8:11], s50 offen  lds
    s_add_u32 m0, s51, 2048
    s_movk_i32 s49, 1536
    buffer_load_dwordx4 v10, s[4:7], s49 offen  lds
    s_add_u32 m0, s52, 4096
    s_add_u32 s50, s50, s48
    buffer_load_dwordx4 v12, s[8:11], s50 offen  lds
    s_add_u32 m0, s52, 5120
    s_nop 0
    buffer_load_dwordx4 v13, s[8:11], s50 offen  lds
    s_add_u32 m0, s51, 3072
    s_movk_i32 s49, 1536
    buffer_load_dwordx4 v11, s[4:7], s49 offen  lds
    s_add_u32 m0, s52, 6144
    s_add_u32 s50, s50, s48
    buffer_load_dwordx4 v12, s[8:11], s50 offen  lds
    s_add_u32 m0, s52, 7168
    s_nop 0
    buffer_load_dwordx4 v13, s[8:11], s50 offen  lds
    s_waitcnt vmcnt(9)
    s_barrier
    s_cmp_lg_u32 s61, 3
    s_cbranch_scc1 K_nf_27
    s_and_b32 s40, s37, 3
    s_lshl2_add_u32 s40, s36, s40
    s_lshl_b32 s40, s40, 5
    s_lshr_b32 s41, s37, 3
    s_add_u32 s40, s40, s41
    s_lshl_b32 s40, s40, 2
    s_add_u32 s40, s40, 17301504
    s_mov_b64 exec, 1
    buffer_store_dword v240, off, s[20:23], s40 sc1
    s_mov_b64 exec, -1
K_nf_27:
    s_add_u32 m0, s51, 49152
    s_movk_i32 s49, 1664
    buffer_load_dwordx4 v8, s[4:7], s49 offen  lds
    s_add_u32 m0, s52, 49152
    s_add_u32 s50, s50, s48
    buffer_load_dwordx4 v12, s[8:11], s50 offen  lds
    s_add_u32 m0, s52, 50176
    s_nop 0
    buffer_load_dwordx4 v13, s[8:11], s50 offen  lds
    s_add_u32 m0, s51, 50176
    s_movk_i32 s49, 1664
    buffer_load_dwordx4 v9, s[4:7], s49 offen  lds
    s_add_u32 m0, s52, 51200
    s_add_u32 s50, s50, s48
    buffer_load_dwordx4 v12, s[8:11], s50 offen  lds
    s_add_u32 m0, s52, 52224
    s_nop 0
    buffer_load_dwordx4 v13, s[8:11], s50 offen  lds
    s_add_u32 m0, s51, 51200
    s_movk_i32 s49, 1664
    buffer_load_dwordx4 v10, s[4:7], s49 offen  lds
    s_add_u32 m0, s52, 53248
    s_add_u32 s50, s50, s48
    buffer_load_dwordx4 v12, s[8:11], s50 offen  lds
    s_add_u32 m0, s52, 54272
    s_nop 0
    buffer_load_dwordx4 v13, s[8:11], s50 offen  lds
    s_add_u32 m0, s51, 52224
    s_movk_i32 s49, 1664
    buffer_load_dwordx4 v11, s[4:7], s49 offen  lds
    s_add_u32 m0, s52, 55296
    s_add_u32 s50, s50, s48
    buffer_load_dwordx4 v12, s[8:11], s50 offen  lds
    s_add_u32 m0, s52, 56320
    s_nop 0
    buffer_load_dwordx4 v13, s[8:11], s50 offen  lds
    s_waitcnt vmcnt(12)
    s_barrier
    s_add_u32 m0, s51, 98304
    s_movk_i32 s49, 1792
    buffer_load_dwordx4 v8, s[4:7], s49 offen  lds
    s_add_u32 m0, s52, 98304
    s_add_u32 s50, s50, s48
    buffer_load_dwordx4 v12, s[8:11], s50 offen  lds
    s_add_u32 m0, s52, 99328
    s_nop 0
    buffer_load_dwordx4 v13, s[8:11], s50 offen  lds
    s_add_u32 m0, s51, 99328
    s_movk_i32 s49, 1792
    buffer_load_dwordx4 v9, s[4:7], s49 offen  lds
    s_add_u32 m0, s52, 100352
    s_add_u32 s50, s50, s48
    buffer_load_dwordx4 v12, s[8:11], s50 offen  lds
    s_add_u32 m0, s52, 101376
    s_nop 0
    buffer_load_dwordx4 v13, s[8:11], s50 offen  lds
    s_add_u32 m0, s51, 100352
    s_movk_i32 s49, 1792
    buffer_load_dwordx4 v10, s[4:7], s49 offen  lds
    s_add_u32 m0, s52, 102400
    s_add_u32 s50, s50, s48
    buffer_load_dwordx4 v12, s[8:11], s50 offen  lds
    s_add_u32 m0, s52, 103424
    s_nop 0
    buffer_load_dwordx4 v13, s[8:11], s50 offen  lds
    s_add_u32 m0, s51, 101376
    s_movk_i32 s49, 1792
    buffer_load_dwordx4 v11, s[4:7], s49 offen  lds
    s_add_u32 m0, s52, 104448
    s_add_u32 s50, s50, s48
    buffer_load_dwordx4 v12, s[8:11], s50 offen  lds
    s_add_u32 m0, s52, 105472
    s_nop 0
    buffer_load_dwordx4 v13, s[8:11], s50 offen  lds
    s_waitcnt vmcnt(12)
    s_barrier
    s_add_u32 m0, s51, 0
    s_movk_i32 s49, 1920
    buffer_load_dwordx4 v8, s[4:7], s49 offen  lds
    s_add_u32 m0, s52, 0
    s_add_u32 s50, s50, s48
    buffer_load_dwordx4 v12, s[8:11], s50 offen  lds
    s_add_u32 m0, s52, 1024
    s_nop 0
    buffer_load_dwordx4 v13, s[8:11], s50 offen  lds
    s_add_u32 m0, s51, 1024
    s_movk_i32 s49, 1920
    buffer_load_dwordx4 v9, s[4:7], s49 offen  lds
    s_add_u32 m0, s52, 2048
    s_add_u32 s50, s50, s48
    buffer_load_dwordx4 v12, s[8:11], s50 offen  lds
    s_add_u32 m0, s52, 3072
    s_nop 0
    buffer_load_dwordx4 v13, s[8:11], s50 offen  lds
    s_add_u32 m0, s51, 2048
    s_movk_i32 s49, 1920
    buffer_load_dwordx4 v10, s[4:7], s49 offen  lds
    s_add_u32 m0, s52, 4096
    s_add_u32 s50, s50, s48
    buffer_load_dwordx4 v12, s[8:11], s50 offen  lds
    s_add_u32 m0, s52, 5120
    s_nop 0
    buffer_load_dwordx4 v13, s[8:11], s50 offen  lds
    s_add_u32 m0, s51, 3072
    s_movk_i32 s49, 1920
    buffer_load_dwordx4 v11, s[4:7], s49 offen  lds
    s_add_u32 m0, s52, 6144
    s_add_u32 s50, s50, s48
    buffer_load_dwordx4 v12, s[8:11], s50 offen  lds
    s_add_u32 m0, s52, 7168
    s_nop 0
    buffer_load_dwordx4 v13, s[8:11], s50 offen  lds
    s_waitcnt vmcnt(12)
    s_branch K_phend
K_ph1_1:
    s_barrier
    s_cmp_lg_u32 s61, 0
    s_cbranch_scc1 K_rr_28
    ds_read_b128 v[20:23], v188 offset:0
    ds_read_b128 v[24:27], v189 offset:0
    ds_read_b128 v[28:31], v190 offset:0
    ds_read_b128 v[32:35], v191 offset:0
K_rr_28:
    s_add_u32 m0, s52, 54272
    s_nop 0
    buffer_load_dwordx4 v13, s[8:11], s50 offen  lds
    s_add_u32 m0, s51, 52224
    s_movk_i32 s49, 128
    buffer_load_dwordx4 v11, s[4:7], s49 offen  lds
    s_add_u32 m0, s52, 55296
    s_add_u32 s50, s50, s48
    buffer_load_dwordx4 v12, s[8:11], s50 offen  lds
    s_add_u32 m0, s52, 56320
    s_nop 0
    buffer_load_dwordx4 v13, s[8:11], s50 offen  lds
    s_waitcnt lgkmcnt(0)
    buffer_load_dwordx4 v[184:187], v15, s[16:19], 0 offen
    s_mov_b32 m0, s60
    s_add_u32 s53, s51, 0
    buffer_load_dwordx4 v4, s[12:15], s53 offen offset:0 lds
    buffer_load_dwordx4 v4, s[12:15], s53 offen offset:1024 lds
    s_add_u32 m0, s51, 98304
    s_movk_i32 s49, 256
    buffer_load_dwordx4 v8, s[4:7], s49 offen  lds
    s_add_u32 m0, s52, 98304
    s_add_u32 s50, s50, s48
    buffer_load_dwordx4 v12, s[8:11], s50 offen  lds
    s_add_u32 m0, s52, 99328
    s_nop 0
    buffer_load_dwordx4 v13, s[8:11], s50 offen  lds
    s_add_u32 m0, s51, 99328
    s_movk_i32 s49, 256
    buffer_load_dwordx4 v9, s[4:7], s49 offen  lds
    s_add_u32 m0, s52, 100352
    s_add_u32 s50, s50, s48
    buffer_load_dwordx4 v12, s[8:11], s50 offen  lds
    s_add_u32 m0, s52, 101376
    s_nop 0
    buffer_load_dwordx4 v13, s[8:11], s50 offen  lds
    s_add_u32 m0, s51, 100352
    s_movk_i32 s49, 256
    buffer_load_dwordx4 v10, s[4:7], s49 offen  lds
    s_add_u32 m0, s52, 102400
    s_add_u32 s50, s50, s48
    buffer_load_dwordx4 v12, s[8:11], s50 offen  lds
    s_add_u32 m0, s52, 103424
    s_nop 0
    buffer_load_dwordx4 v13, s[8:11], s50 offen  lds
    s_add_u32 m0, s51, 101376
    s_movk_i32 s49, 256
    buffer_load_dwordx4 v11, s[4:7], s49 offen  lds
    s_waitcnt vmcnt(13)
    s_barrier
    s_waitcnt vmcnt(10)
    ds_read_b64_tr_b16 v[84:85], v16 offset:0
    ds_read_b64_tr_b16 v[86:87], v16 offset:256
    ds_read_b64_tr_b16 v[88:89], v16 offset:32
    ds_read_b64_tr_b16 v[90:91], v16 offset:288
    s_cmp_lg_u32 s61, 1
    s_cbranch_scc1 K_rr_29
    ds_read_b128 v[20:23], v188 offset:49152
    ds_read_b128 v[24:27], v189 offset:49152
    ds_read_b128 v[28:31], v190 offset:49152
    ds_read_b128 v[32:35], v191 offset:49152
K_rr_29:
    s_add_u32 m0, s52, 104448
    s_add_u32 s50, s50, s48
    buffer_load_dwordx4 v12, s[8:11], s50 offen  lds
    s_add_u32 m0, s52, 105472
    s_nop 0
    buffer_load_dwordx4 v13, s[8:11], s50 offen  lds
    s_waitcnt lgkmcnt(0)
    s_mov_b32 m0, s60
    s_add_u32 s53, s51, 2048
    buffer_load_dwordx4 v4, s[12:15], s53 offen offset:0 lds
    buffer_load_dwordx4 v4, s[12:15], s53 offen offset:1024 lds
    s_add_u32 m0, s51, 0
    s_movk_i32 s49, 384
    buffer_load_dwordx4 v8, s[4:7], s49 offen  lds
    s_add_u32 m0, s52, 0
    s_add_u32 s50, s50, s48
    buffer_load_dwordx4 v12, s[8:11], s50 offen  lds
    s_add_u32 m0, s52, 1024
    s_nop 0
    buffer_load_dwordx4 v13, s[8:11], s50 offen  lds
    s_add_u32 m0, s51, 1024
    s_movk_i32 s49, 384
    buffer_load_dwordx4 v9, s[4:7], s49 offen  lds
    s_add_u32 m0, s52, 2048
    s_add_u32 s50, s50, s48
    buffer_load_dwordx4 v12, s[8:11], s50 offen  lds
    s_add_u32 m0, s52, 3072
    s_nop 0
    buffer_load_dwordx4 v13, s[8:11], s50 offen  lds
    s_add_u32 m0, s51, 2048
    s_movk_i32 s49, 384
    buffer_load_dwordx4 v10, s[4:7], s49 offen  lds
    s_add_u32 m0, s52, 4096
    s_add_u32 s50, s50, s48
    buffer_load_dwordx4 v12, s[8:11], s50 offen  lds
    s_add_u32 m0, s52, 5120
    s_nop 0
    buffer_load_dwordx4 v13, s[8:11], s50 offen  lds
    s_add_u32 m0, s51, 3072
    s_movk_i32 s49, 384
    buffer_load_dwordx4 v11, s[4:7], s49 offen  lds
    s_add_u32 m0, s52, 6144
    s_add_u32 s50, s50, s48
    buffer_load_dwordx4 v12, s[8:11], s50 offen  lds
    s_add_u32 m0, s52, 7168
    s_nop 0
    buffer_load_dwordx4 v13, s[8:11], s50 offen  lds
    s_waitcnt vmcnt(14)
    s_barrier
    s_waitcnt vmcnt(12)
    ds_read_b64_tr_b16 v[92:93], v16 offset:0
    ds_read_b64_tr_b16 v[94:95], v16 offset:256
    ds_read_b64_tr_b16 v[96:97], v16 offset:32
    ds_read_b64_tr_b16 v[98:99], v16 offset:288
    s_cmp_lg_u32 s61, 2
    s_cbranch_scc1 K_rr_30
    v_add_u32 v192, 98304, v188
    ds_read_b128 v[20:23], v192
    v_add_u32 v193, 98304, v189
    ds_read_b128 v[24:27], v193
    v_add_u32 v194, 98304, v190
    ds_read_b128 v[28:31], v194
    v_add_u32 v195, 98304, v191
    ds_read_b128 v[32:35], v195
K_rr_30:
    s_add_u32 m0, s51, 49152
    s_movk_i32 s49, 512
    buffer_load_dwordx4 v8, s[4:7], s49 offen  lds
    s_add_u32 m0, s52, 49152
    s_add_u32 s50, s50, s48
    buffer_load_dwordx4 v12, s[8:11], s50 offen  lds
    s_waitcnt lgkmcnt(0)
    s_mov_b32 m0, s60
    s_add_u32 s53, s51, 32768
    buffer_load_dwordx4 v4, s[12:15], s53 offen offset:0 lds
    buffer_load_dwordx4 v4, s[12:15], s53 offen offset:1024 lds
    s_add_u32 m0, s52, 50176
    s_nop 0
    buffer_load_dwordx4 v13, s[8:11], s50 offen  lds
    s_add_u32 m0, s51, 50176
    s_movk_i32 s49, 512
    buffer_load_dwordx4 v9, s[4:7], s49 offen  lds
    s_add_u32 m0, s52, 51200
    s_add_u32 s50, s50, s48
    buffer_load_dwordx4 v12, s[8:11], s50 offen  lds
    s_add_u32 m0, s52, 52224
    s_nop 0
    buffer_load_dwordx4 v13, s[8:11], s50 offen  lds
    s_add_u32 m0, s51, 51200
    s_movk_i32 s49, 512
    buffer_load_dwordx4 v10, s[4:7], s49 offen  lds
    s_add_u32 m0, s52, 53248
    s_add_u32 s50, s50, s48
    buffer_load_dwordx4 v12, s[8:11], s50 offen  lds
    s_add_u32 m0, s52, 54272
    s_nop 0
    buffer_load_dwordx4 v13, s[8:11], s50 offen  lds
    s_add_u32 m0, s51, 52224
    s_movk_i32 s49, 512
    buffer_load_dwordx4 v11, s[4:7], s49 offen  lds
    s_add_u32 m0, s52, 55296
    s_add_u32 s50, s50, s48
    buffer_load_dwordx4 v12, s[8:11], s50 offen  lds
    s_add_u32 m0, s52, 56320
    s_nop 0
    buffer_load_dwordx4 v13, s[8:11], s50 offen  lds
    s_mul_i32 s40, s62, 384
    s_mov_b64 exec, 0xffff
    buffer_load_dword v255, v17, s[8:11], s40 offen
    s_mov_b64 exec, -1
    s_waitcnt vmcnt(15)
    s_barrier
    s_waitcnt vmcnt(11)
    ds_read_b64_tr_b16 v[116:117], v16 offset:0
    ds_read_b64_tr_b16 v[118:119], v16 offset:256
    ds_read_b64_tr_b16 v[120:121], v16 offset:32
    ds_read_b64_tr_b16 v[122:123], v16 offset:288
    s_cmp_lg_u32 s61, 3
    s_cbranch_scc1 K_rr_31
    ds_read_b128 v[20:23], v188 offset:0
    ds_read_b128 v[24:27], v189 offset:0
    ds_read_b128 v[28:31], v190 offset:0
    ds_read_b128 v[32:35], v191 offset:0
K_rr_31:
    s_add_u32 m0, s51, 98304
    s_movk_i32 s49, 640
    buffer_load_dwordx4 v8, s[4:7], s49 offen  lds
    s_add_u32 m0, s52, 98304
    s_add_u32 s50, s50, s48
    buffer_load_dwordx4 v12, s[8:11], s50 offen  lds
    s_waitcnt lgkmcnt(0)
    s_mov_b32 m0, s60
    s_add_u32 s53, s51, 34816
    buffer_load_dwordx4 v4, s[12:15], s53 offen offset:0 lds
    buffer_load_dwordx4 v4, s[12:15], s53 offen offset:1024 lds
    s_add_u32 m0, s52, 99328
    s_nop 0
    buffer_load_dwordx4 v13, s[8:11], s50 offen  lds
    s_add_u32 m0, s51, 99328
    s_movk_i32 s49, 640
    buffer_load_dwordx4 v9, s[4:7], s49 offen  lds
    s_add_u32 m0, s52, 100352
    s_add_u32 s50, s50, s48
    buffer_load_dwordx4 v12, s[8:11], s50 offen  lds
    s_add_u32 m0, s52, 101376
    s_nop 0
    buffer_load_dwordx4 v13, s[8:11], s50 offen  lds
    s_add_u32 m0, s51, 100352
    s_movk_i32 s49, 640
    buffer_load_dwordx4 v10, s[4:7], s49 offen  lds
    s_add_u32 m0, s52, 102400
    s_add_u32 s50, s50, s48
    buffer_load_dwordx4 v12, s[8:11], s50 offen  lds
    s_add_u32 m0, s52, 103424
    s_nop 0
    buffer_load_dwordx4 v13, s[8:11], s50 offen  lds
    s_add_u32 m0, s51, 101376
    s_movk_i32 s49, 640
    buffer_load_dwordx4 v11, s[4:7], s49 offen  lds
    s_add_u32 m0, s52, 104448
    s_add_u32 s50, s50, s48
    buffer_load_dwordx4 v12, s[8:11], s50 offen  lds
    s_add_u32 m0, s52, 105472
    s_nop 0
    buffer_load_dwordx4 v13, s[8:11], s50 offen  lds
    s_waitcnt vmcnt(15)
    s_barrier
    s_waitcnt vmcnt(10)
    ds_read_b64_tr_b16 v[124:125], v16 offset:0
    ds_read_b64_tr_b16 v[126:127], v16 offset:256
    ds_read_b64_tr_b16 v[128:129], v16 offset:32
    ds_read_b64_tr_b16 v[130:131], v16 offset:288
    s_cmp_lg_u32 s61, 0
    s_cbranch_scc1 K_rr_32
    ds_read_b128 v[36:39], v188 offset:49152
    ds_read_b128 v[40:43], v189 offset:49152
    ds_read_b128 v[44:47], v190 offset:49152
    ds_read_b128 v[48:51], v191 offset:49152
K_rr_32:
    s_add_u32 m0, s51, 0
    s_movk_i32 s49, 768
    buffer_load_dwordx4 v8, s[4:7], s49 offen  lds
    s_add_u32 m0, s52, 0
    s_add_u32 s50, s50, s48
    buffer_load_dwordx4 v12, s[8:11], s50 offen  lds
    s_waitcnt lgkmcnt(0)
    s_mov_b32 m0, s60
    s_add_u32 s53, s51, 16384
    buffer_load_dwordx4 v4, s[12:15], s53 offen offset:0 lds
    buffer_load_dwordx4 v4, s[12:15], s53 offen offset:1024 lds
    s_add_u32 m0, s60, 2048
    s_mov_b32 s49, 1024
    buffer_load_dwordx4 v14, s[4:7], s49 offen lds
    s_add_u32 m0, s60, 3072
    s_nop 0
    buffer_load_dwordx4 v19, s[4:7], s49 offen lds
    v_mov_b32_dpp v172, v184 row_newbcast:0 row_mask:0xf bank_mask:0xf
    v_mov_b32_dpp v173, v185 row_newbcast:0 row_mask:0xf bank_mask:0xf
    v_mov_b32_dpp v174, v186 row_newbcast:0 row_mask:0xf bank_mask:0xf
    v_mov_b32_dpp v175, v187 row_newbcast:0 row_mask:0xf bank_mask:0xf
    v_mov_b32_dpp v176, v184 row_newbcast:1 row_mask:0xf bank_mask:0xf
    v_mov_b32_dpp v177, v185 row_newbcast:1 row_mask:0xf bank_mask:0xf
    v_mov_b32_dpp v178, v186 row_newbcast:1 row_mask:0xf bank_mask:0xf
    v_mov_b32_dpp v179, v187 row_newbcast:1 row_mask:0xf bank_mask:0xf
    s_bitcmp1_b32 s37, 3
    s_cbranch_scc1 K_sv_33
    v_mfma_f32_16x16x32_bf16 v[148:151], v[84:87], v[20:23], v[148:151]
    v_mfma_f32_16x16x32_bf16 v[152:155], v[88:91], v[20:23], v[152:155]
    v_mfma_f32_16x16x32_bf16 v[160:163], v[84:87], v[24:27], v[160:163]
    v_mfma_f32_16x16x32_bf16 v[164:167], v[88:91], v[24:27], v[164:167]
    v_mfma_f32_16x16x32_bf16 v[156:159], v[172:175], v[20:23], v[156:159]
    v_mfma_f32_16x16x32_bf16 v[148:151], v[92:95], v[28:31], v[148:151]
    v_mfma_f32_16x16x32_bf16 v[152:155], v[96:99], v[28:31], v[152:155]
    v_mfma_f32_16x16x32_bf16 v[160:163], v[92:95], v[32:35], v[160:163]
    v_mfma_f32_16x16x32_bf16 v[164:167], v[96:99], v[32:35], v[164:167]
    v_mfma_f32_16x16x32_bf16 v[156:159], v[176:179], v[28:31], v[156:159]
    s_branch K_se_34
K_sv_33:
    v_mfma_f32_16x16x32_bf16 v[148:151], v[20:23], v[84:87], v[148:151]
    v_mfma_f32_16x16x32_bf16 v[152:155], v[20:23], v[88:91], v[152:155]
    v_mfma_f32_16x16x32_bf16 v[160:163], v[24:27], v[84:87], v[160:163]
    v_mfma_f32_16x16x32_bf16 v[164:167], v[24:27], v[88:91], v[164:167]
    v_mfma_f32_16x16x32_bf16 v[168:171], v[172:175], v[24:27], v[168:171]
    v_mfma_f32_16x16x32_bf16 v[148:151], v[28:31], v[92:95], v[148:151]
    v_mfma_f32_16x16x32_bf16 v[152:155], v[28:31], v[96:99], v[152:155]
    v_mfma_f32_16x16x32_bf16 v[160:163], v[32:35], v[92:95], v[160:163]
    v_mfma_f32_16x16x32_bf16 v[164:167], v[32:35], v[96:99], v[164:167]
    v_mfma_f32_16x16x32_bf16 v[168:171], v[176:179], v[32:35], v[168:171]
K_se_34:
    s_add_u32 m0, s52, 1024
    s_nop 0
    buffer_load_dwordx4 v13, s[8:11], s50 offen  lds
    s_add_u32 m0, s51, 1024
    s_movk_i32 s49, 768
    buffer_load_dwordx4 v9, s[4:7], s49 offen  lds
    s_add_u32 m0, s52, 2048
    s_add_u32 s50, s50, s48
    buffer_load_dwordx4 v12, s[8:11], s50 offen  lds
    s_add_u32 m0, s52, 3072
    s_nop 0
    buffer_load_dwordx4 v13, s[8:11], s50 offen  lds
    s_add_u32 m0, s51, 2048
    s_movk_i32 s49, 768
    buffer_load_dwordx4 v10, s[4:7], s49 offen  lds
    s_add_u32 m0, s52, 4096
    s_add_u32 s50, s50, s48
    buffer_load_dwordx4 v12, s[8:11], s50 offen  lds
    s_add_u32 m0, s52, 5120
    s_nop 0
    buffer_load_dwordx4 v13, s[8:11], s50 offen  lds
    s_add_u32 m0, s51, 3072
    s_movk_i32 s49, 768
    buffer_load_dwordx4 v11, s[4:7], s49 offen  lds
    s_add_u32 m0, s52, 6144
    s_add_u32 s50, s50, s48
    buffer_load_dwordx4 v12, s[8:11], s50 offen  lds
    s_add_u32 m0, s52, 7168
    s_nop 0
    buffer_load_dwordx4 v13, s[8:11], s50 offen  lds
    s_waitcnt vmcnt(16)
    s_barrier
    s_waitcnt vmcnt(10)
    ds_read_b64_tr_b16 v[100:101], v16 offset:0
    ds_read_b64_tr_b16 v[102:103], v16 offset:256
    ds_read_b64_tr_b16 v[104:105], v16 offset:32
    ds_read_b64_tr_b16 v[106:107], v16 offset:288
    ds_read_b128 v[52:55], v180
    ds_read_b128 v[60:63], v181
    s_cmp_lg_u32 s61, 1
    s_cbranch_scc1 K_rr_35
    v_add_u32 v192, 98304, v188
    ds_read_b128 v[36:39], v192
    v_add_u32 v193, 98304, v189
    ds_read_b128 v[40:43], v193
    v_add_u32 v194, 98304, v190
    ds_read_b128 v[44:47], v194
    v_add_u32 v195, 98304, v191
    ds_read_b128 v[48:51], v195
K_rr_35:
    s_add_u32 m0, s51, 49152
    s_movk_i32 s49, 896
    buffer_load_dwordx4 v8, s[4:7], s49 offen  lds
    s_add_u32 m0, s52, 49152
    s_add_u32 s50, s50, s48
    buffer_load_dwordx4 v12, s[8:11], s50 offen  lds
    s_waitcnt lgkmcnt(0)
    s_mov_b32 m0, s60
    s_add_u32 s53, s51, 18432
    buffer_load_dwordx4 v4, s[12:15], s53 offen offset:0 lds
    buffer_load_dwordx4 v4, s[12:15], s53 offen offset:1024 lds
    s_add_u32 m0, s60, 2048
    s_mov_b32 s49, 33792
    buffer_load_dwordx4 v14, s[4:7], s49 offen lds
    s_add_u32 m0, s60, 3072
    s_nop 0
    buffer_load_dwordx4 v19, s[4:7], s49 offen lds
    s_add_u32 m0, s52, 50176
    s_nop 0
    buffer_load_dwordx4 v13, s[8:11], s50 offen  lds
    s_add_u32 m0, s51, 50176
    s_movk_i32 s49, 896
    buffer_load_dwordx4 v9, s[4:7], s49 offen  lds
    s_add_u32 m0, s52, 51200
    s_add_u32 s50, s50, s48
    buffer_load_dwordx4 v12, s[8:11], s50 offen  lds
    s_add_u32 m0, s52, 52224
    s_nop 0
    buffer_load_dwordx4 v13, s[8:11], s50 offen  lds
    s_add_u32 m0, s51, 51200
    s_movk_i32 s49, 896
    buffer_load_dwordx4 v10, s[4:7], s49 offen  lds
    s_add_u32 m0, s52, 53248
    s_add_u32 s50, s50, s48
    buffer_load_dwordx4 v12, s[8:11], s50 offen  lds
    s_add_u32 m0, s52, 54272
    s_nop 0
    buffer_load_dwordx4 v13, s[8:11], s50 offen  lds
    s_add_u32 m0, s51, 52224
    s_movk_i32 s49, 896
    buffer_load_dwordx4 v11, s[4:7], s49 offen  lds
    s_add_u32 m0, s52, 55296
    s_add_u32 s50, s50, s48
    buffer_load_dwordx4 v12, s[8:11], s50 offen  lds
    s_add_u32 m0, s52, 56320
    s_nop 0
    buffer_load_dwordx4 v13, s[8:11], s50 offen  lds
    s_waitcnt vmcnt(16)
    s_barrier
    s_waitcnt vmcnt(10)
    ds_read_b64_tr_b16 v[108:109], v16 offset:0
    ds_read_b64_tr_b16 v[110:111], v16 offset:256
    ds_read_b64_tr_b16 v[112:113], v16 offset:32
    ds_read_b64_tr_b16 v[114:115], v16 offset:288
    ds_read_b128 v[56:59], v180
    ds_read_b128 v[64:67], v181
    s_cmp_lg_u32 s61, 2
    s_cbranch_scc1 K_rr_36
    ds_read_b128 v[36:39], v188 offset:0
    ds_read_b128 v[40:43], v189 offset:0
    ds_read_b128 v[44:47], v190 offset:0
    ds_read_b128 v[48:51], v191 offset:0
K_rr_36:
    s_add_u32 m0, s51, 98304
    s_movk_i32 s49, 1024
    buffer_load_dwordx4 v8, s[4:7], s49 offen  lds
    s_add_u32 m0, s52, 98304
    s_add_u32 s50, s50, s48
    buffer_load_dwordx4 v12, s[8:11], s50 offen  lds
    s_waitcnt lgkmcnt(0)
    s_mov_b32 m0, s60
    s_add_u32 s53, s51, 49152
    buffer_load_dwordx4 v4, s[12:15], s53 offen offset:0 lds
    buffer_load_dwordx4 v4, s[12:15], s53 offen offset:1024 lds
    s_add_u32 m0, s60, 2048
    s_mov_b32 s49, 1536
    buffer_load_dwordx4 v14, s[4:7], s49 offen lds
    s_add_u32 m0, s60, 3072
    s_nop 0
    buffer_load_dwordx4 v19, s[4:7], s49 offen lds
    v_mov_b32_dpp v172, v184 row_newbcast:4 row_mask:0xf bank_mask:0xf
    v_mov_b32_dpp v173, v185 row_newbcast:4 row_mask:0xf bank_mask:0xf
    v_mov_b32_dpp v174, v186 row_newbcast:4 row_mask:0xf bank_mask:0xf
    v_mov_b32_dpp v175, v187 row_newbcast:4 row_mask:0xf bank_mask:0xf
    v_mov_b32_dpp v176, v184 row_newbcast:5 row_mask:0xf bank_mask:0xf
    v_mov_b32_dpp v177, v185 row_newbcast:5 row_mask:0xf bank_mask:0xf
    v_mov_b32_dpp v178, v186 row_newbcast:5 row_mask:0xf bank_mask:0xf
    v_mov_b32_dpp v179, v187 row_newbcast:5 row_mask:0xf bank_mask:0xf
    s_bitcmp1_b32 s37, 3
    s_cbranch_scc1 K_sv_37
    v_mfma_f32_16x16x32_bf16 v[148:151], v[116:119], v[52:55], v[148:151]
    v_mfma_f32_16x16x32_bf16 v[152:155], v[120:123], v[52:55], v[152:155]
    v_mfma_f32_16x16x32_bf16 v[160:163], v[116:119], v[56:59], v[160:163]
    v_mfma_f32_16x16x32_bf16 v[164:167], v[120:123], v[56:59], v[164:167]
    v_mfma_f32_16x16x32_bf16 v[156:159], v[172:175], v[52:55], v[156:159]
    v_mfma_f32_16x16x32_bf16 v[148:151], v[124:127], v[60:63], v[148:151]
    v_mfma_f32_16x16x32_bf16 v[152:155], v[128:131], v[60:63], v[152:155]
    v_mfma_f32_16x16x32_bf16 v[160:163], v[124:127], v[64:67], v[160:163]
    v_mfma_f32_16x16x32_bf16 v[164:167], v[128:131], v[64:67], v[164:167]
    v_mfma_f32_16x16x32_bf16 v[156:159], v[176:179], v[60:63], v[156:159]
    s_branch K_se_38
K_sv_37:
    v_mfma_f32_16x16x32_bf16 v[148:151], v[52:55], v[116:119], v[148:151]
    v_mfma_f32_16x16x32_bf16 v[152:155], v[52:55], v[120:123], v[152:155]
    v_mfma_f32_16x16x32_bf16 v[160:163], v[56:59], v[116:119], v[160:163]
    v_mfma_f32_16x16x32_bf16 v[164:167], v[56:59], v[120:123], v[164:167]
    v_mfma_f32_16x16x32_bf16 v[168:171], v[172:175], v[56:59], v[168:171]
    v_mfma_f32_16x16x32_bf16 v[148:151], v[60:63], v[124:127], v[148:151]
    v_mfma_f32_16x16x32_bf16 v[152:155], v[60:63], v[128:131], v[152:155]
    v_mfma_f32_16x16x32_bf16 v[160:163], v[64:67], v[124:127], v[160:163]
    v_mfma_f32_16x16x32_bf16 v[164:167], v[64:67], v[128:131], v[164:167]
    v_mfma_f32_16x16x32_bf16 v[168:171], v[176:179], v[64:67], v[168:171]
K_se_38:
    s_add_u32 m0, s52, 99328
    s_nop 0
    buffer_load_dwordx4 v13, s[8:11], s50 offen  lds
    s_add_u32 m0, s51, 99328
    s_movk_i32 s49, 1024
    buffer_load_dwordx4 v9, s[4:7], s49 offen  lds
    s_add_u32 m0, s52, 100352
    s_add_u32 s50, s50, s48
    buffer_load_dwordx4 v12, s[8:11], s50 offen  lds
    s_add_u32 m0, s52, 101376
    s_nop 0
    buffer_load_dwordx4 v13, s[8:11], s50 offen  lds
    s_add_u32 m0, s51, 100352
    s_movk_i32 s49, 1024
    buffer_load_dwordx4 v10, s[4:7], s49 offen  lds
    s_add_u32 m0, s52, 102400
    s_add_u32 s50, s50, s48
    buffer_load_dwordx4 v12, s[8:11], s50 offen  lds
    s_add_u32 m0, s52, 103424
    s_nop 0
    buffer_load_dwordx4 v13, s[8:11], s50 offen  lds
    s_add_u32 m0, s51, 101376
    s_movk_i32 s49, 1024
    buffer_load_dwordx4 v11, s[4:7], s49 offen  lds
    s_add_u32 m0, s52, 104448
    s_add_u32 s50, s50, s48
    buffer_load_dwordx4 v12, s[8:11], s50 offen  lds
    s_add_u32 m0, s52, 105472
    s_nop 0
    buffer_load_dwordx4 v13, s[8:11], s50 offen  lds
    s_mul_i32 s40, s62, 640
    s_mov_b64 exec, 0
    s_mov_b32 exec_lo, -1
    s_mov_b32 exec_hi, 0x0
    buffer_load_dword v255, v17, s[8:11], s40 offen
    s_mov_b64 exec, -1
    s_waitcnt vmcnt(17)
    s_barrier
    s_waitcnt vmcnt(11)
    ds_read_b64_tr_b16 v[132:133], v16 offset:0
    ds_read_b64_tr_b16 v[134:135], v16 offset:256
    ds_read_b64_tr_b16 v[136:137], v16 offset:32
    ds_read_b64_tr_b16 v[138:139], v16 offset:288
    ds_read_b128 v[68:71], v180
    ds_read_b128 v[76:79], v181
    s_cmp_lg_u32 s61, 3
    s_cbranch_scc1 K_rr_39
    ds_read_b128 v[36:39], v188 offset:49152
    ds_read_b128 v[40:43], v189 offset:49152
    ds_read_b128 v[44:47], v190 offset:49152
    ds_read_b128 v[48:51], v191 offset:49152
K_rr_39:
    s_add_u32 m0, s51, 0
    s_movk_i32 s49, 1152
    buffer_load_dwordx4 v8, s[4:7], s49 offen  lds
    s_add_u32 m0, s52, 0
    s_add_u32 s50, s50, s48
    buffer_load_dwordx4 v12, s[8:11], s50 offen  lds
    s_waitcnt lgkmcnt(0)
    s_mov_b32 m0, s60
    s_add_u32 s53, s51, 51200
    buffer_load_dwordx4 v4, s[12:15], s53 offen offset:0 lds
    buffer_load_dwordx4 v4, s[12:15], s53 offen offset:1024 lds
    s_add_u32 m0, s60, 2048
    s_mov_b32 s49, 34304
    buffer_load_dwordx4 v14, s[4:7], s49 offen lds
    s_add_u32 m0, s60, 3072
    s_nop 0
    buffer_load_dwordx4 v19, s[4:7], s49 offen lds
    s_add_u32 m0, s52, 1024
    s_nop 0
    buffer_load_dwordx4 v13, s[8:11], s50 offen  lds
    s_add_u32 m0, s51, 1024
    s_movk_i32 s49, 1152
    buffer_load_dwordx4 v9, s[4:7], s49 offen  lds
    s_add_u32 m0, s52, 2048
    s_add_u32 s50, s50, s48
    buffer_load_dwordx4 v12, s[8:11], s50 offen  lds
    s_add_u32 m0, s52, 3072
    s_nop 0
    buffer_load_dwordx4 v13, s[8:11], s50 offen  lds
    s_add_u32 m0, s51, 2048
    s_movk_i32 s49, 1152
    buffer_load_dwordx4 v10, s[4:7], s49 offen  lds
    s_add_u32 m0, s52, 4096
    s_add_u32 s50, s50, s48
    buffer_load_dwordx4 v12, s[8:11], s50 offen  lds
    s_add_u32 m0, s52, 5120
    s_nop 0
    buffer_load_dwordx4 v13, s[8:11], s50 offen  lds
    s_add_u32 m0, s51, 3072
    s_movk_i32 s49, 1152
    buffer_load_dwordx4 v11, s[4:7], s49 offen  lds
    s_add_u32 m0, s52, 6144
    s_add_u32 s50, s50, s48
    buffer_load_dwordx4 v12, s[8:11], s50 offen  lds
    s_add_u32 m0, s52, 7168
    s_nop 0
    buffer_load_dwordx4 v13, s[8:11], s50 offen  lds
    s_waitcnt vmcnt(17)
    s_barrier
    s_waitcnt vmcnt(10)
    ds_read_b64_tr_b16 v[140:141], v16 offset:0
    ds_read_b64_tr_b16 v[142:143], v16 offset:256
    ds_read_b64_tr_b16 v[144:145], v16 offset:32
    ds_read_b64_tr_b16 v[146:147], v16 offset:288
    ds_read_b128 v[72:75], v180
    ds_read_b128 v[80:83], v181
    s_add_u32 m0, s51, 49152
    s_movk_i32 s49, 1280
    buffer_load_dwordx4 v8, s[4:7], s49 offen  lds
    s_add_u32 m0, s52, 49152
    s_add_u32 s50, s50, s48
    buffer_load_dwordx4 v12, s[8:11], s50 offen  lds
    s_waitcnt lgkmcnt(0)
    v_mov_b32_dpp v172, v184 row_newbcast:2 row_mask:0xf bank_mask:0xf
    v_mov_b32_dpp v173, v185 row_newbcast:2 row_mask:0xf bank_mask:0xf
    v_mov_b32_dpp v174, v186 row_newbcast:2 row_mask:0xf bank_mask:0xf
    v_mov_b32_dpp v175, v187 row_newbcast:2 row_mask:0xf bank_mask:0xf
    v_mov_b32_dpp v176, v184 row_newbcast:3 row_mask:0xf bank_mask:0xf
    v_mov_b32_dpp v177, v185 row_newbcast:3 row_mask:0xf bank_mask:0xf
    v_mov_b32_dpp v178, v186 row_newbcast:3 row_mask:0xf bank_mask:0xf
    v_mov_b32_dpp v179, v187 row_newbcast:3 row_mask:0xf bank_mask:0xf
    s_bitcmp1_b32 s37, 3
    s_cbranch_scc1 K_sv_40
    v_mfma_f32_16x16x32_bf16 v[148:151], v[100:103], v[36:39], v[148:151]
    v_mfma_f32_16x16x32_bf16 v[152:155], v[104:107], v[36:39], v[152:155]
    v_mfma_f32_16x16x32_bf16 v[160:163], v[100:103], v[40:43], v[160:163]
    v_mfma_f32_16x16x32_bf16 v[164:167], v[104:107], v[40:43], v[164:167]
    v_mfma_f32_16x16x32_bf16 v[156:159], v[172:175], v[36:39], v[156:159]
    v_mfma_f32_16x16x32_bf16 v[148:151], v[108:111], v[44:47], v[148:151]
    v_mfma_f32_16x16x32_bf16 v[152:155], v[112:115], v[44:47], v[152:155]
    v_mfma_f32_16x16x32_bf16 v[160:163], v[108:111], v[48:51], v[160:163]
    v_mfma_f32_16x16x32_bf16 v[164:167], v[112:115], v[48:51], v[164:167]
    v_mfma_f32_16x16x32_bf16 v[156:159], v[176:179], v[44:47], v[156:159]
    s_branch K_se_41
K_sv_40:
    v_mfma_f32_16x16x32_bf16 v[148:151], v[36:39], v[100:103], v[148:151]
    v_mfma_f32_16x16x32_bf16 v[152:155], v[36:39], v[104:107], v[152:155]
    v_mfma_f32_16x16x32_bf16 v[160:163], v[40:43], v[100:103], v[160:163]
    v_mfma_f32_16x16x32_bf16 v[164:167], v[40:43], v[104:107], v[164:167]
    v_mfma_f32_16x16x32_bf16 v[168:171], v[172:175], v[40:43], v[168:171]
    v_mfma_f32_16x16x32_bf16 v[148:151], v[44:47], v[108:111], v[148:151]
    v_mfma_f32_16x16x32_bf16 v[152:155], v[44:47], v[112:115], v[152:155]
    v_mfma_f32_16x16x32_bf16 v[160:163], v[48:51], v[108:111], v[160:163]
    v_mfma_f32_16x16x32_bf16 v[164:167], v[48:51], v[112:115], v[164:167]
    v_mfma_f32_16x16x32_bf16 v[168:171], v[176:179], v[48:51], v[168:171]
K_se_41:
    s_add_u32 m0, s52, 50176
    s_nop 0
    buffer_load_dwordx4 v13, s[8:11], s50 offen  lds
    s_add_u32 m0, s51, 50176
    s_movk_i32 s49, 1280
    buffer_load_dwordx4 v9, s[4:7], s49 offen  lds
    s_add_u32 m0, s52, 51200
    s_add_u32 s50, s50, s48
    buffer_load_dwordx4 v12, s[8:11], s50 offen  lds
    v_mov_b32_dpp v172, v184 row_newbcast:6 row_mask:0xf bank_mask:0xf
    v_mov_b32_dpp v173, v185 row_newbcast:6 row_mask:0xf bank_mask:0xf
    v_mov_b32_dpp v174, v186 row_newbcast:6 row_mask:0xf bank_mask:0xf
    v_mov_b32_dpp v175, v187 row_newbcast:6 row_mask:0xf bank_mask:0xf
    v_mov_b32_dpp v176, v184 row_newbcast:7 row_mask:0xf bank_mask:0xf
    v_mov_b32_dpp v177, v185 row_newbcast:7 row_mask:0xf bank_mask:0xf
    v_mov_b32_dpp v178, v186 row_newbcast:7 row_mask:0xf bank_mask:0xf
    v_mov_b32_dpp v179, v187 row_newbcast:7 row_mask:0xf bank_mask:0xf
    s_bitcmp1_b32 s37, 3
    s_cbranch_scc1 K_sv_42
    v_mfma_f32_16x16x32_bf16 v[148:151], v[132:135], v[68:71], v[148:151]
    v_mfma_f32_16x16x32_bf16 v[152:155], v[136:139], v[68:71], v[152:155]
    v_mfma_f32_16x16x32_bf16 v[160:163], v[132:135], v[72:75], v[160:163]
    v_mfma_f32_16x16x32_bf16 v[164:167], v[136:139], v[72:75], v[164:167]
    v_mfma_f32_16x16x32_bf16 v[156:159], v[172:175], v[68:71], v[156:159]
    v_mfma_f32_16x16x32_bf16 v[148:151], v[140:143], v[76:79], v[148:151]
    v_mfma_f32_16x16x32_bf16 v[152:155], v[144:147], v[76:79], v[152:155]
    v_mfma_f32_16x16x32_bf16 v[160:163], v[140:143], v[80:83], v[160:163]
    v_mfma_f32_16x16x32_bf16 v[164:167], v[144:147], v[80:83], v[164:167]
    v_mfma_f32_16x16x32_bf16 v[156:159], v[176:179], v[76:79], v[156:159]
    s_branch K_se_43
K_sv_42:
    v_mfma_f32_16x16x32_bf16 v[148:151], v[68:71], v[132:135], v[148:151]
    v_mfma_f32_16x16x32_bf16 v[152:155], v[68:71], v[136:139], v[152:155]
    v_mfma_f32_16x16x32_bf16 v[160:163], v[72:75], v[132:135], v[160:163]
    v_mfma_f32_16x16x32_bf16 v[164:167], v[72:75], v[136:139], v[164:167]
    v_mfma_f32_16x16x32_bf16 v[168:171], v[172:175], v[72:75], v[168:171]
    v_mfma_f32_16x16x32_bf16 v[148:151], v[76:79], v[140:143], v[148:151]
    v_mfma_f32_16x16x32_bf16 v[152:155], v[76:79], v[144:147], v[152:155]
    v_mfma_f32_16x16x32_bf16 v[160:163], v[80:83], v[140:143], v[160:163]
    v_mfma_f32_16x16x32_bf16 v[164:167], v[80:83], v[144:147], v[164:167]
    v_mfma_f32_16x16x32_bf16 v[168:171], v[176:179], v[80:83], v[168:171]
K_se_43:
    s_add_u32 m0, s52, 52224
    s_nop 0
    buffer_load_dwordx4 v13, s[8:11], s50 offen  lds
    s_add_u32 m0, s51, 51200
    s_movk_i32 s49, 1280
    buffer_load_dwordx4 v10, s[4:7], s49 offen  lds
    s_add_u32 m0, s52, 53248
    s_add_u32 s50, s50, s48
    buffer_load_dwordx4 v12, s[8:11], s50 offen  lds
    s_add_u32 m0, s52, 54272
    s_nop 0
    buffer_load_dwordx4 v13, s[8:11], s50 offen  lds
    s_add_u32 m0, s51, 52224
    s_movk_i32 s49, 1280
    buffer_load_dwordx4 v11, s[4:7], s49 offen  lds
    s_add_u32 m0, s52, 55296
    s_add_u32 s50, s50, s48
    buffer_load_dwordx4 v12, s[8:11], s50 offen  lds
    s_add_u32 m0, s52, 56320
    s_nop 0
    buffer_load_dwordx4 v13, s[8:11], s50 offen  lds
    s_waitcnt vmcnt(12)
    s_barrier
    s_cmp_eq_u32 s61, 0
    s_cbranch_scc1 K_pw_44
    ds_write_b128 v196, v[148:151] offset:0
    ds_write_b128 v196, v[152:155] offset:1024
    ds_write_b32 v197, v156 offset:2048
K_pw_44:
    s_cmp_eq_u32 s61, 1
    s_cbranch_scc1 K_pw_45
    ds_write_b128 v196, v[160:163] offset:6912
    ds_write_b128 v196, v[164:167] offset:7936
    ds_write_b32 v197, v168 offset:8960
K_pw_45:
    s_add_u32 m0, s51, 98304
    s_movk_i32 s49, 1408
    buffer_load_dwordx4 v8, s[4:7], s49 offen  lds
    s_add_u32 m0, s52, 98304
    s_add_u32 s50, s50, s48
    buffer_load_dwordx4 v12, s[8:11], s50 offen  lds
    s_add_u32 m0, s52, 99328
    s_nop 0
    buffer_load_dwordx4 v13, s[8:11], s50 offen  lds
    s_add_u32 m0, s51, 99328
    s_movk_i32 s49, 1408
    buffer_load_dwordx4 v9, s[4:7], s49 offen  lds
    s_add_u32 m0, s52, 100352
    s_add_u32 s50, s50, s48
    buffer_load_dwordx4 v12, s[8:11], s50 offen  lds
    s_add_u32 m0, s52, 101376
    s_nop 0
    buffer_load_dwordx4 v13, s[8:11], s50 offen  lds
    s_add_u32 m0, s51, 100352
    s_movk_i32 s49, 1408
    buffer_load_dwordx4 v10, s[4:7], s49 offen  lds
    s_add_u32 m0, s52, 102400
    s_add_u32 s50, s50, s48
    buffer_load_dwordx4 v12, s[8:11], s50 offen  lds
    s_add_u32 m0, s52, 103424
    s_nop 0
    buffer_load_dwordx4 v13, s[8:11], s50 offen  lds
    s_add_u32 m0, s51, 101376
    s_movk_i32 s49, 1408
    buffer_load_dwordx4 v11, s[4:7], s49 offen  lds
    s_add_u32 m0, s52, 104448
    s_add_u32 s50, s50, s48
    buffer_load_dwordx4 v12, s[8:11], s50 offen  lds
    s_add_u32 m0, s52, 105472
    s_nop 0
    buffer_load_dwordx4 v13, s[8:11], s50 offen  lds
    s_waitcnt lgkmcnt(0)
    s_waitcnt vmcnt(12)
    s_barrier
    ds_read_b128 v[20:23], v198 offset:0
    ds_read_b128 v[24:27], v198 offset:1024
    ds_read_b32 v28, v199 offset:2048
    ds_read_b128 v[32:35], v198 offset:2304
    ds_read_b128 v[36:39], v198 offset:3328
    ds_read_b32 v40, v199 offset:4352
    ds_read_b128 v[44:47], v198 offset:4608
    ds_read_b128 v[48:51], v198 offset:5632
    ds_read_b32 v52, v199 offset:6656
    s_add_u32 m0, s51, 0
    s_movk_i32 s49, 1536
    buffer_load_dwordx4 v8, s[4:7], s49 offen  lds
    s_add_u32 m0, s52, 0
    s_add_u32 s50, s50, s48
    buffer_load_dwordx4 v12, s[8:11], s50 offen  lds
    s_cmp_gt_u32 s61, 1
    s_cbranch_scc1 K_pe_47
    s_cmp_eq_u32 s61, 0
    s_cbranch_scc1 K_p0_48
    v_mov_b32 v148, v160
    v_mov_b32 v149, v161
    v_mov_b32 v150, v162
    v_mov_b32 v151, v163
    v_mov_b32 v152, v164
    v_mov_b32 v153, v165
    v_mov_b32 v154, v166
    v_mov_b32 v155, v167
    v_mov_b32 v156, v168
K_p0_48:
    s_and_b32 s40, s37, 3
    s_lshl2_add_u32 s40, s36, s40
    s_lshl_b32 s41, s40, 12
    s_add_u32 s41, s41, 16777216
    s_lshl1_add_u32 s40, s40, s61
    s_waitcnt lgkmcnt(0)
    v_add_f32 v148, v148, v20
    v_add_f32 v149, v149, v21
    v_add_f32 v150, v150, v22
    v_add_f32 v151, v151, v23
    v_add_f32 v152, v152, v24
    v_add_f32 v153, v153, v25
    v_add_f32 v154, v154, v26
    v_add_f32 v155, v155, v27
    v_add_f32 v156, v156, v28
    v_add_f32 v148, v148, v32
    v_add_f32 v149, v149, v33
    v_add_f32 v150, v150, v34
    v_add_f32 v151, v151, v35
    v_add_f32 v152, v152, v36
    v_add_f32 v153, v153, v37
    v_add_f32 v154, v154, v38
    v_add_f32 v155, v155, v39
    v_add_f32 v156, v156, v40
    v_add_f32 v148, v148, v44
    v_add_f32 v149, v149, v45
    v_add_f32 v150, v150, v46
    v_add_f32 v151, v151, v47
    v_add_f32 v152, v152, v48
    v_add_f32 v153, v153, v49
    v_add_f32 v154, v154, v50
    v_add_f32 v155, v155, v51
    v_add_f32 v156, v156, v52
    s_lshr_b32 s42, s37, 3
    s_cmp_lg_u32 s42, s61
    s_cbranch_scc1 K_pg_49
    v_mul_f32 v156, 0xbfb8aa3b, v156
    v_exp_f32 v156, v156
    s_lshl_b32 s40, s40, 6
    v_add_f32 v156, 1.0, v156
    v_rcp_f32 v156, v156
    s_add_u32 s40, s40, 17039360
    s_mov_b64 exec, 0xffff
    buffer_store_dword v156, v243, s[20:23], s40 offen sc1
    s_mov_b64 exec, -1
K_pg_49:
    s_bitcmp1_b32 s37, 3
    s_cbranch_scc1 K_pv_46
    v_mul_f32 v148, 0x3e8293ee, v148
    v_mul_f32 v149, 0x3e8293ee, v149
    v_mul_f32 v150, 0x3e8293ee, v150
    v_mul_f32 v151, 0x3e8293ee, v151
    v_mul_f32 v152, 0x3e8293ee, v152
    v_mul_f32 v153, 0x3e8293ee, v153
    v_mul_f32 v154, 0x3e8293ee, v154
    v_mul_f32 v155, 0x3e8293ee, v155
    v_cvt_pk_bf16_f32 v172, v148, v149
    v_cvt_pk_bf16_f32 v173, v150, v151
    v_cvt_pk_bf16_f32 v174, v152, v153
    v_cvt_pk_bf16_f32 v175, v154, v155
    v_lshlrev_b32 v5, 9, v3
    v_lshl_add_u32 v5, v2, 4, v5
    s_lshl_b32 s42, s61, 8
    s_add_u32 s41, s41, s42
    buffer_store_dwordx4 v[172:175], v5, s[20:23], s41 offen sc1
    s_branch K_pe_47
K_pv_46:
    v_cvt_pk_bf16_f32 v172, v148, v149
    v_cvt_pk_bf16_f32 v173, v150, v151
    v_cvt_pk_bf16_f32 v174, v152, v153
    v_cvt_pk_bf16_f32 v175, v154, v155
    v_lshrrev_b32 v5, 1, v3
    v_lshlrev_b32 v5, 9, v5
    v_lshl_add_u32 v5, v2, 4, v5
    v_and_b32 v6, 1, v3
    v_lshl_add_u32 v5, v6, 3, v5
    s_lshl_b32 s42, s61, 10
    s_add_u32 s41, s41, s42
    buffer_store_dwordx2 v[172:173], v5, s[20:23], s41 offen offset:2048 sc1
    buffer_store_dwordx2 v[174:175], v5, s[20:23], s41 offen offset:2304 sc1
K_pe_47:
    s_add_u32 m0, s52, 1024
    s_nop 0
    buffer_load_dwordx4 v13, s[8:11], s50 offen  lds
    s_add_u32 m0, s51, 1024
    s_movk_i32 s49, 1536
    buffer_load_dwordx4 v9, s[4:7], s49 offen  lds
    s_add_u32 m0, s52, 2048
    s_add_u32 s50, s50, s48
    buffer_load_dwordx4 v12, s[8:11], s50 offen  lds
    s_add_u32 m0, s52, 3072
    s_nop 0
    buffer_load_dwordx4 v13, s[8:11], s50 offen  lds
    s_add_u32 m0, s51, 2048
    s_movk_i32 s49, 1536
    buffer_load_dwordx4 v10, s[4:7], s49 offen  lds
    s_add_u32 m0, s52, 4096
    s_add_u32 s50, s50, s48
    buffer_load_dwordx4 v12, s[8:11], s50 offen  lds
    s_add_u32 m0, s52, 5120
    s_nop 0
    buffer_load_dwordx4 v13, s[8:11], s50 offen  lds
    s_add_u32 m0, s51, 3072
    s_movk_i32 s49, 1536
    buffer_load_dwordx4 v11, s[4:7], s49 offen  lds
    s_add_u32 m0, s52, 6144
    s_add_u32 s50, s50, s48
    buffer_load_dwordx4 v12, s[8:11], s50 offen  lds
    s_add_u32 m0, s52, 7168
    s_nop 0
    buffer_load_dwordx4 v13, s[8:11], s50 offen  lds
    s_waitcnt vmcnt(9)
    s_barrier
    s_cmp_lg_u32 s61, 3
    s_cbranch_scc1 K_nf_50
    s_and_b32 s40, s37, 3
    s_lshl2_add_u32 s40, s36, s40
    s_lshl_b32 s40, s40, 5
    s_lshr_b32 s41, s37, 3
    s_add_u32 s40, s40, s41
    s_lshl_b32 s40, s40, 2
    s_add_u32 s40, s40, 17301504
    s_mov_b64 exec, 1
    buffer_store_dword v240, off, s[20:23], s40 sc1
    s_mov_b64 exec, -1
K_nf_50:
    s_add_u32 m0, s51, 49152
    s_movk_i32 s49, 1664
    buffer_load_dwordx4 v8, s[4:7], s49 offen  lds
    s_add_u32 m0, s52, 49152
    s_add_u32 s50, s50, s48
    buffer_load_dwordx4 v12, s[8:11], s50 offen  lds
    s_add_u32 m0, s52, 50176
    s_nop 0
    buffer_load_dwordx4 v13, s[8:11], s50 offen  lds
    s_add_u32 m0, s51, 50176
    s_movk_i32 s49, 1664
    buffer_load_dwordx4 v9, s[4:7], s49 offen  lds
    s_add_u32 m0, s52, 51200
    s_add_u32 s50, s50, s48
    buffer_load_dwordx4 v12, s[8:11], s50 offen  lds
    s_add_u32 m0, s52, 52224
    s_nop 0
    buffer_load_dwordx4 v13, s[8:11], s50 offen  lds
    s_add_u32 m0, s51, 51200
    s_movk_i32 s49, 1664
    buffer_load_dwordx4 v10, s[4:7], s49 offen  lds
    s_add_u32 m0, s52, 53248
    s_add_u32 s50, s50, s48
    buffer_load_dwordx4 v12, s[8:11], s50 offen  lds
    s_add_u32 m0, s52, 54272
    s_nop 0
    buffer_load_dwordx4 v13, s[8:11], s50 offen  lds
    s_add_u32 m0, s51, 52224
    s_movk_i32 s49, 1664
    buffer_load_dwordx4 v11, s[4:7], s49 offen  lds
    s_add_u32 m0, s52, 55296
    s_add_u32 s50, s50, s48
    buffer_load_dwordx4 v12, s[8:11], s50 offen  lds
    s_add_u32 m0, s52, 56320
    s_nop 0
    buffer_load_dwordx4 v13, s[8:11], s50 offen  lds
    s_waitcnt vmcnt(12)
    s_barrier
    s_add_u32 m0, s51, 98304
    s_movk_i32 s49, 1792
    buffer_load_dwordx4 v8, s[4:7], s49 offen  lds
    s_add_u32 m0, s52, 98304
    s_add_u32 s50, s50, s48
    buffer_load_dwordx4 v12, s[8:11], s50 offen  lds
    s_add_u32 m0, s52, 99328
    s_nop 0
    buffer_load_dwordx4 v13, s[8:11], s50 offen  lds
    s_add_u32 m0, s51, 99328
    s_movk_i32 s49, 1792
    buffer_load_dwordx4 v9, s[4:7], s49 offen  lds
    s_add_u32 m0, s52, 100352
    s_add_u32 s50, s50, s48
    buffer_load_dwordx4 v12, s[8:11], s50 offen  lds
    s_add_u32 m0, s52, 101376
    s_nop 0
    buffer_load_dwordx4 v13, s[8:11], s50 offen  lds
    s_add_u32 m0, s51, 100352
    s_movk_i32 s49, 1792
    buffer_load_dwordx4 v10, s[4:7], s49 offen  lds
    s_add_u32 m0, s52, 102400
    s_add_u32 s50, s50, s48
    buffer_load_dwordx4 v12, s[8:11], s50 offen  lds
    s_add_u32 m0, s52, 103424
    s_nop 0
    buffer_load_dwordx4 v13, s[8:11], s50 offen  lds
    s_add_u32 m0, s51, 101376
    s_movk_i32 s49, 1792
    buffer_load_dwordx4 v11, s[4:7], s49 offen  lds
    s_add_u32 m0, s52, 104448
    s_add_u32 s50, s50, s48
    buffer_load_dwordx4 v12, s[8:11], s50 offen  lds
    s_add_u32 m0, s52, 105472
    s_nop 0
    buffer_load_dwordx4 v13, s[8:11], s50 offen  lds
    s_waitcnt vmcnt(12)
    s_barrier
    s_add_u32 m0, s51, 0
    s_movk_i32 s49, 1920
    buffer_load_dwordx4 v8, s[4:7], s49 offen  lds
    s_add_u32 m0, s52, 0
    s_add_u32 s50, s50, s48
    buffer_load_dwordx4 v12, s[8:11], s50 offen  lds
    s_add_u32 m0, s52, 1024
    s_nop 0
    buffer_load_dwordx4 v13, s[8:11], s50 offen  lds
    s_add_u32 m0, s51, 1024
    s_movk_i32 s49, 1920
    buffer_load_dwordx4 v9, s[4:7], s49 offen  lds
    s_add_u32 m0, s52, 2048
    s_add_u32 s50, s50, s48
    buffer_load_dwordx4 v12, s[8:11], s50 offen  lds
    s_add_u32 m0, s52, 3072
    s_nop 0
    buffer_load_dwordx4 v13, s[8:11], s50 offen  lds
    s_add_u32 m0, s51, 2048
    s_movk_i32 s49, 1920
    buffer_load_dwordx4 v10, s[4:7], s49 offen  lds
    s_add_u32 m0, s52, 4096
    s_add_u32 s50, s50, s48
    buffer_load_dwordx4 v12, s[8:11], s50 offen  lds
    s_add_u32 m0, s52, 5120
    s_nop 0
    buffer_load_dwordx4 v13, s[8:11], s50 offen  lds
    s_add_u32 m0, s51, 3072
    s_movk_i32 s49, 1920
    buffer_load_dwordx4 v11, s[4:7], s49 offen  lds
    s_add_u32 m0, s52, 6144
    s_add_u32 s50, s50, s48
    buffer_load_dwordx4 v12, s[8:11], s50 offen  lds
    s_add_u32 m0, s52, 7168
    s_nop 0
    buffer_load_dwordx4 v13, s[8:11], s50 offen  lds
    s_waitcnt vmcnt(12)
    s_branch K_phend
K_ph1_2:
    s_barrier
    s_cmp_lg_u32 s61, 0
    s_cbranch_scc1 K_rr_51
    ds_read_b128 v[20:23], v188 offset:0
    ds_read_b128 v[24:27], v189 offset:0
    ds_read_b128 v[28:31], v190 offset:0
    ds_read_b128 v[32:35], v191 offset:0
K_rr_51:
    s_add_u32 m0, s52, 54272
    s_nop 0
    buffer_load_dwordx4 v13, s[8:11], s50 offen  lds
    s_add_u32 m0, s51, 52224
    s_movk_i32 s49, 128
    buffer_load_dwordx4 v11, s[4:7], s49 offen  lds
    s_add_u32 m0, s52, 55296
    s_add_u32 s50, s50, s48
    buffer_load_dwordx4 v12, s[8:11], s50 offen  lds
    s_add_u32 m0, s52, 56320
    s_nop 0
    buffer_load_dwordx4 v13, s[8:11], s50 offen  lds
    s_waitcnt lgkmcnt(0)
    buffer_load_dwordx4 v[184:187], v15, s[16:19], 0 offen
    s_mov_b32 m0, s60
    s_add_u32 s53, s51, 0
    buffer_load_dwordx4 v4, s[12:15], s53 offen offset:0 lds
    buffer_load_dwordx4 v4, s[12:15], s53 offen offset:1024 lds
    s_add_u32 m0, s51, 98304
    s_movk_i32 s49, 256
    buffer_load_dwordx4 v8, s[4:7], s49 offen  lds
    s_add_u32 m0, s52, 98304
    s_add_u32 s50, s50, s48
    buffer_load_dwordx4 v12, s[8:11], s50 offen  lds
    s_add_u32 m0, s52, 99328
    s_nop 0
    buffer_load_dwordx4 v13, s[8:11], s50 offen  lds
    s_add_u32 m0, s51, 99328
    s_movk_i32 s49, 256
    buffer_load_dwordx4 v9, s[4:7], s49 offen  lds
    s_add_u32 m0, s52, 100352
    s_add_u32 s50, s50, s48
    buffer_load_dwordx4 v12, s[8:11], s50 offen  lds
    s_add_u32 m0, s52, 101376
    s_nop 0
    buffer_load_dwordx4 v13, s[8:11], s50 offen  lds
    s_add_u32 m0, s51, 100352
    s_movk_i32 s49, 256
    buffer_load_dwordx4 v10, s[4:7], s49 offen  lds
    s_add_u32 m0, s52, 102400
    s_add_u32 s50, s50, s48
    buffer_load_dwordx4 v12, s[8:11], s50 offen  lds
    s_add_u32 m0, s52, 103424
    s_nop 0
    buffer_load_dwordx4 v13, s[8:11], s50 offen  lds
    s_add_u32 m0, s51, 101376
    s_movk_i32 s49, 256
    buffer_load_dwordx4 v11, s[4:7], s49 offen  lds
    s_waitcnt vmcnt(13)
    s_barrier
    s_waitcnt vmcnt(10)
    ds_read_b64_tr_b16 v[84:85], v16 offset:0
    ds_read_b64_tr_b16 v[86:87], v16 offset:256
    ds_read_b64_tr_b16 v[88:89], v16 offset:32
    ds_read_b64_tr_b16 v[90:91], v16 offset:288
    s_cmp_lg_u32 s61, 1
    s_cbranch_scc1 K_rr_52
    ds_read_b128 v[20:23], v188 offset:49152
    ds_read_b128 v[24:27], v189 offset:49152
    ds_read_b128 v[28:31], v190 offset:49152
    ds_read_b128 v[32:35], v191 offset:49152
K_rr_52:
    s_add_u32 m0, s52, 104448
    s_add_u32 s50, s50, s48
    buffer_load_dwordx4 v12, s[8:11], s50 offen  lds
    s_add_u32 m0, s52, 105472
    s_nop 0
    buffer_load_dwordx4 v13, s[8:11], s50 offen  lds
    s_waitcnt lgkmcnt(0)
    s_mov_b32 m0, s60
    s_add_u32 s53, s51, 2048
    buffer_load_dwordx4 v4, s[12:15], s53 offen offset:0 lds
    buffer_load_dwordx4 v4, s[12:15], s53 offen offset:1024 lds
    s_add_u32 m0, s51, 0
    s_movk_i32 s49, 384
    buffer_load_dwordx4 v8, s[4:7], s49 offen  lds
    s_add_u32 m0, s52, 0
    s_add_u32 s50, s50, s48
    buffer_load_dwordx4 v12, s[8:11], s50 offen  lds
    s_add_u32 m0, s52, 1024
    s_nop 0
    buffer_load_dwordx4 v13, s[8:11], s50 offen  lds
    s_add_u32 m0, s51, 1024
    s_movk_i32 s49, 384
    buffer_load_dwordx4 v9, s[4:7], s49 offen  lds
    s_add_u32 m0, s52, 2048
    s_add_u32 s50, s50, s48
    buffer_load_dwordx4 v12, s[8:11], s50 offen  lds
    s_add_u32 m0, s52, 3072
    s_nop 0
    buffer_load_dwordx4 v13, s[8:11], s50 offen  lds
    s_add_u32 m0, s51, 2048
    s_movk_i32 s49, 384
    buffer_load_dwordx4 v10, s[4:7], s49 offen  lds
    s_add_u32 m0, s52, 4096
    s_add_u32 s50, s50, s48
    buffer_load_dwordx4 v12, s[8:11], s50 offen  lds
    s_add_u32 m0, s52, 5120
    s_nop 0
    buffer_load_dwordx4 v13, s[8:11], s50 offen  lds
    s_add_u32 m0, s51, 3072
    s_movk_i32 s49, 384
    buffer_load_dwordx4 v11, s[4:7], s49 offen  lds
    s_add_u32 m0, s52, 6144
    s_add_u32 s50, s50, s48
    buffer_load_dwordx4 v12, s[8:11], s50 offen  lds
    s_add_u32 m0, s52, 7168
    s_nop 0
    buffer_load_dwordx4 v13, s[8:11], s50 offen  lds
    s_waitcnt vmcnt(14)
    s_barrier
    s_waitcnt vmcnt(12)
    ds_read_b64_tr_b16 v[92:93], v16 offset:0
    ds_read_b64_tr_b16 v[94:95], v16 offset:256
    ds_read_b64_tr_b16 v[96:97], v16 offset:32
    ds_read_b64_tr_b16 v[98:99], v16 offset:288
    s_cmp_lg_u32 s61, 2
    s_cbranch_scc1 K_rr_53
    v_add_u32 v192, 98304, v188
    ds_read_b128 v[20:23], v192
    v_add_u32 v193, 98304, v189
    ds_read_b128 v[24:27], v193
    v_add_u32 v194, 98304, v190
    ds_read_b128 v[28:31], v194
    v_add_u32 v195, 98304, v191
    ds_read_b128 v[32:35], v195
K_rr_53:
    s_add_u32 m0, s51, 49152
    s_movk_i32 s49, 512
    buffer_load_dwordx4 v8, s[4:7], s49 offen  lds
    s_add_u32 m0, s52, 49152
    s_add_u32 s50, s50, s48
    buffer_load_dwordx4 v12, s[8:11], s50 offen  lds
    s_waitcnt lgkmcnt(0)
    s_mov_b32 m0, s60
    s_add_u32 s53, s51, 32768
    buffer_load_dwordx4 v4, s[12:15], s53 offen offset:0 lds
    buffer_load_dwordx4 v4, s[12:15], s53 offen offset:1024 lds
    s_add_u32 m0, s52, 50176
    s_nop 0
    buffer_load_dwordx4 v13, s[8:11], s50 offen  lds
    s_add_u32 m0, s51, 50176
    s_movk_i32 s49, 512
    buffer_load_dwordx4 v9, s[4:7], s49 offen  lds
    s_add_u32 m0, s52, 51200
    s_add_u32 s50, s50, s48
    buffer_load_dwordx4 v12, s[8:11], s50 offen  lds
    s_add_u32 m0, s52, 52224
    s_nop 0
    buffer_load_dwordx4 v13, s[8:11], s50 offen  lds
    s_add_u32 m0, s51, 51200
    s_movk_i32 s49, 512
    buffer_load_dwordx4 v10, s[4:7], s49 offen  lds
    s_add_u32 m0, s52, 53248
    s_add_u32 s50, s50, s48
    buffer_load_dwordx4 v12, s[8:11], s50 offen  lds
    s_add_u32 m0, s52, 54272
    s_nop 0
    buffer_load_dwordx4 v13, s[8:11], s50 offen  lds
    s_add_u32 m0, s51, 52224
    s_movk_i32 s49, 512
    buffer_load_dwordx4 v11, s[4:7], s49 offen  lds
    s_add_u32 m0, s52, 55296
    s_add_u32 s50, s50, s48
    buffer_load_dwordx4 v12, s[8:11], s50 offen  lds
    s_add_u32 m0, s52, 56320
    s_nop 0
    buffer_load_dwordx4 v13, s[8:11], s50 offen  lds
    s_waitcnt vmcnt(14)
    s_barrier
    s_waitcnt vmcnt(10)
    ds_read_b64_tr_b16 v[116:117], v16 offset:0
    ds_read_b64_tr_b16 v[118:119], v16 offset:256
    ds_read_b64_tr_b16 v[120:121], v16 offset:32
    ds_read_b64_tr_b16 v[122:123], v16 offset:288
    s_cmp_lg_u32 s61, 3
    s_cbranch_scc1 K_rr_54
    ds_read_b128 v[20:23], v188 offset:0
    ds_read_b128 v[24:27], v189 offset:0
    ds_read_b128 v[28:31], v190 offset:0
    ds_read_b128 v[32:35], v191 offset:0
K_rr_54:
    s_add_u32 m0, s51, 98304
    s_movk_i32 s49, 640
    buffer_load_dwordx4 v8, s[4:7], s49 offen  lds
    s_add_u32 m0, s52, 98304
    s_add_u32 s50, s50, s48
    buffer_load_dwordx4 v12, s[8:11], s50 offen  lds
    s_waitcnt lgkmcnt(0)
    s_mov_b32 m0, s60
    s_add_u32 s53, s51, 34816
    buffer_load_dwordx4 v4, s[12:15], s53 offen offset:0 lds
    buffer_load_dwordx4 v4, s[12:15], s53 offen offset:1024 lds
    s_add_u32 m0, s52, 99328
    s_nop 0
    buffer_load_dwordx4 v13, s[8:11], s50 offen  lds
    s_add_u32 m0, s51, 99328
    s_movk_i32 s49, 640
    buffer_load_dwordx4 v9, s[4:7], s49 offen  lds
    s_add_u32 m0, s52, 100352
    s_add_u32 s50, s50, s48
    buffer_load_dwordx4 v12, s[8:11], s50 offen  lds
    s_add_u32 m0, s52, 101376
    s_nop 0
    buffer_load_dwordx4 v13, s[8:11], s50 offen  lds
    s_add_u32 m0, s51, 100352
    s_movk_i32 s49, 640
    buffer_load_dwordx4 v10, s[4:7], s49 offen  lds
    s_add_u32 m0, s52, 102400
    s_add_u32 s50, s50, s48
    buffer_load_dwordx4 v12, s[8:11], s50 offen  lds
    s_add_u32 m0, s52, 103424
    s_nop 0
    buffer_load_dwordx4 v13, s[8:11], s50 offen  lds
    s_add_u32 m0, s51, 101376
    s_movk_i32 s49, 640
    buffer_load_dwordx4 v11, s[4:7], s49 offen  lds
    s_add_u32 m0, s52, 104448
    s_add_u32 s50, s50, s48
    buffer_load_dwordx4 v12, s[8:11], s50 offen  lds
    s_add_u32 m0, s52, 105472
    s_nop 0
    buffer_load_dwordx4 v13, s[8:11], s50 offen  lds
    s_mul_i32 s40, s62, 448
    s_mov_b64 exec, 0xffff
    buffer_load_dword v255, v17, s[8:11], s40 offen
    s_mov_b64 exec, -1
    s_waitcnt vmcnt(15)
    s_barrier
    s_waitcnt vmcnt(11)
    ds_read_b64_tr_b16 v[124:125], v16 offset:0
    ds_read_b64_tr_b16 v[126:127], v16 offset:256
    ds_read_b64_tr_b16 v[128:129], v16 offset:32
    ds_read_b64_tr_b16 v[130:131], v16 offset:288
    s_cmp_lg_u32 s61, 0
    s_cbranch_scc1 K_rr_55
    ds_read_b128 v[36:39], v188 offset:49152
    ds_read_b128 v[40:43], v189 offset:49152
    ds_read_b128 v[44:47], v190 offset:49152
    ds_read_b128 v[48:51], v191 offset:49152
K_rr_55:
    s_add_u32 m0, s51, 0
    s_movk_i32 s49, 768
    buffer_load_dwordx4 v8, s[4:7], s49 offen  lds
    s_add_u32 m0, s52, 0
    s_add_u32 s50, s50, s48
    buffer_load_dwordx4 v12, s[8:11], s50 offen  lds
    s_waitcnt lgkmcnt(0)
    s_mov_b32 m0, s60
    s_add_u32 s53, s51, 16384
    buffer_load_dwordx4 v4, s[12:15], s53 offen offset:0 lds
    buffer_load_dwordx4 v4, s[12:15], s53 offen offset:1024 lds
    s_add_u32 m0, s60, 2048
    s_mov_b32 s49, 1024
    buffer_load_dwordx4 v14, s[4:7], s49 offen lds
    s_add_u32 m0, s60, 3072
    s_nop 0
    buffer_load_dwordx4 v19, s[4:7], s49 offen lds
    v_mov_b32_dpp v172, v184 row_newbcast:0 row_mask:0xf bank_mask:0xf
    v_mov_b32_dpp v173, v185 row_newbcast:0 row_mask:0xf bank_mask:0xf
    v_mov_b32_dpp v174, v186 row_newbcast:0 row_mask:0xf bank_mask:0xf
    v_mov_b32_dpp v175, v187 row_newbcast:0 row_mask:0xf bank_mask:0xf
    v_mov_b32_dpp v176, v184 row_newbcast:1 row_mask:0xf bank_mask:0xf
    v_mov_b32_dpp v177, v185 row_newbcast:1 row_mask:0xf bank_mask:0xf
    v_mov_b32_dpp v178, v186 row_newbcast:1 row_mask:0xf bank_mask:0xf
    v_mov_b32_dpp v179, v187 row_newbcast:1 row_mask:0xf bank_mask:0xf
    s_bitcmp1_b32 s37, 3
    s_cbranch_scc1 K_sv_56
    v_mfma_f32_16x16x32_bf16 v[148:151], v[84:87], v[20:23], v[148:151]
    v_mfma_f32_16x16x32_bf16 v[152:155], v[88:91], v[20:23], v[152:155]
    v_mfma_f32_16x16x32_bf16 v[160:163], v[84:87], v[24:27], v[160:163]
    v_mfma_f32_16x16x32_bf16 v[164:167], v[88:91], v[24:27], v[164:167]
    v_mfma_f32_16x16x32_bf16 v[156:159], v[172:175], v[20:23], v[156:159]
    v_mfma_f32_16x16x32_bf16 v[148:151], v[92:95], v[28:31], v[148:151]
    v_mfma_f32_16x16x32_bf16 v[152:155], v[96:99], v[28:31], v[152:155]
    v_mfma_f32_16x16x32_bf16 v[160:163], v[92:95], v[32:35], v[160:163]
    v_mfma_f32_16x16x32_bf16 v[164:167], v[96:99], v[32:35], v[164:167]
    v_mfma_f32_16x16x32_bf16 v[156:159], v[176:179], v[28:31], v[156:159]
    s_branch K_se_57
K_sv_56:
    v_mfma_f32_16x16x32_bf16 v[148:151], v[20:23], v[84:87], v[148:151]
    v_mfma_f32_16x16x32_bf16 v[152:155], v[20:23], v[88:91], v[152:155]
    v_mfma_f32_16x16x32_bf16 v[160:163], v[24:27], v[84:87], v[160:163]
    v_mfma_f32_16x16x32_bf16 v[164:167], v[24:27], v[88:91], v[164:167]
    v_mfma_f32_16x16x32_bf16 v[168:171], v[172:175], v[24:27], v[168:171]
    v_mfma_f32_16x16x32_bf16 v[148:151], v[28:31], v[92:95], v[148:151]
    v_mfma_f32_16x16x32_bf16 v[152:155], v[28:31], v[96:99], v[152:155]
    v_mfma_f32_16x16x32_bf16 v[160:163], v[32:35], v[92:95], v[160:163]
    v_mfma_f32_16x16x32_bf16 v[164:167], v[32:35], v[96:99], v[164:167]
    v_mfma_f32_16x16x32_bf16 v[168:171], v[176:179], v[32:35], v[168:171]
K_se_57:
    s_add_u32 m0, s52, 1024
    s_nop 0
    buffer_load_dwordx4 v13, s[8:11], s50 offen  lds
    s_add_u32 m0, s51, 1024
    s_movk_i32 s49, 768
    buffer_load_dwordx4 v9, s[4:7], s49 offen  lds
    s_add_u32 m0, s52, 2048
    s_add_u32 s50, s50, s48
    buffer_load_dwordx4 v12, s[8:11], s50 offen  lds
    s_add_u32 m0, s52, 3072
    s_nop 0
    buffer_load_dwordx4 v13, s[8:11], s50 offen  lds
    s_add_u32 m0, s51, 2048
    s_movk_i32 s49, 768
    buffer_load_dwordx4 v10, s[4:7], s49 offen  lds
    s_add_u32 m0, s52, 4096
    s_add_u32 s50, s50, s48
    buffer_load_dwordx4 v12, s[8:11], s50 offen  lds
    s_add_u32 m0, s52, 5120
    s_nop 0
    buffer_load_dwordx4 v13, s[8:11], s50 offen  lds
    s_add_u32 m0, s51, 3072
    s_movk_i32 s49, 768
    buffer_load_dwordx4 v11, s[4:7], s49 offen  lds
    s_add_u32 m0, s52, 6144
    s_add_u32 s50, s50, s48
    buffer_load_dwordx4 v12, s[8:11], s50 offen  lds
    s_add_u32 m0, s52, 7168
    s_nop 0
    buffer_load_dwordx4 v13, s[8:11], s50 offen  lds
    s_waitcnt vmcnt(17)
    s_barrier
    s_waitcnt vmcnt(10)
    ds_read_b64_tr_b16 v[100:101], v16 offset:0
    ds_read_b64_tr_b16 v[102:103], v16 offset:256
    ds_read_b64_tr_b16 v[104:105], v16 offset:32
    ds_read_b64_tr_b16 v[106:107], v16 offset:288
    ds_read_b128 v[52:55], v180
    ds_read_b128 v[60:63], v181
    s_cmp_lg_u32 s61, 1
    s_cbranch_scc1 K_rr_58
    v_add_u32 v192, 98304, v188
    ds_read_b128 v[36:39], v192
    v_add_u32 v193, 98304, v189
    ds_read_b128 v[40:43], v193
    v_add_u32 v194, 98304, v190
    ds_read_b128 v[44:47], v194
    v_add_u32 v195, 98304, v191
    ds_read_b128 v[48:51], v195
K_rr_58:
    s_add_u32 m0, s51, 49152
    s_movk_i32 s49, 896
    buffer_load_dwordx4 v8, s[4:7], s49 offen  lds
    s_add_u32 m0, s52, 49152
    s_add_u32 s50, s50, s48
    buffer_load_dwordx4 v12, s[8:11], s50 offen  lds
    s_waitcnt lgkmcnt(0)
    s_mov_b32 m0, s60
    s_add_u32 s53, s51, 18432
    buffer_load_dwordx4 v4, s[12:15], s53 offen offset:0 lds
    buffer_load_dwordx4 v4, s[12:15], s53 offen offset:1024 lds
    s_add_u32 m0, s60, 2048
    s_mov_b32 s49, 33792
    buffer_load_dwordx4 v14, s[4:7], s49 offen lds
    s_add_u32 m0, s60, 3072
    s_nop 0
    buffer_load_dwordx4 v19, s[4:7], s49 offen lds
    s_add_u32 m0, s52, 50176
    s_nop 0
    buffer_load_dwordx4 v13, s[8:11], s50 offen  lds
    s_add_u32 m0, s51, 50176
    s_movk_i32 s49, 896
    buffer_load_dwordx4 v9, s[4:7], s49 offen  lds
    s_add_u32 m0, s52, 51200
    s_add_u32 s50, s50, s48
    buffer_load_dwordx4 v12, s[8:11], s50 offen  lds
    s_add_u32 m0, s52, 52224
    s_nop 0
    buffer_load_dwordx4 v13, s[8:11], s50 offen  lds
    s_add_u32 m0, s51, 51200
    s_movk_i32 s49, 896
    buffer_load_dwordx4 v10, s[4:7], s49 offen  lds
    s_add_u32 m0, s52, 53248
    s_add_u32 s50, s50, s48
    buffer_load_dwordx4 v12, s[8:11], s50 offen  lds
    s_add_u32 m0, s52, 54272
    s_nop 0
    buffer_load_dwordx4 v13, s[8:11], s50 offen  lds
    s_add_u32 m0, s51, 52224
    s_movk_i32 s49, 896
    buffer_load_dwordx4 v11, s[4:7], s49 offen  lds
    s_add_u32 m0, s52, 55296
    s_add_u32 s50, s50, s48
    buffer_load_dwordx4 v12, s[8:11], s50 offen  lds
    s_add_u32 m0, s52, 56320
    s_nop 0
    buffer_load_dwordx4 v13, s[8:11], s50 offen  lds
    s_waitcnt vmcnt(16)
    s_barrier
    s_waitcnt vmcnt(10)
    ds_read_b64_tr_b16 v[108:109], v16 offset:0
    ds_read_b64_tr_b16 v[110:111], v16 offset:256
    ds_read_b64_tr_b16 v[112:113], v16 offset:32
    ds_read_b64_tr_b16 v[114:115], v16 offset:288
    ds_read_b128 v[56:59], v180
    ds_read_b128 v[64:67], v181
    s_cmp_lg_u32 s61, 2
    s_cbranch_scc1 K_rr_59
    ds_read_b128 v[36:39], v188 offset:0
    ds_read_b128 v[40:43], v189 offset:0
    ds_read_b128 v[44:47], v190 offset:0
    ds_read_b128 v[48:51], v191 offset:0
K_rr_59:
    s_add_u32 m0, s51, 98304
    s_movk_i32 s49, 1024
    buffer_load_dwordx4 v8, s[4:7], s49 offen  lds
    s_add_u32 m0, s52, 98304
    s_add_u32 s50, s50, s48
    buffer_load_dwordx4 v12, s[8:11], s50 offen  lds
    s_waitcnt lgkmcnt(0)
    s_mov_b32 m0, s60
    s_add_u32 s53, s51, 49152
    buffer_load_dwordx4 v4, s[12:15], s53 offen offset:0 lds
    buffer_load_dwordx4 v4, s[12:15], s53 offen offset:1024 lds
    s_add_u32 m0, s60, 2048
    s_mov_b32 s49, 1536
    buffer_load_dwordx4 v14, s[4:7], s49 offen lds
    s_add_u32 m0, s60, 3072
    s_nop 0
    buffer_load_dwordx4 v19, s[4:7], s49 offen lds
    v_mov_b32_dpp v172, v184 row_newbcast:4 row_mask:0xf bank_mask:0xf
    v_mov_b32_dpp v173, v185 row_newbcast:4 row_mask:0xf bank_mask:0xf
    v_mov_b32_dpp v174, v186 row_newbcast:4 row_mask:0xf bank_mask:0xf
    v_mov_b32_dpp v175, v187 row_newbcast:4 row_mask:0xf bank_mask:0xf
    v_mov_b32_dpp v176, v184 row_newbcast:5 row_mask:0xf bank_mask:0xf
    v_mov_b32_dpp v177, v185 row_newbcast:5 row_mask:0xf bank_mask:0xf
    v_mov_b32_dpp v178, v186 row_newbcast:5 row_mask:0xf bank_mask:0xf
    v_mov_b32_dpp v179, v187 row_newbcast:5 row_mask:0xf bank_mask:0xf
    s_bitcmp1_b32 s37, 3
    s_cbranch_scc1 K_sv_60
    v_mfma_f32_16x16x32_bf16 v[148:151], v[116:119], v[52:55], v[148:151]
    v_mfma_f32_16x16x32_bf16 v[152:155], v[120:123], v[52:55], v[152:155]
    v_mfma_f32_16x16x32_bf16 v[160:163], v[116:119], v[56:59], v[160:163]
    v_mfma_f32_16x16x32_bf16 v[164:167], v[120:123], v[56:59], v[164:167]
    v_mfma_f32_16x16x32_bf16 v[156:159], v[172:175], v[52:55], v[156:159]
    v_mfma_f32_16x16x32_bf16 v[148:151], v[124:127], v[60:63], v[148:151]
    v_mfma_f32_16x16x32_bf16 v[152:155], v[128:131], v[60:63], v[152:155]
    v_mfma_f32_16x16x32_bf16 v[160:163], v[124:127], v[64:67], v[160:163]
    v_mfma_f32_16x16x32_bf16 v[164:167], v[128:131], v[64:67], v[164:167]
    v_mfma_f32_16x16x32_bf16 v[156:159], v[176:179], v[60:63], v[156:159]
    s_branch K_se_61
K_sv_60:
    v_mfma_f32_16x16x32_bf16 v[148:151], v[52:55], v[116:119], v[148:151]
    v_mfma_f32_16x16x32_bf16 v[152:155], v[52:55], v[120:123], v[152:155]
    v_mfma_f32_16x16x32_bf16 v[160:163], v[56:59], v[116:119], v[160:163]
    v_mfma_f32_16x16x32_bf16 v[164:167], v[56:59], v[120:123], v[164:167]
    v_mfma_f32_16x16x32_bf16 v[168:171], v[172:175], v[56:59], v[168:171]
    v_mfma_f32_16x16x32_bf16 v[148:151], v[60:63], v[124:127], v[148:151]
    v_mfma_f32_16x16x32_bf16 v[152:155], v[60:63], v[128:131], v[152:155]
    v_mfma_f32_16x16x32_bf16 v[160:163], v[64:67], v[124:127], v[160:163]
    v_mfma_f32_16x16x32_bf16 v[164:167], v[64:67], v[128:131], v[164:167]
    v_mfma_f32_16x16x32_bf16 v[168:171], v[176:179], v[64:67], v[168:171]
K_se_61:
    s_add_u32 m0, s52, 99328
    s_nop 0
    buffer_load_dwordx4 v13, s[8:11], s50 offen  lds
    s_add_u32 m0, s51, 99328
    s_movk_i32 s49, 1024
    buffer_load_dwordx4 v9, s[4:7], s49 offen  lds
    s_add_u32 m0, s52, 100352
    s_add_u32 s50, s50, s48
    buffer_load_dwordx4 v12, s[8:11], s50 offen  lds
    s_add_u32 m0, s52, 101376
    s_nop 0
    buffer_load_dwordx4 v13, s[8:11], s50 offen  lds
    s_add_u32 m0, s51, 100352
    s_movk_i32 s49, 1024
    buffer_load_dwordx4 v10, s[4:7], s49 offen  lds
    s_add_u32 m0, s52, 102400
    s_add_u32 s50, s50, s48
    buffer_load_dwordx4 v12, s[8:11], s50 offen  lds
    s_add_u32 m0, s52, 103424
    s_nop 0
    buffer_load_dwordx4 v13, s[8:11], s50 offen  lds
    s_add_u32 m0, s51, 101376
    s_movk_i32 s49, 1024
    buffer_load_dwordx4 v11, s[4:7], s49 offen  lds
    s_add_u32 m0, s52, 104448
    s_add_u32 s50, s50, s48
    buffer_load_dwordx4 v12, s[8:11], s50 offen  lds
    s_add_u32 m0, s52, 105472
    s_nop 0
    buffer_load_dwordx4 v13, s[8:11], s50 offen  lds
    s_waitcnt vmcnt(16)
    s_barrier
    s_waitcnt vmcnt(10)
    ds_read_b64_tr_b16 v[132:133], v16 offset:0
    ds_read_b64_tr_b16 v[134:135], v16 offset:256
    ds_read_b64_tr_b16 v[136:137], v16 offset:32
    ds_read_b64_tr_b16 v[138:139], v16 offset:288
    ds_read_b128 v[68:71], v180
    ds_read_b128 v[76:79], v181
    s_cmp_lg_u32 s61, 3
    s_cbranch_scc1 K_rr_62
    ds_read_b128 v[36:39], v188 offset:49152
    ds_read_b128 v[40:43], v189 offset:49152
    ds_read_b128 v[44:47], v190 offset:49152
    ds_read_b128 v[48:51], v191 offset:49152
K_rr_62:
    s_add_u32 m0, s51, 0
    s_movk_i32 s49, 1152
    buffer_load_dwordx4 v8, s[4:7], s49 offen  lds
    s_add_u32 m0, s52, 0
    s_add_u32 s50, s50, s48
    buffer_load_dwordx4 v12, s[8:11], s50 offen  lds
    s_waitcnt lgkmcnt(0)
    s_mov_b32 m0, s60
    s_add_u32 s53, s51, 51200
    buffer_load_dwordx4 v4, s[12:15], s53 offen offset:0 lds
    buffer_load_dwordx4 v4, s[12:15], s53 offen offset:1024 lds
    s_add_u32 m0, s60, 2048
    s_mov_b32 s49, 34304
    buffer_load_dwordx4 v14, s[4:7], s49 offen lds
    s_add_u32 m0, s60, 3072
    s_nop 0
    buffer_load_dwordx4 v19, s[4:7], s49 offen lds
    s_add_u32 m0, s52, 1024
    s_nop 0
    buffer_load_dwordx4 v13, s[8:11], s50 offen  lds
    s_add_u32 m0, s51, 1024
    s_movk_i32 s49, 1152
    buffer_load_dwordx4 v9, s[4:7], s49 offen  lds
    s_add_u32 m0, s52, 2048
    s_add_u32 s50, s50, s48
    buffer_load_dwordx4 v12, s[8:11], s50 offen  lds
    s_add_u32 m0, s52, 3072
    s_nop 0
    buffer_load_dwordx4 v13, s[8:11], s50 offen  lds
    s_add_u32 m0, s51, 2048
    s_movk_i32 s49, 1152
    buffer_load_dwordx4 v10, s[4:7], s49 offen  lds
    s_add_u32 m0, s52, 4096
    s_add_u32 s50, s50, s48
    buffer_load_dwordx4 v12, s[8:11], s50 offen  lds
    s_add_u32 m0, s52, 5120
    s_nop 0
    buffer_load_dwordx4 v13, s[8:11], s50 offen  lds
    s_add_u32 m0, s51, 3072
    s_movk_i32 s49, 1152
    buffer_load_dwordx4 v11, s[4:7], s49 offen  lds
    s_add_u32 m0, s52, 6144
    s_add_u32 s50, s50, s48
    buffer_load_dwordx4 v12, s[8:11], s50 offen  lds
    s_add_u32 m0, s52, 7168
    s_nop 0
    buffer_load_dwordx4 v13, s[8:11], s50 offen  lds
    s_mul_i32 s40, s62, 704
    s_mov_b64 exec, 0
    s_mov_b32 exec_lo, -1
    s_mov_b32 exec_hi, 0x0
    buffer_load_dword v255, v17, s[8:11], s40 offen
    s_mov_b64 exec, -1
    s_waitcnt vmcnt(17)
    s_barrier
    s_waitcnt vmcnt(11)
    ds_read_b64_tr_b16 v[140:141], v16 offset:0
    ds_read_b64_tr_b16 v[142:143], v16 offset:256
    ds_read_b64_tr_b16 v[144:145], v16 offset:32
    ds_read_b64_tr_b16 v[146:147], v16 offset:288
    ds_read_b128 v[72:75], v180
    ds_read_b128 v[80:83], v181
    s_add_u32 m0, s51, 49152
    s_movk_i32 s49, 1280
    buffer_load_dwordx4 v8, s[4:7], s49 offen  lds
    s_add_u32 m0, s52, 49152
    s_add_u32 s50, s50, s48
    buffer_load_dwordx4 v12, s[8:11], s50 offen  lds
    s_waitcnt lgkmcnt(0)
    v_mov_b32_dpp v172, v184 row_newbcast:2 row_mask:0xf bank_mask:0xf
    v_mov_b32_dpp v173, v185 row_newbcast:2 row_mask:0xf bank_mask:0xf
    v_mov_b32_dpp v174, v186 row_newbcast:2 row_mask:0xf bank_mask:0xf
    v_mov_b32_dpp v175, v187 row_newbcast:2 row_mask:0xf bank_mask:0xf
    v_mov_b32_dpp v176, v184 row_newbcast:3 row_mask:0xf bank_mask:0xf
    v_mov_b32_dpp v177, v185 row_newbcast:3 row_mask:0xf bank_mask:0xf
    v_mov_b32_dpp v178, v186 row_newbcast:3 row_mask:0xf bank_mask:0xf
    v_mov_b32_dpp v179, v187 row_newbcast:3 row_mask:0xf bank_mask:0xf
    s_bitcmp1_b32 s37, 3
    s_cbranch_scc1 K_sv_63
    v_mfma_f32_16x16x32_bf16 v[148:151], v[100:103], v[36:39], v[148:151]
    v_mfma_f32_16x16x32_bf16 v[152:155], v[104:107], v[36:39], v[152:155]
    v_mfma_f32_16x16x32_bf16 v[160:163], v[100:103], v[40:43], v[160:163]
    v_mfma_f32_16x16x32_bf16 v[164:167], v[104:107], v[40:43], v[164:167]
    v_mfma_f32_16x16x32_bf16 v[156:159], v[172:175], v[36:39], v[156:159]
    v_mfma_f32_16x16x32_bf16 v[148:151], v[108:111], v[44:47], v[148:151]
    v_mfma_f32_16x16x32_bf16 v[152:155], v[112:115], v[44:47], v[152:155]
    v_mfma_f32_16x16x32_bf16 v[160:163], v[108:111], v[48:51], v[160:163]
    v_mfma_f32_16x16x32_bf16 v[164:167], v[112:115], v[48:51], v[164:167]
    v_mfma_f32_16x16x32_bf16 v[156:159], v[176:179], v[44:47], v[156:159]
    s_branch K_se_64
K_sv_63:
    v_mfma_f32_16x16x32_bf16 v[148:151], v[36:39], v[100:103], v[148:151]
    v_mfma_f32_16x16x32_bf16 v[152:155], v[36:39], v[104:107], v[152:155]
    v_mfma_f32_16x16x32_bf16 v[160:163], v[40:43], v[100:103], v[160:163]
    v_mfma_f32_16x16x32_bf16 v[164:167], v[40:43], v[104:107], v[164:167]
    v_mfma_f32_16x16x32_bf16 v[168:171], v[172:175], v[40:43], v[168:171]
    v_mfma_f32_16x16x32_bf16 v[148:151], v[44:47], v[108:111], v[148:151]
    v_mfma_f32_16x16x32_bf16 v[152:155], v[44:47], v[112:115], v[152:155]
    v_mfma_f32_16x16x32_bf16 v[160:163], v[48:51], v[108:111], v[160:163]
    v_mfma_f32_16x16x32_bf16 v[164:167], v[48:51], v[112:115], v[164:167]
    v_mfma_f32_16x16x32_bf16 v[168:171], v[176:179], v[48:51], v[168:171]
K_se_64:
    s_add_u32 m0, s52, 50176
    s_nop 0
    buffer_load_dwordx4 v13, s[8:11], s50 offen  lds
    s_add_u32 m0, s51, 50176
    s_movk_i32 s49, 1280
    buffer_load_dwordx4 v9, s[4:7], s49 offen  lds
    s_add_u32 m0, s52, 51200
    s_add_u32 s50, s50, s48
    buffer_load_dwordx4 v12, s[8:11], s50 offen  lds
    v_mov_b32_dpp v172, v184 row_newbcast:6 row_mask:0xf bank_mask:0xf
    v_mov_b32_dpp v173, v185 row_newbcast:6 row_mask:0xf bank_mask:0xf
    v_mov_b32_dpp v174, v186 row_newbcast:6 row_mask:0xf bank_mask:0xf
    v_mov_b32_dpp v175, v187 row_newbcast:6 row_mask:0xf bank_mask:0xf
    v_mov_b32_dpp v176, v184 row_newbcast:7 row_mask:0xf bank_mask:0xf
    v_mov_b32_dpp v177, v185 row_newbcast:7 row_mask:0xf bank_mask:0xf
    v_mov_b32_dpp v178, v186 row_newbcast:7 row_mask:0xf bank_mask:0xf
    v_mov_b32_dpp v179, v187 row_newbcast:7 row_mask:0xf bank_mask:0xf
    s_bitcmp1_b32 s37, 3
    s_cbranch_scc1 K_sv_65
    v_mfma_f32_16x16x32_bf16 v[148:151], v[132:135], v[68:71], v[148:151]
    v_mfma_f32_16x16x32_bf16 v[152:155], v[136:139], v[68:71], v[152:155]
    v_mfma_f32_16x16x32_bf16 v[160:163], v[132:135], v[72:75], v[160:163]
    v_mfma_f32_16x16x32_bf16 v[164:167], v[136:139], v[72:75], v[164:167]
    v_mfma_f32_16x16x32_bf16 v[156:159], v[172:175], v[68:71], v[156:159]
    v_mfma_f32_16x16x32_bf16 v[148:151], v[140:143], v[76:79], v[148:151]
    v_mfma_f32_16x16x32_bf16 v[152:155], v[144:147], v[76:79], v[152:155]
    v_mfma_f32_16x16x32_bf16 v[160:163], v[140:143], v[80:83], v[160:163]
    v_mfma_f32_16x16x32_bf16 v[164:167], v[144:147], v[80:83], v[164:167]
    v_mfma_f32_16x16x32_bf16 v[156:159], v[176:179], v[76:79], v[156:159]
    s_branch K_se_66
K_sv_65:
    v_mfma_f32_16x16x32_bf16 v[148:151], v[68:71], v[132:135], v[148:151]
    v_mfma_f32_16x16x32_bf16 v[152:155], v[68:71], v[136:139], v[152:155]
    v_mfma_f32_16x16x32_bf16 v[160:163], v[72:75], v[132:135], v[160:163]
    v_mfma_f32_16x16x32_bf16 v[164:167], v[72:75], v[136:139], v[164:167]
    v_mfma_f32_16x16x32_bf16 v[168:171], v[172:175], v[72:75], v[168:171]
    v_mfma_f32_16x16x32_bf16 v[148:151], v[76:79], v[140:143], v[148:151]
    v_mfma_f32_16x16x32_bf16 v[152:155], v[76:79], v[144:147], v[152:155]
    v_mfma_f32_16x16x32_bf16 v[160:163], v[80:83], v[140:143], v[160:163]
    v_mfma_f32_16x16x32_bf16 v[164:167], v[80:83], v[144:147], v[164:167]
    v_mfma_f32_16x16x32_bf16 v[168:171], v[176:179], v[80:83], v[168:171]
K_se_66:
    s_add_u32 m0, s52, 52224
    s_nop 0
    buffer_load_dwordx4 v13, s[8:11], s50 offen  lds
    s_add_u32 m0, s51, 51200
    s_movk_i32 s49, 1280
    buffer_load_dwordx4 v10, s[4:7], s49 offen  lds
    s_add_u32 m0, s52, 53248
    s_add_u32 s50, s50, s48
    buffer_load_dwordx4 v12, s[8:11], s50 offen  lds
    s_add_u32 m0, s52, 54272
    s_nop 0
    buffer_load_dwordx4 v13, s[8:11], s50 offen  lds
    s_add_u32 m0, s51, 52224
    s_movk_i32 s49, 1280
    buffer_load_dwordx4 v11, s[4:7], s49 offen  lds
    s_add_u32 m0, s52, 55296
    s_add_u32 s50, s50, s48
    buffer_load_dwordx4 v12, s[8:11], s50 offen  lds
    s_add_u32 m0, s52, 56320
    s_nop 0
    buffer_load_dwordx4 v13, s[8:11], s50 offen  lds
    s_waitcnt vmcnt(13)
    s_barrier
    s_cmp_eq_u32 s61, 0
    s_cbranch_scc1 K_pw_67
    ds_write_b128 v196, v[148:151] offset:0
    ds_write_b128 v196, v[152:155] offset:1024
    ds_write_b32 v197, v156 offset:2048
K_pw_67:
    s_cmp_eq_u32 s61, 1
    s_cbranch_scc1 K_pw_68
    ds_write_b128 v196, v[160:163] offset:6912
    ds_write_b128 v196, v[164:167] offset:7936
    ds_write_b32 v197, v168 offset:8960
K_pw_68:
    s_add_u32 m0, s51, 98304
    s_movk_i32 s49, 1408
    buffer_load_dwordx4 v8, s[4:7], s49 offen  lds
    s_add_u32 m0, s52, 98304
    s_add_u32 s50, s50, s48
    buffer_load_dwordx4 v12, s[8:11], s50 offen  lds
    s_add_u32 m0, s52, 99328
    s_nop 0
    buffer_load_dwordx4 v13, s[8:11], s50 offen  lds
    s_add_u32 m0, s51, 99328
    s_movk_i32 s49, 1408
    buffer_load_dwordx4 v9, s[4:7], s49 offen  lds
    s_add_u32 m0, s52, 100352
    s_add_u32 s50, s50, s48
    buffer_load_dwordx4 v12, s[8:11], s50 offen  lds
    s_add_u32 m0, s52, 101376
    s_nop 0
    buffer_load_dwordx4 v13, s[8:11], s50 offen  lds
    s_add_u32 m0, s51, 100352
    s_movk_i32 s49, 1408
    buffer_load_dwordx4 v10, s[4:7], s49 offen  lds
    s_add_u32 m0, s52, 102400
    s_add_u32 s50, s50, s48
    buffer_load_dwordx4 v12, s[8:11], s50 offen  lds
    s_add_u32 m0, s52, 103424
    s_nop 0
    buffer_load_dwordx4 v13, s[8:11], s50 offen  lds
    s_add_u32 m0, s51, 101376
    s_movk_i32 s49, 1408
    buffer_load_dwordx4 v11, s[4:7], s49 offen  lds
    s_add_u32 m0, s52, 104448
    s_add_u32 s50, s50, s48
    buffer_load_dwordx4 v12, s[8:11], s50 offen  lds
    s_add_u32 m0, s52, 105472
    s_nop 0
    buffer_load_dwordx4 v13, s[8:11], s50 offen  lds
    s_waitcnt lgkmcnt(0)
    s_waitcnt vmcnt(12)
    s_barrier
    ds_read_b128 v[20:23], v198 offset:0
    ds_read_b128 v[24:27], v198 offset:1024
    ds_read_b32 v28, v199 offset:2048
    ds_read_b128 v[32:35], v198 offset:2304
    ds_read_b128 v[36:39], v198 offset:3328
    ds_read_b32 v40, v199 offset:4352
    ds_read_b128 v[44:47], v198 offset:4608
    ds_read_b128 v[48:51], v198 offset:5632
    ds_read_b32 v52, v199 offset:6656
    s_add_u32 m0, s51, 0
    s_movk_i32 s49, 1536
    buffer_load_dwordx4 v8, s[4:7], s49 offen  lds
    s_add_u32 m0, s52, 0
    s_add_u32 s50, s50, s48
    buffer_load_dwordx4 v12, s[8:11], s50 offen  lds
    s_cmp_gt_u32 s61, 1
    s_cbranch_scc1 K_pe_70
    s_cmp_eq_u32 s61, 0
    s_cbranch_scc1 K_p0_71
    v_mov_b32 v148, v160
    v_mov_b32 v149, v161
    v_mov_b32 v150, v162
    v_mov_b32 v151, v163
    v_mov_b32 v152, v164
    v_mov_b32 v153, v165
    v_mov_b32 v154, v166
    v_mov_b32 v155, v167
    v_mov_b32 v156, v168
K_p0_71:
    s_and_b32 s40, s37, 3
    s_lshl2_add_u32 s40, s36, s40
    s_lshl_b32 s41, s40, 12
    s_add_u32 s41, s41, 16777216
    s_lshl1_add_u32 s40, s40, s61
    s_waitcnt lgkmcnt(0)
    v_add_f32 v148, v148, v20
    v_add_f32 v149, v149, v21
    v_add_f32 v150, v150, v22
    v_add_f32 v151, v151, v23
    v_add_f32 v152, v152, v24
    v_add_f32 v153, v153, v25
    v_add_f32 v154, v154, v26
    v_add_f32 v155, v155, v27
    v_add_f32 v156, v156, v28
    v_add_f32 v148, v148, v32
    v_add_f32 v149, v149, v33
    v_add_f32 v150, v150, v34
    v_add_f32 v151, v151, v35
    v_add_f32 v152, v152, v36
    v_add_f32 v153, v153, v37
    v_add_f32 v154, v154, v38
    v_add_f32 v155, v155, v39
    v_add_f32 v156, v156, v40
    v_add_f32 v148, v148, v44
    v_add_f32 v149, v149, v45
    v_add_f32 v150, v150, v46
    v_add_f32 v151, v151, v47
    v_add_f32 v152, v152, v48
    v_add_f32 v153, v153, v49
    v_add_f32 v154, v154, v50
    v_add_f32 v155, v155, v51
    v_add_f32 v156, v156, v52
    s_lshr_b32 s42, s37, 3
    s_cmp_lg_u32 s42, s61
    s_cbranch_scc1 K_pg_72
    v_mul_f32 v156, 0xbfb8aa3b, v156
    v_exp_f32 v156, v156
    s_lshl_b32 s40, s40, 6
    v_add_f32 v156, 1.0, v156
    v_rcp_f32 v156, v156
    s_add_u32 s40, s40, 17039360
    s_mov_b64 exec, 0xffff
    buffer_store_dword v156, v243, s[20:23], s40 offen sc1
    s_mov_b64 exec, -1
K_pg_72:
    s_bitcmp1_b32 s37, 3
    s_cbranch_scc1 K_pv_69
    v_mul_f32 v148, 0x3e8293ee, v148
    v_mul_f32 v149, 0x3e8293ee, v149
    v_mul_f32 v150, 0x3e8293ee, v150
    v_mul_f32 v151, 0x3e8293ee, v151
    v_mul_f32 v152, 0x3e8293ee, v152
    v_mul_f32 v153, 0x3e8293ee, v153
    v_mul_f32 v154, 0x3e8293ee, v154
    v_mul_f32 v155, 0x3e8293ee, v155
    v_cvt_pk_bf16_f32 v172, v148, v149
    v_cvt_pk_bf16_f32 v173, v150, v151
    v_cvt_pk_bf16_f32 v174, v152, v153
    v_cvt_pk_bf16_f32 v175, v154, v155
    v_lshlrev_b32 v5, 9, v3
    v_lshl_add_u32 v5, v2, 4, v5
    s_lshl_b32 s42, s61, 8
    s_add_u32 s41, s41, s42
    buffer_store_dwordx4 v[172:175], v5, s[20:23], s41 offen sc1
    s_branch K_pe_70
K_pv_69:
    v_cvt_pk_bf16_f32 v172, v148, v149
    v_cvt_pk_bf16_f32 v173, v150, v151
    v_cvt_pk_bf16_f32 v174, v152, v153
    v_cvt_pk_bf16_f32 v175, v154, v155
    v_lshrrev_b32 v5, 1, v3
    v_lshlrev_b32 v5, 9, v5
    v_lshl_add_u32 v5, v2, 4, v5
    v_and_b32 v6, 1, v3
    v_lshl_add_u32 v5, v6, 3, v5
    s_lshl_b32 s42, s61, 10
    s_add_u32 s41, s41, s42
    buffer_store_dwordx2 v[172:173], v5, s[20:23], s41 offen offset:2048 sc1
    buffer_store_dwordx2 v[174:175], v5, s[20:23], s41 offen offset:2304 sc1
K_pe_70:
    s_add_u32 m0, s52, 1024
    s_nop 0
    buffer_load_dwordx4 v13, s[8:11], s50 offen  lds
    s_add_u32 m0, s51, 1024
    s_movk_i32 s49, 1536
    buffer_load_dwordx4 v9, s[4:7], s49 offen  lds
    s_add_u32 m0, s52, 2048
    s_add_u32 s50, s50, s48
    buffer_load_dwordx4 v12, s[8:11], s50 offen  lds
    s_add_u32 m0, s52, 3072
    s_nop 0
    buffer_load_dwordx4 v13, s[8:11], s50 offen  lds
    s_add_u32 m0, s51, 2048
    s_movk_i32 s49, 1536
    buffer_load_dwordx4 v10, s[4:7], s49 offen  lds
    s_add_u32 m0, s52, 4096
    s_add_u32 s50, s50, s48
    buffer_load_dwordx4 v12, s[8:11], s50 offen  lds
    s_add_u32 m0, s52, 5120
    s_nop 0
    buffer_load_dwordx4 v13, s[8:11], s50 offen  lds
    s_add_u32 m0, s51, 3072
    s_movk_i32 s49, 1536
    buffer_load_dwordx4 v11, s[4:7], s49 offen  lds
    s_add_u32 m0, s52, 6144
    s_add_u32 s50, s50, s48
    buffer_load_dwordx4 v12, s[8:11], s50 offen  lds
    s_add_u32 m0, s52, 7168
    s_nop 0
    buffer_load_dwordx4 v13, s[8:11], s50 offen  lds
    s_waitcnt vmcnt(9)
    s_barrier
    s_cmp_lg_u32 s61, 3
    s_cbranch_scc1 K_nf_73
    s_and_b32 s40, s37, 3
    s_lshl2_add_u32 s40, s36, s40
    s_lshl_b32 s40, s40, 5
    s_lshr_b32 s41, s37, 3
    s_add_u32 s40, s40, s41
    s_lshl_b32 s40, s40, 2
    s_add_u32 s40, s40, 17301504
    s_mov_b64 exec, 1
    buffer_store_dword v240, off, s[20:23], s40 sc1
    s_mov_b64 exec, -1
K_nf_73:
    s_add_u32 m0, s51, 49152
    s_movk_i32 s49, 1664
    buffer_load_dwordx4 v8, s[4:7], s49 offen  lds
    s_add_u32 m0, s52, 49152
    s_add_u32 s50, s50, s48
    buffer_load_dwordx4 v12, s[8:11], s50 offen  lds
    s_add_u32 m0, s52, 50176
    s_nop 0
    buffer_load_dwordx4 v13, s[8:11], s50 offen  lds
    s_add_u32 m0, s51, 50176
    s_movk_i32 s49, 1664
    buffer_load_dwordx4 v9, s[4:7], s49 offen  lds
    s_add_u32 m0, s52, 51200
    s_add_u32 s50, s50, s48
    buffer_load_dwordx4 v12, s[8:11], s50 offen  lds
    s_add_u32 m0, s52, 52224
    s_nop 0
    buffer_load_dwordx4 v13, s[8:11], s50 offen  lds
    s_add_u32 m0, s51, 51200
    s_movk_i32 s49, 1664
    buffer_load_dwordx4 v10, s[4:7], s49 offen  lds
    s_add_u32 m0, s52, 53248
    s_add_u32 s50, s50, s48
    buffer_load_dwordx4 v12, s[8:11], s50 offen  lds
    s_add_u32 m0, s52, 54272
    s_nop 0
    buffer_load_dwordx4 v13, s[8:11], s50 offen  lds
    s_add_u32 m0, s51, 52224
    s_movk_i32 s49, 1664
    buffer_load_dwordx4 v11, s[4:7], s49 offen  lds
    s_add_u32 m0, s52, 55296
    s_add_u32 s50, s50, s48
    buffer_load_dwordx4 v12, s[8:11], s50 offen  lds
    s_add_u32 m0, s52, 56320
    s_nop 0
    buffer_load_dwordx4 v13, s[8:11], s50 offen  lds
    s_waitcnt vmcnt(12)
    s_barrier
    s_add_u32 m0, s51, 98304
    s_movk_i32 s49, 1792
    buffer_load_dwordx4 v8, s[4:7], s49 offen  lds
    s_add_u32 m0, s52, 98304
    s_add_u32 s50, s50, s48
    buffer_load_dwordx4 v12, s[8:11], s50 offen  lds
    s_add_u32 m0, s52, 99328
    s_nop 0
    buffer_load_dwordx4 v13, s[8:11], s50 offen  lds
    s_add_u32 m0, s51, 99328
    s_movk_i32 s49, 1792
    buffer_load_dwordx4 v9, s[4:7], s49 offen  lds
    s_add_u32 m0, s52, 100352
    s_add_u32 s50, s50, s48
    buffer_load_dwordx4 v12, s[8:11], s50 offen  lds
    s_add_u32 m0, s52, 101376
    s_nop 0
    buffer_load_dwordx4 v13, s[8:11], s50 offen  lds
    s_add_u32 m0, s51, 100352
    s_movk_i32 s49, 1792
    buffer_load_dwordx4 v10, s[4:7], s49 offen  lds
    s_add_u32 m0, s52, 102400
    s_add_u32 s50, s50, s48
    buffer_load_dwordx4 v12, s[8:11], s50 offen  lds
    s_add_u32 m0, s52, 103424
    s_nop 0
    buffer_load_dwordx4 v13, s[8:11], s50 offen  lds
    s_add_u32 m0, s51, 101376
    s_movk_i32 s49, 1792
    buffer_load_dwordx4 v11, s[4:7], s49 offen  lds
    s_add_u32 m0, s52, 104448
    s_add_u32 s50, s50, s48
    buffer_load_dwordx4 v12, s[8:11], s50 offen  lds
    s_add_u32 m0, s52, 105472
    s_nop 0
    buffer_load_dwordx4 v13, s[8:11], s50 offen  lds
    s_waitcnt vmcnt(12)
    s_barrier
    s_add_u32 m0, s51, 0
    s_movk_i32 s49, 1920
    buffer_load_dwordx4 v8, s[4:7], s49 offen  lds
    s_add_u32 m0, s52, 0
    s_add_u32 s50, s50, s48
    buffer_load_dwordx4 v12, s[8:11], s50 offen  lds
    s_add_u32 m0, s52, 1024
    s_nop 0
    buffer_load_dwordx4 v13, s[8:11], s50 offen  lds
    s_add_u32 m0, s51, 1024
    s_movk_i32 s49, 1920
    buffer_load_dwordx4 v9, s[4:7], s49 offen  lds
    s_add_u32 m0, s52, 2048
    s_add_u32 s50, s50, s48
    buffer_load_dwordx4 v12, s[8:11], s50 offen  lds
    s_add_u32 m0, s52, 3072
    s_nop 0
    buffer_load_dwordx4 v13, s[8:11], s50 offen  lds
    s_add_u32 m0, s51, 2048
    s_movk_i32 s49, 1920
    buffer_load_dwordx4 v10, s[4:7], s49 offen  lds
    s_add_u32 m0, s52, 4096
    s_add_u32 s50, s50, s48
    buffer_load_dwordx4 v12, s[8:11], s50 offen  lds
    s_add_u32 m0, s52, 5120
    s_nop 0
    buffer_load_dwordx4 v13, s[8:11], s50 offen  lds
    s_add_u32 m0, s51, 3072
    s_movk_i32 s49, 1920
    buffer_load_dwordx4 v11, s[4:7], s49 offen  lds
    s_add_u32 m0, s52, 6144
    s_add_u32 s50, s50, s48
    buffer_load_dwordx4 v12, s[8:11], s50 offen  lds
    s_add_u32 m0, s52, 7168
    s_nop 0
    buffer_load_dwordx4 v13, s[8:11], s50 offen  lds
    s_waitcnt vmcnt(12)
    s_branch K_phend
K_ph1_3:
    s_barrier
    s_cmp_lg_u32 s61, 0
    s_cbranch_scc1 K_rr_74
    ds_read_b128 v[20:23], v188 offset:0
    ds_read_b128 v[24:27], v189 offset:0
    ds_read_b128 v[28:31], v190 offset:0
    ds_read_b128 v[32:35], v191 offset:0
K_rr_74:
    s_add_u32 m0, s52, 54272
    s_nop 0
    buffer_load_dwordx4 v13, s[8:11], s50 offen  lds
    s_add_u32 m0, s51, 52224
    s_movk_i32 s49, 128
    buffer_load_dwordx4 v11, s[4:7], s49 offen  lds
    s_add_u32 m0, s52, 55296
    s_add_u32 s50, s50, s48
    buffer_load_dwordx4 v12, s[8:11], s50 offen  lds
    s_add_u32 m0, s52, 56320
    s_nop 0
    buffer_load_dwordx4 v13, s[8:11], s50 offen  lds
    s_waitcnt lgkmcnt(0)
    buffer_load_dwordx4 v[184:187], v15, s[16:19], 0 offen
    s_mov_b32 m0, s60
    s_add_u32 s53, s51, 0
    buffer_load_dwordx4 v4, s[12:15], s53 offen offset:0 lds
    buffer_load_dwordx4 v4, s[12:15], s53 offen offset:1024 lds
    s_add_u32 m0, s51, 98304
    s_movk_i32 s49, 256
    buffer_load_dwordx4 v8, s[4:7], s49 offen  lds
    s_add_u32 m0, s52, 98304
    s_add_u32 s50, s50, s48
    buffer_load_dwordx4 v12, s[8:11], s50 offen  lds
    s_add_u32 m0, s52, 99328
    s_nop 0
    buffer_load_dwordx4 v13, s[8:11], s50 offen  lds
    s_add_u32 m0, s51, 99328
    s_movk_i32 s49, 256
    buffer_load_dwordx4 v9, s[4:7], s49 offen  lds
    s_add_u32 m0, s52, 100352
    s_add_u32 s50, s50, s48
    buffer_load_dwordx4 v12, s[8:11], s50 offen  lds
    s_add_u32 m0, s52, 101376
    s_nop 0
    buffer_load_dwordx4 v13, s[8:11], s50 offen  lds
    s_add_u32 m0, s51, 100352
    s_movk_i32 s49, 256
    buffer_load_dwordx4 v10, s[4:7], s49 offen  lds
    s_add_u32 m0, s52, 102400
    s_add_u32 s50, s50, s48
    buffer_load_dwordx4 v12, s[8:11], s50 offen  lds
    s_add_u32 m0, s52, 103424
    s_nop 0
    buffer_load_dwordx4 v13, s[8:11], s50 offen  lds
    s_add_u32 m0, s51, 101376
    s_movk_i32 s49, 256
    buffer_load_dwordx4 v11, s[4:7], s49 offen  lds
    s_waitcnt vmcnt(13)
    s_barrier
    s_waitcnt vmcnt(10)
    ds_read_b64_tr_b16 v[84:85], v16 offset:0
    ds_read_b64_tr_b16 v[86:87], v16 offset:256
    ds_read_b64_tr_b16 v[88:89], v16 offset:32
    ds_read_b64_tr_b16 v[90:91], v16 offset:288
    s_cmp_lg_u32 s61, 1
    s_cbranch_scc1 K_rr_75
    ds_read_b128 v[20:23], v188 offset:49152
    ds_read_b128 v[24:27], v189 offset:49152
    ds_read_b128 v[28:31], v190 offset:49152
    ds_read_b128 v[32:35], v191 offset:49152
K_rr_75:
    s_add_u32 m0, s52, 104448
    s_add_u32 s50, s50, s48
    buffer_load_dwordx4 v12, s[8:11], s50 offen  lds
    s_add_u32 m0, s52, 105472
    s_nop 0
    buffer_load_dwordx4 v13, s[8:11], s50 offen  lds
    s_waitcnt lgkmcnt(0)
    s_mov_b32 m0, s60
    s_add_u32 s53, s51, 2048
    buffer_load_dwordx4 v4, s[12:15], s53 offen offset:0 lds
    buffer_load_dwordx4 v4, s[12:15], s53 offen offset:1024 lds
    s_add_u32 m0, s51, 0
    s_movk_i32 s49, 384
    buffer_load_dwordx4 v8, s[4:7], s49 offen  lds
    s_add_u32 m0, s52, 0
    s_add_u32 s50, s50, s48
    buffer_load_dwordx4 v12, s[8:11], s50 offen  lds
    s_add_u32 m0, s52, 1024
    s_nop 0
    buffer_load_dwordx4 v13, s[8:11], s50 offen  lds
    s_add_u32 m0, s51, 1024
    s_movk_i32 s49, 384
    buffer_load_dwordx4 v9, s[4:7], s49 offen  lds
    s_add_u32 m0, s52, 2048
    s_add_u32 s50, s50, s48
    buffer_load_dwordx4 v12, s[8:11], s50 offen  lds
    s_add_u32 m0, s52, 3072
    s_nop 0
    buffer_load_dwordx4 v13, s[8:11], s50 offen  lds
    s_add_u32 m0, s51, 2048
    s_movk_i32 s49, 384
    buffer_load_dwordx4 v10, s[4:7], s49 offen  lds
    s_add_u32 m0, s52, 4096
    s_add_u32 s50, s50, s48
    buffer_load_dwordx4 v12, s[8:11], s50 offen  lds
    s_add_u32 m0, s52, 5120
    s_nop 0
    buffer_load_dwordx4 v13, s[8:11], s50 offen  lds
    s_add_u32 m0, s51, 3072
    s_movk_i32 s49, 384
    buffer_load_dwordx4 v11, s[4:7], s49 offen  lds
    s_add_u32 m0, s52, 6144
    s_add_u32 s50, s50, s48
    buffer_load_dwordx4 v12, s[8:11], s50 offen  lds
    s_add_u32 m0, s52, 7168
    s_nop 0
    buffer_load_dwordx4 v13, s[8:11], s50 offen  lds
    s_waitcnt vmcnt(14)
    s_barrier
    s_waitcnt vmcnt(12)
    ds_read_b64_tr_b16 v[92:93], v16 offset:0
    ds_read_b64_tr_b16 v[94:95], v16 offset:256
    ds_read_b64_tr_b16 v[96:97], v16 offset:32
    ds_read_b64_tr_b16 v[98:99], v16 offset:288
    s_cmp_lg_u32 s61, 2
    s_cbranch_scc1 K_rr_76
    v_add_u32 v192, 98304, v188
    ds_read_b128 v[20:23], v192
    v_add_u32 v193, 98304, v189
    ds_read_b128 v[24:27], v193
    v_add_u32 v194, 98304, v190
    ds_read_b128 v[28:31], v194
    v_add_u32 v195, 98304, v191
    ds_read_b128 v[32:35], v195
K_rr_76:
    s_add_u32 m0, s51, 49152
    s_movk_i32 s49, 512
    buffer_load_dwordx4 v8, s[4:7], s49 offen  lds
    s_add_u32 m0, s52, 49152
    s_add_u32 s50, s50, s48
    buffer_load_dwordx4 v12, s[8:11], s50 offen  lds
    s_waitcnt lgkmcnt(0)
    s_mov_b32 m0, s60
    s_add_u32 s53, s51, 32768
    buffer_load_dwordx4 v4, s[12:15], s53 offen offset:0 lds
    buffer_load_dwordx4 v4, s[12:15], s53 offen offset:1024 lds
    s_add_u32 m0, s52, 50176
    s_nop 0
    buffer_load_dwordx4 v13, s[8:11], s50 offen  lds
    s_add_u32 m0, s51, 50176
    s_movk_i32 s49, 512
    buffer_load_dwordx4 v9, s[4:7], s49 offen  lds
    s_add_u32 m0, s52, 51200
    s_add_u32 s50, s50, s48
    buffer_load_dwordx4 v12, s[8:11], s50 offen  lds
    s_add_u32 m0, s52, 52224
    s_nop 0
    buffer_load_dwordx4 v13, s[8:11], s50 offen  lds
    s_add_u32 m0, s51, 51200
    s_movk_i32 s49, 512
    buffer_load_dwordx4 v10, s[4:7], s49 offen  lds
    s_add_u32 m0, s52, 53248
    s_add_u32 s50, s50, s48
    buffer_load_dwordx4 v12, s[8:11], s50 offen  lds
    s_add_u32 m0, s52, 54272
    s_nop 0
    buffer_load_dwordx4 v13, s[8:11], s50 offen  lds
    s_add_u32 m0, s51, 52224
    s_movk_i32 s49, 512
    buffer_load_dwordx4 v11, s[4:7], s49 offen  lds
    s_add_u32 m0, s52, 55296
    s_add_u32 s50, s50, s48
    buffer_load_dwordx4 v12, s[8:11], s50 offen  lds
    s_add_u32 m0, s52, 56320
    s_nop 0
    buffer_load_dwordx4 v13, s[8:11], s50 offen  lds
    s_waitcnt vmcnt(14)
    s_barrier
    s_waitcnt vmcnt(10)
    ds_read_b64_tr_b16 v[116:117], v16 offset:0
    ds_read_b64_tr_b16 v[118:119], v16 offset:256
    ds_read_b64_tr_b16 v[120:121], v16 offset:32
    ds_read_b64_tr_b16 v[122:123], v16 offset:288
    s_cmp_lg_u32 s61, 3
    s_cbranch_scc1 K_rr_77
    ds_read_b128 v[20:23], v188 offset:0
    ds_read_b128 v[24:27], v189 offset:0
    ds_read_b128 v[28:31], v190 offset:0
    ds_read_b128 v[32:35], v191 offset:0
K_rr_77:
    s_add_u32 m0, s51, 98304
    s_movk_i32 s49, 640
    buffer_load_dwordx4 v8, s[4:7], s49 offen  lds
    s_add_u32 m0, s52, 98304
    s_add_u32 s50, s50, s48
    buffer_load_dwordx4 v12, s[8:11], s50 offen  lds
    s_waitcnt lgkmcnt(0)
    s_mov_b32 m0, s60
    s_add_u32 s53, s51, 34816
    buffer_load_dwordx4 v4, s[12:15], s53 offen offset:0 lds
    buffer_load_dwordx4 v4, s[12:15], s53 offen offset:1024 lds
    s_add_u32 m0, s52, 99328
    s_nop 0
    buffer_load_dwordx4 v13, s[8:11], s50 offen  lds
    s_add_u32 m0, s51, 99328
    s_movk_i32 s49, 640
    buffer_load_dwordx4 v9, s[4:7], s49 offen  lds
    s_add_u32 m0, s52, 100352
    s_add_u32 s50, s50, s48
    buffer_load_dwordx4 v12, s[8:11], s50 offen  lds
    s_add_u32 m0, s52, 101376
    s_nop 0
    buffer_load_dwordx4 v13, s[8:11], s50 offen  lds
    s_add_u32 m0, s51, 100352
    s_movk_i32 s49, 640
    buffer_load_dwordx4 v10, s[4:7], s49 offen  lds
    s_add_u32 m0, s52, 102400
    s_add_u32 s50, s50, s48
    buffer_load_dwordx4 v12, s[8:11], s50 offen  lds
    s_add_u32 m0, s52, 103424
    s_nop 0
    buffer_load_dwordx4 v13, s[8:11], s50 offen  lds
    s_add_u32 m0, s51, 101376
    s_movk_i32 s49, 640
    buffer_load_dwordx4 v11, s[4:7], s49 offen  lds
    s_add_u32 m0, s52, 104448
    s_add_u32 s50, s50, s48
    buffer_load_dwordx4 v12, s[8:11], s50 offen  lds
    s_add_u32 m0, s52, 105472
    s_nop 0
    buffer_load_dwordx4 v13, s[8:11], s50 offen  lds
    s_waitcnt vmcnt(14)
    s_barrier
    s_waitcnt vmcnt(10)
    ds_read_b64_tr_b16 v[124:125], v16 offset:0
    ds_read_b64_tr_b16 v[126:127], v16 offset:256
    ds_read_b64_tr_b16 v[128:129], v16 offset:32
    ds_read_b64_tr_b16 v[130:131], v16 offset:288
    s_cmp_lg_u32 s61, 0
    s_cbranch_scc1 K_rr_78
    ds_read_b128 v[36:39], v188 offset:49152
    ds_read_b128 v[40:43], v189 offset:49152
    ds_read_b128 v[44:47], v190 offset:49152
    ds_read_b128 v[48:51], v191 offset:49152
K_rr_78:
    s_add_u32 m0, s51, 0
    s_movk_i32 s49, 768
    buffer_load_dwordx4 v8, s[4:7], s49 offen  lds
    s_add_u32 m0, s52, 0
    s_add_u32 s50, s50, s48
    buffer_load_dwordx4 v12, s[8:11], s50 offen  lds
    s_waitcnt lgkmcnt(0)
    s_mov_b32 m0, s60
    s_add_u32 s53, s51, 16384
    buffer_load_dwordx4 v4, s[12:15], s53 offen offset:0 lds
    buffer_load_dwordx4 v4, s[12:15], s53 offen offset:1024 lds
    s_add_u32 m0, s60, 2048
    s_mov_b32 s49, 1024
    buffer_load_dwordx4 v14, s[4:7], s49 offen lds
    s_add_u32 m0, s60, 3072
    s_nop 0
    buffer_load_dwordx4 v19, s[4:7], s49 offen lds
    v_mov_b32_dpp v172, v184 row_newbcast:0 row_mask:0xf bank_mask:0xf
    v_mov_b32_dpp v173, v185 row_newbcast:0 row_mask:0xf bank_mask:0xf
    v_mov_b32_dpp v174, v186 row_newbcast:0 row_mask:0xf bank_mask:0xf
    v_mov_b32_dpp v175, v187 row_newbcast:0 row_mask:0xf bank_mask:0xf
    v_mov_b32_dpp v176, v184 row_newbcast:1 row_mask:0xf bank_mask:0xf
    v_mov_b32_dpp v177, v185 row_newbcast:1 row_mask:0xf bank_mask:0xf
    v_mov_b32_dpp v178, v186 row_newbcast:1 row_mask:0xf bank_mask:0xf
    v_mov_b32_dpp v179, v187 row_newbcast:1 row_mask:0xf bank_mask:0xf
    s_bitcmp1_b32 s37, 3
    s_cbranch_scc1 K_sv_79
    v_mfma_f32_16x16x32_bf16 v[148:151], v[84:87], v[20:23], v[148:151]
    v_mfma_f32_16x16x32_bf16 v[152:155], v[88:91], v[20:23], v[152:155]
    v_mfma_f32_16x16x32_bf16 v[160:163], v[84:87], v[24:27], v[160:163]
    v_mfma_f32_16x16x32_bf16 v[164:167], v[88:91], v[24:27], v[164:167]
    v_mfma_f32_16x16x32_bf16 v[156:159], v[172:175], v[20:23], v[156:159]
    v_mfma_f32_16x16x32_bf16 v[148:151], v[92:95], v[28:31], v[148:151]
    v_mfma_f32_16x16x32_bf16 v[152:155], v[96:99], v[28:31], v[152:155]
    v_mfma_f32_16x16x32_bf16 v[160:163], v[92:95], v[32:35], v[160:163]
    v_mfma_f32_16x16x32_bf16 v[164:167], v[96:99], v[32:35], v[164:167]
    v_mfma_f32_16x16x32_bf16 v[156:159], v[176:179], v[28:31], v[156:159]
    s_branch K_se_80
K_sv_79:
    v_mfma_f32_16x16x32_bf16 v[148:151], v[20:23], v[84:87], v[148:151]
    v_mfma_f32_16x16x32_bf16 v[152:155], v[20:23], v[88:91], v[152:155]
    v_mfma_f32_16x16x32_bf16 v[160:163], v[24:27], v[84:87], v[160:163]
    v_mfma_f32_16x16x32_bf16 v[164:167], v[24:27], v[88:91], v[164:167]
    v_mfma_f32_16x16x32_bf16 v[168:171], v[172:175], v[24:27], v[168:171]
    v_mfma_f32_16x16x32_bf16 v[148:151], v[28:31], v[92:95], v[148:151]
    v_mfma_f32_16x16x32_bf16 v[152:155], v[28:31], v[96:99], v[152:155]
    v_mfma_f32_16x16x32_bf16 v[160:163], v[32:35], v[92:95], v[160:163]
    v_mfma_f32_16x16x32_bf16 v[164:167], v[32:35], v[96:99], v[164:167]
    v_mfma_f32_16x16x32_bf16 v[168:171], v[176:179], v[32:35], v[168:171]
K_se_80:
    s_add_u32 m0, s52, 1024
    s_nop 0
    buffer_load_dwordx4 v13, s[8:11], s50 offen  lds
    s_add_u32 m0, s51, 1024
    s_movk_i32 s49, 768
    buffer_load_dwordx4 v9, s[4:7], s49 offen  lds
    s_add_u32 m0, s52, 2048
    s_add_u32 s50, s50, s48
    buffer_load_dwordx4 v12, s[8:11], s50 offen  lds
    s_add_u32 m0, s52, 3072
    s_nop 0
    buffer_load_dwordx4 v13, s[8:11], s50 offen  lds
    s_add_u32 m0, s51, 2048
    s_movk_i32 s49, 768
    buffer_load_dwordx4 v10, s[4:7], s49 offen  lds
    s_add_u32 m0, s52, 4096
    s_add_u32 s50, s50, s48
    buffer_load_dwordx4 v12, s[8:11], s50 offen  lds
    s_add_u32 m0, s52, 5120
    s_nop 0
    buffer_load_dwordx4 v13, s[8:11], s50 offen  lds
    s_add_u32 m0, s51, 3072
    s_movk_i32 s49, 768
    buffer_load_dwordx4 v11, s[4:7], s49 offen  lds
    s_add_u32 m0, s52, 6144
    s_add_u32 s50, s50, s48
    buffer_load_dwordx4 v12, s[8:11], s50 offen  lds
    s_add_u32 m0, s52, 7168
    s_nop 0
    buffer_load_dwordx4 v13, s[8:11], s50 offen  lds
    s_mul_i32 s40, s62, 512
    s_mov_b64 exec, 0xffff
    buffer_load_dword v255, v17, s[8:11], s40 offen
    s_mov_b64 exec, -1
    s_waitcnt vmcnt(17)
    s_barrier
    s_waitcnt vmcnt(11)
    ds_read_b64_tr_b16 v[100:101], v16 offset:0
    ds_read_b64_tr_b16 v[102:103], v16 offset:256
    ds_read_b64_tr_b16 v[104:105], v16 offset:32
    ds_read_b64_tr_b16 v[106:107], v16 offset:288
    ds_read_b128 v[52:55], v180
    ds_read_b128 v[60:63], v181
    s_cmp_lg_u32 s61, 1
    s_cbranch_scc1 K_rr_81
    v_add_u32 v192, 98304, v188
    ds_read_b128 v[36:39], v192
    v_add_u32 v193, 98304, v189
    ds_read_b128 v[40:43], v193
    v_add_u32 v194, 98304, v190
    ds_read_b128 v[44:47], v194
    v_add_u32 v195, 98304, v191
    ds_read_b128 v[48:51], v195
K_rr_81:
    s_add_u32 m0, s51, 49152
    s_movk_i32 s49, 896
    buffer_load_dwordx4 v8, s[4:7], s49 offen  lds
    s_add_u32 m0, s52, 49152
    s_add_u32 s50, s50, s48
    buffer_load_dwordx4 v12, s[8:11], s50 offen  lds
    s_waitcnt lgkmcnt(0)
    s_mov_b32 m0, s60
    s_add_u32 s53, s51, 18432
    buffer_load_dwordx4 v4, s[12:15], s53 offen offset:0 lds
    buffer_load_dwordx4 v4, s[12:15], s53 offen offset:1024 lds
    s_add_u32 m0, s60, 2048
    s_mov_b32 s49, 33792
    buffer_load_dwordx4 v14, s[4:7], s49 offen lds
    s_add_u32 m0, s60, 3072
    s_nop 0
    buffer_load_dwordx4 v19, s[4:7], s49 offen lds
    s_add_u32 m0, s52, 50176
    s_nop 0
    buffer_load_dwordx4 v13, s[8:11], s50 offen  lds
    s_add_u32 m0, s51, 50176
    s_movk_i32 s49, 896
    buffer_load_dwordx4 v9, s[4:7], s49 offen  lds
    s_add_u32 m0, s52, 51200
    s_add_u32 s50, s50, s48
    buffer_load_dwordx4 v12, s[8:11], s50 offen  lds
    s_add_u32 m0, s52, 52224
    s_nop 0
    buffer_load_dwordx4 v13, s[8:11], s50 offen  lds
    s_add_u32 m0, s51, 51200
    s_movk_i32 s49, 896
    buffer_load_dwordx4 v10, s[4:7], s49 offen  lds
    s_add_u32 m0, s52, 53248
    s_add_u32 s50, s50, s48
    buffer_load_dwordx4 v12, s[8:11], s50 offen  lds
    s_add_u32 m0, s52, 54272
    s_nop 0
    buffer_load_dwordx4 v13, s[8:11], s50 offen  lds
    s_add_u32 m0, s51, 52224
    s_movk_i32 s49, 896
    buffer_load_dwordx4 v11, s[4:7], s49 offen  lds
    s_add_u32 m0, s52, 55296
    s_add_u32 s50, s50, s48
    buffer_load_dwordx4 v12, s[8:11], s50 offen  lds
    s_add_u32 m0, s52, 56320
    s_nop 0
    buffer_load_dwordx4 v13, s[8:11], s50 offen  lds
    s_waitcnt vmcnt(17)
    s_barrier
    s_waitcnt vmcnt(10)
    ds_read_b64_tr_b16 v[108:109], v16 offset:0
    ds_read_b64_tr_b16 v[110:111], v16 offset:256
    ds_read_b64_tr_b16 v[112:113], v16 offset:32
    ds_read_b64_tr_b16 v[114:115], v16 offset:288
    ds_read_b128 v[56:59], v180
    ds_read_b128 v[64:67], v181
    s_cmp_lg_u32 s61, 2
    s_cbranch_scc1 K_rr_82
    ds_read_b128 v[36:39], v188 offset:0
    ds_read_b128 v[40:43], v189 offset:0
    ds_read_b128 v[44:47], v190 offset:0
    ds_read_b128 v[48:51], v191 offset:0
K_rr_82:
    s_add_u32 m0, s51, 98304
    s_movk_i32 s49, 1024
    buffer_load_dwordx4 v8, s[4:7], s49 offen  lds
    s_add_u32 m0, s52, 98304
    s_add_u32 s50, s50, s48
    buffer_load_dwordx4 v12, s[8:11], s50 offen  lds
    s_waitcnt lgkmcnt(0)
    s_mov_b32 m0, s60
    s_add_u32 s53, s51, 49152
    buffer_load_dwordx4 v4, s[12:15], s53 offen offset:0 lds
    buffer_load_dwordx4 v4, s[12:15], s53 offen offset:1024 lds
    s_add_u32 m0, s60, 2048
    s_mov_b32 s49, 1536
    buffer_load_dwordx4 v14, s[4:7], s49 offen lds
    s_add_u32 m0, s60, 3072
    s_nop 0
    buffer_load_dwordx4 v19, s[4:7], s49 offen lds
    v_mov_b32_dpp v172, v184 row_newbcast:4 row_mask:0xf bank_mask:0xf
    v_mov_b32_dpp v173, v185 row_newbcast:4 row_mask:0xf bank_mask:0xf
    v_mov_b32_dpp v174, v186 row_newbcast:4 row_mask:0xf bank_mask:0xf
    v_mov_b32_dpp v175, v187 row_newbcast:4 row_mask:0xf bank_mask:0xf
    v_mov_b32_dpp v176, v184 row_newbcast:5 row_mask:0xf bank_mask:0xf
    v_mov_b32_dpp v177, v185 row_newbcast:5 row_mask:0xf bank_mask:0xf
    v_mov_b32_dpp v178, v186 row_newbcast:5 row_mask:0xf bank_mask:0xf
    v_mov_b32_dpp v179, v187 row_newbcast:5 row_mask:0xf bank_mask:0xf
    s_bitcmp1_b32 s37, 3
    s_cbranch_scc1 K_sv_83
    v_mfma_f32_16x16x32_bf16 v[148:151], v[116:119], v[52:55], v[148:151]
    v_mfma_f32_16x16x32_bf16 v[152:155], v[120:123], v[52:55], v[152:155]
    v_mfma_f32_16x16x32_bf16 v[160:163], v[116:119], v[56:59], v[160:163]
    v_mfma_f32_16x16x32_bf16 v[164:167], v[120:123], v[56:59], v[164:167]
    v_mfma_f32_16x16x32_bf16 v[156:159], v[172:175], v[52:55], v[156:159]
    v_mfma_f32_16x16x32_bf16 v[148:151], v[124:127], v[60:63], v[148:151]
    v_mfma_f32_16x16x32_bf16 v[152:155], v[128:131], v[60:63], v[152:155]
    v_mfma_f32_16x16x32_bf16 v[160:163], v[124:127], v[64:67], v[160:163]
    v_mfma_f32_16x16x32_bf16 v[164:167], v[128:131], v[64:67], v[164:167]
    v_mfma_f32_16x16x32_bf16 v[156:159], v[176:179], v[60:63], v[156:159]
    s_branch K_se_84
K_sv_83:
    v_mfma_f32_16x16x32_bf16 v[148:151], v[52:55], v[116:119], v[148:151]
    v_mfma_f32_16x16x32_bf16 v[152:155], v[52:55], v[120:123], v[152:155]
    v_mfma_f32_16x16x32_bf16 v[160:163], v[56:59], v[116:119], v[160:163]
    v_mfma_f32_16x16x32_bf16 v[164:167], v[56:59], v[120:123], v[164:167]
    v_mfma_f32_16x16x32_bf16 v[168:171], v[172:175], v[56:59], v[168:171]
    v_mfma_f32_16x16x32_bf16 v[148:151], v[60:63], v[124:127], v[148:151]
    v_mfma_f32_16x16x32_bf16 v[152:155], v[60:63], v[128:131], v[152:155]
    v_mfma_f32_16x16x32_bf16 v[160:163], v[64:67], v[124:127], v[160:163]
    v_mfma_f32_16x16x32_bf16 v[164:167], v[64:67], v[128:131], v[164:167]
    v_mfma_f32_16x16x32_bf16 v[168:171], v[176:179], v[64:67], v[168:171]
K_se_84:
    s_add_u32 m0, s52, 99328
    s_nop 0
    buffer_load_dwordx4 v13, s[8:11], s50 offen  lds
    s_add_u32 m0, s51, 99328
    s_movk_i32 s49, 1024
    buffer_load_dwordx4 v9, s[4:7], s49 offen  lds
    s_add_u32 m0, s52, 100352
    s_add_u32 s50, s50, s48
    buffer_load_dwordx4 v12, s[8:11], s50 offen  lds
    s_add_u32 m0, s52, 101376
    s_nop 0
    buffer_load_dwordx4 v13, s[8:11], s50 offen  lds
    s_add_u32 m0, s51, 100352
    s_movk_i32 s49, 1024
    buffer_load_dwordx4 v10, s[4:7], s49 offen  lds
    s_add_u32 m0, s52, 102400
    s_add_u32 s50, s50, s48
    buffer_load_dwordx4 v12, s[8:11], s50 offen  lds
    s_add_u32 m0, s52, 103424
    s_nop 0
    buffer_load_dwordx4 v13, s[8:11], s50 offen  lds
    s_add_u32 m0, s51, 101376
    s_movk_i32 s49, 1024
    buffer_load_dwordx4 v11, s[4:7], s49 offen  lds
    s_add_u32 m0, s52, 104448
    s_add_u32 s50, s50, s48
    buffer_load_dwordx4 v12, s[8:11], s50 offen  lds
    s_add_u32 m0, s52, 105472
    s_nop 0
    buffer_load_dwordx4 v13, s[8:11], s50 offen  lds
    s_waitcnt vmcnt(16)
    s_barrier
    s_waitcnt vmcnt(10)
    ds_read_b64_tr_b16 v[132:133], v16 offset:0
    ds_read_b64_tr_b16 v[134:135], v16 offset:256
    ds_read_b64_tr_b16 v[136:137], v16 offset:32
    ds_read_b64_tr_b16 v[138:139], v16 offset:288
    ds_read_b128 v[68:71], v180
    ds_read_b128 v[76:79], v181
    s_cmp_lg_u32 s61, 3
    s_cbranch_scc1 K_rr_85
    ds_read_b128 v[36:39], v188 offset:49152
    ds_read_b128 v[40:43], v189 offset:49152
    ds_read_b128 v[44:47], v190 offset:49152
    ds_read_b128 v[48:51], v191 offset:49152
K_rr_85:
    s_add_u32 m0, s51, 0
    s_movk_i32 s49, 1152
    buffer_load_dwordx4 v8, s[4:7], s49 offen  lds
    s_add_u32 m0, s52, 0
    s_add_u32 s50, s50, s48
    buffer_load_dwordx4 v12, s[8:11], s50 offen  lds
    s_waitcnt lgkmcnt(0)
    s_mov_b32 m0, s60
    s_add_u32 s53, s51, 51200
    buffer_load_dwordx4 v4, s[12:15], s53 offen offset:0 lds
    buffer_load_dwordx4 v4, s[12:15], s53 offen offset:1024 lds
    s_add_u32 m0, s60, 2048
    s_mov_b32 s49, 34304
    buffer_load_dwordx4 v14, s[4:7], s49 offen lds
    s_add_u32 m0, s60, 3072
    s_nop 0
    buffer_load_dwordx4 v19, s[4:7], s49 offen lds
    s_add_u32 m0, s52, 1024
    s_nop 0
    buffer_load_dwordx4 v13, s[8:11], s50 offen  lds
    s_add_u32 m0, s51, 1024
    s_movk_i32 s49, 1152
    buffer_load_dwordx4 v9, s[4:7], s49 offen  lds
    s_add_u32 m0, s52, 2048
    s_add_u32 s50, s50, s48
    buffer_load_dwordx4 v12, s[8:11], s50 offen  lds
    s_add_u32 m0, s52, 3072
    s_nop 0
    buffer_load_dwordx4 v13, s[8:11], s50 offen  lds
    s_add_u32 m0, s51, 2048
    s_movk_i32 s49, 1152
    buffer_load_dwordx4 v10, s[4:7], s49 offen  lds
    s_add_u32 m0, s52, 4096
    s_add_u32 s50, s50, s48
    buffer_load_dwordx4 v12, s[8:11], s50 offen  lds
    s_add_u32 m0, s52, 5120
    s_nop 0
    buffer_load_dwordx4 v13, s[8:11], s50 offen  lds
    s_add_u32 m0, s51, 3072
    s_movk_i32 s49, 1152
    buffer_load_dwordx4 v11, s[4:7], s49 offen  lds
    s_add_u32 m0, s52, 6144
    s_add_u32 s50, s50, s48
    buffer_load_dwordx4 v12, s[8:11], s50 offen  lds
    s_add_u32 m0, s52, 7168
    s_nop 0
    buffer_load_dwordx4 v13, s[8:11], s50 offen  lds
    s_waitcnt vmcnt(16)
    s_barrier
    s_waitcnt vmcnt(10)
    ds_read_b64_tr_b16 v[140:141], v16 offset:0
    ds_read_b64_tr_b16 v[142:143], v16 offset:256
    ds_read_b64_tr_b16 v[144:145], v16 offset:32
    ds_read_b64_tr_b16 v[146:147], v16 offset:288
    ds_read_b128 v[72:75], v180
    ds_read_b128 v[80:83], v181
    s_add_u32 m0, s51, 49152
    s_movk_i32 s49, 1280
    buffer_load_dwordx4 v8, s[4:7], s49 offen  lds
    s_add_u32 m0, s52, 49152
    s_add_u32 s50, s50, s48
    buffer_load_dwordx4 v12, s[8:11], s50 offen  lds
    s_waitcnt lgkmcnt(0)
    v_mov_b32_dpp v172, v184 row_newbcast:2 row_mask:0xf bank_mask:0xf
    v_mov_b32_dpp v173, v185 row_newbcast:2 row_mask:0xf bank_mask:0xf
    v_mov_b32_dpp v174, v186 row_newbcast:2 row_mask:0xf bank_mask:0xf
    v_mov_b32_dpp v175, v187 row_newbcast:2 row_mask:0xf bank_mask:0xf
    v_mov_b32_dpp v176, v184 row_newbcast:3 row_mask:0xf bank_mask:0xf
    v_mov_b32_dpp v177, v185 row_newbcast:3 row_mask:0xf bank_mask:0xf
    v_mov_b32_dpp v178, v186 row_newbcast:3 row_mask:0xf bank_mask:0xf
    v_mov_b32_dpp v179, v187 row_newbcast:3 row_mask:0xf bank_mask:0xf
    s_bitcmp1_b32 s37, 3
    s_cbranch_scc1 K_sv_86
    v_mfma_f32_16x16x32_bf16 v[148:151], v[100:103], v[36:39], v[148:151]
    v_mfma_f32_16x16x32_bf16 v[152:155], v[104:107], v[36:39], v[152:155]
    v_mfma_f32_16x16x32_bf16 v[160:163], v[100:103], v[40:43], v[160:163]
    v_mfma_f32_16x16x32_bf16 v[164:167], v[104:107], v[40:43], v[164:167]
    v_mfma_f32_16x16x32_bf16 v[156:159], v[172:175], v[36:39], v[156:159]
    v_mfma_f32_16x16x32_bf16 v[148:151], v[108:111], v[44:47], v[148:151]
    v_mfma_f32_16x16x32_bf16 v[152:155], v[112:115], v[44:47], v[152:155]
    v_mfma_f32_16x16x32_bf16 v[160:163], v[108:111], v[48:51], v[160:163]
    v_mfma_f32_16x16x32_bf16 v[164:167], v[112:115], v[48:51], v[164:167]
    v_mfma_f32_16x16x32_bf16 v[156:159], v[176:179], v[44:47], v[156:159]
    s_branch K_se_87
K_sv_86:
    v_mfma_f32_16x16x32_bf16 v[148:151], v[36:39], v[100:103], v[148:151]
    v_mfma_f32_16x16x32_bf16 v[152:155], v[36:39], v[104:107], v[152:155]
    v_mfma_f32_16x16x32_bf16 v[160:163], v[40:43], v[100:103], v[160:163]
    v_mfma_f32_16x16x32_bf16 v[164:167], v[40:43], v[104:107], v[164:167]
    v_mfma_f32_16x16x32_bf16 v[168:171], v[172:175], v[40:43], v[168:171]
    v_mfma_f32_16x16x32_bf16 v[148:151], v[44:47], v[108:111], v[148:151]
    v_mfma_f32_16x16x32_bf16 v[152:155], v[44:47], v[112:115], v[152:155]
    v_mfma_f32_16x16x32_bf16 v[160:163], v[48:51], v[108:111], v[160:163]
    v_mfma_f32_16x16x32_bf16 v[164:167], v[48:51], v[112:115], v[164:167]
    v_mfma_f32_16x16x32_bf16 v[168:171], v[176:179], v[48:51], v[168:171]
K_se_87:
    s_add_u32 m0, s52, 50176
    s_nop 0
    buffer_load_dwordx4 v13, s[8:11], s50 offen  lds
    s_add_u32 m0, s51, 50176
    s_movk_i32 s49, 1280
    buffer_load_dwordx4 v9, s[4:7], s49 offen  lds
    s_add_u32 m0, s52, 51200
    s_add_u32 s50, s50, s48
    buffer_load_dwordx4 v12, s[8:11], s50 offen  lds
    v_mov_b32_dpp v172, v184 row_newbcast:6 row_mask:0xf bank_mask:0xf
    v_mov_b32_dpp v173, v185 row_newbcast:6 row_mask:0xf bank_mask:0xf
    v_mov_b32_dpp v174, v186 row_newbcast:6 row_mask:0xf bank_mask:0xf
    v_mov_b32_dpp v175, v187 row_newbcast:6 row_mask:0xf bank_mask:0xf
    v_mov_b32_dpp v176, v184 row_newbcast:7 row_mask:0xf bank_mask:0xf
    v_mov_b32_dpp v177, v185 row_newbcast:7 row_mask:0xf bank_mask:0xf
    v_mov_b32_dpp v178, v186 row_newbcast:7 row_mask:0xf bank_mask:0xf
    v_mov_b32_dpp v179, v187 row_newbcast:7 row_mask:0xf bank_mask:0xf
    s_bitcmp1_b32 s37, 3
    s_cbranch_scc1 K_sv_88
    v_mfma_f32_16x16x32_bf16 v[148:151], v[132:135], v[68:71], v[148:151]
    v_mfma_f32_16x16x32_bf16 v[152:155], v[136:139], v[68:71], v[152:155]
    v_mfma_f32_16x16x32_bf16 v[160:163], v[132:135], v[72:75], v[160:163]
    v_mfma_f32_16x16x32_bf16 v[164:167], v[136:139], v[72:75], v[164:167]
    v_mfma_f32_16x16x32_bf16 v[156:159], v[172:175], v[68:71], v[156:159]
    v_mfma_f32_16x16x32_bf16 v[148:151], v[140:143], v[76:79], v[148:151]
    v_mfma_f32_16x16x32_bf16 v[152:155], v[144:147], v[76:79], v[152:155]
    v_mfma_f32_16x16x32_bf16 v[160:163], v[140:143], v[80:83], v[160:163]
    v_mfma_f32_16x16x32_bf16 v[164:167], v[144:147], v[80:83], v[164:167]
    v_mfma_f32_16x16x32_bf16 v[156:159], v[176:179], v[76:79], v[156:159]
    s_branch K_se_89
K_sv_88:
    v_mfma_f32_16x16x32_bf16 v[148:151], v[68:71], v[132:135], v[148:151]
    v_mfma_f32_16x16x32_bf16 v[152:155], v[68:71], v[136:139], v[152:155]
    v_mfma_f32_16x16x32_bf16 v[160:163], v[72:75], v[132:135], v[160:163]
    v_mfma_f32_16x16x32_bf16 v[164:167], v[72:75], v[136:139], v[164:167]
    v_mfma_f32_16x16x32_bf16 v[168:171], v[172:175], v[72:75], v[168:171]
    v_mfma_f32_16x16x32_bf16 v[148:151], v[76:79], v[140:143], v[148:151]
    v_mfma_f32_16x16x32_bf16 v[152:155], v[76:79], v[144:147], v[152:155]
    v_mfma_f32_16x16x32_bf16 v[160:163], v[80:83], v[140:143], v[160:163]
    v_mfma_f32_16x16x32_bf16 v[164:167], v[80:83], v[144:147], v[164:167]
    v_mfma_f32_16x16x32_bf16 v[168:171], v[176:179], v[80:83], v[168:171]
K_se_89:
    s_add_u32 m0, s52, 52224
    s_nop 0
    buffer_load_dwordx4 v13, s[8:11], s50 offen  lds
    s_add_u32 m0, s51, 51200
    s_movk_i32 s49, 1280
    buffer_load_dwordx4 v10, s[4:7], s49 offen  lds
    s_add_u32 m0, s52, 53248
    s_add_u32 s50, s50, s48
    buffer_load_dwordx4 v12, s[8:11], s50 offen  lds
    s_add_u32 m0, s52, 54272
    s_nop 0
    buffer_load_dwordx4 v13, s[8:11], s50 offen  lds
    s_add_u32 m0, s51, 52224
    s_movk_i32 s49, 1280
    buffer_load_dwordx4 v11, s[4:7], s49 offen  lds
    s_add_u32 m0, s52, 55296
    s_add_u32 s50, s50, s48
    buffer_load_dwordx4 v12, s[8:11], s50 offen  lds
    s_add_u32 m0, s52, 56320
    s_nop 0
    buffer_load_dwordx4 v13, s[8:11], s50 offen  lds
    s_mul_i32 s40, s62, 768
    s_mov_b64 exec, 0
    s_mov_b32 exec_lo, -1
    s_mov_b32 exec_hi, 0x0
    buffer_load_dword v255, v17, s[8:11], s40 offen
    s_mov_b64 exec, -1
    s_waitcnt vmcnt(13)
    s_barrier
    s_cmp_eq_u32 s61, 0
    s_cbranch_scc1 K_pw_90
    ds_write_b128 v196, v[148:151] offset:0
    ds_write_b128 v196, v[152:155] offset:1024
    ds_write_b32 v197, v156 offset:2048
K_pw_90:
    s_cmp_eq_u32 s61, 1
    s_cbranch_scc1 K_pw_91
    ds_write_b128 v196, v[160:163] offset:6912
    ds_write_b128 v196, v[164:167] offset:7936
    ds_write_b32 v197, v168 offset:8960
K_pw_91:
    s_add_u32 m0, s51, 98304
    s_movk_i32 s49, 1408
    buffer_load_dwordx4 v8, s[4:7], s49 offen  lds
    s_add_u32 m0, s52, 98304
    s_add_u32 s50, s50, s48
    buffer_load_dwordx4 v12, s[8:11], s50 offen  lds
    s_add_u32 m0, s52, 99328
    s_nop 0
    buffer_load_dwordx4 v13, s[8:11], s50 offen  lds
    s_add_u32 m0, s51, 99328
    s_movk_i32 s49, 1408
    buffer_load_dwordx4 v9, s[4:7], s49 offen  lds
    s_add_u32 m0, s52, 100352
    s_add_u32 s50, s50, s48
    buffer_load_dwordx4 v12, s[8:11], s50 offen  lds
    s_add_u32 m0, s52, 101376
    s_nop 0
    buffer_load_dwordx4 v13, s[8:11], s50 offen  lds
    s_add_u32 m0, s51, 100352
    s_movk_i32 s49, 1408
    buffer_load_dwordx4 v10, s[4:7], s49 offen  lds
    s_add_u32 m0, s52, 102400
    s_add_u32 s50, s50, s48
    buffer_load_dwordx4 v12, s[8:11], s50 offen  lds
    s_add_u32 m0, s52, 103424
    s_nop 0
    buffer_load_dwordx4 v13, s[8:11], s50 offen  lds
    s_add_u32 m0, s51, 101376
    s_movk_i32 s49, 1408
    buffer_load_dwordx4 v11, s[4:7], s49 offen  lds
    s_add_u32 m0, s52, 104448
    s_add_u32 s50, s50, s48
    buffer_load_dwordx4 v12, s[8:11], s50 offen  lds
    s_add_u32 m0, s52, 105472
    s_nop 0
    buffer_load_dwordx4 v13, s[8:11], s50 offen  lds
    s_waitcnt lgkmcnt(0)
    s_waitcnt vmcnt(13)
    s_barrier
    ds_read_b128 v[20:23], v198 offset:0
    ds_read_b128 v[24:27], v198 offset:1024
    ds_read_b32 v28, v199 offset:2048
    ds_read_b128 v[32:35], v198 offset:2304
    ds_read_b128 v[36:39], v198 offset:3328
    ds_read_b32 v40, v199 offset:4352
    ds_read_b128 v[44:47], v198 offset:4608
    ds_read_b128 v[48:51], v198 offset:5632
    ds_read_b32 v52, v199 offset:6656
    s_add_u32 m0, s51, 0
    s_movk_i32 s49, 1536
    buffer_load_dwordx4 v8, s[4:7], s49 offen  lds
    s_add_u32 m0, s52, 0
    s_add_u32 s50, s50, s48
    buffer_load_dwordx4 v12, s[8:11], s50 offen  lds
    s_cmp_gt_u32 s61, 1
    s_cbranch_scc1 K_pe_93
    s_cmp_eq_u32 s61, 0
    s_cbranch_scc1 K_p0_94
    v_mov_b32 v148, v160
    v_mov_b32 v149, v161
    v_mov_b32 v150, v162
    v_mov_b32 v151, v163
    v_mov_b32 v152, v164
    v_mov_b32 v153, v165
    v_mov_b32 v154, v166
    v_mov_b32 v155, v167
    v_mov_b32 v156, v168
K_p0_94:
    s_and_b32 s40, s37, 3
    s_lshl2_add_u32 s40, s36, s40
    s_lshl_b32 s41, s40, 12
    s_add_u32 s41, s41, 16777216
    s_lshl1_add_u32 s40, s40, s61
    s_waitcnt lgkmcnt(0)
    v_add_f32 v148, v148, v20
    v_add_f32 v149, v149, v21
    v_add_f32 v150, v150, v22
    v_add_f32 v151, v151, v23
    v_add_f32 v152, v152, v24
    v_add_f32 v153, v153, v25
    v_add_f32 v154, v154, v26
    v_add_f32 v155, v155, v27
    v_add_f32 v156, v156, v28
    v_add_f32 v148, v148, v32
    v_add_f32 v149, v149, v33
    v_add_f32 v150, v150, v34
    v_add_f32 v151, v151, v35
    v_add_f32 v152, v152, v36
    v_add_f32 v153, v153, v37
    v_add_f32 v154, v154, v38
    v_add_f32 v155, v155, v39
    v_add_f32 v156, v156, v40
    v_add_f32 v148, v148, v44
    v_add_f32 v149, v149, v45
    v_add_f32 v150, v150, v46
    v_add_f32 v151, v151, v47
    v_add_f32 v152, v152, v48
    v_add_f32 v153, v153, v49
    v_add_f32 v154, v154, v50
    v_add_f32 v155, v155, v51
    v_add_f32 v156, v156, v52
    s_lshr_b32 s42, s37, 3
    s_cmp_lg_u32 s42, s61
    s_cbranch_scc1 K_pg_95
    v_mul_f32 v156, 0xbfb8aa3b, v156
    v_exp_f32 v156, v156
    s_lshl_b32 s40, s40, 6
    v_add_f32 v156, 1.0, v156
    v_rcp_f32 v156, v156
    s_add_u32 s40, s40, 17039360
    s_mov_b64 exec, 0xffff
    buffer_store_dword v156, v243, s[20:23], s40 offen sc1
    s_mov_b64 exec, -1
K_pg_95:
    s_bitcmp1_b32 s37, 3
    s_cbranch_scc1 K_pv_92
    v_mul_f32 v148, 0x3e8293ee, v148
    v_mul_f32 v149, 0x3e8293ee, v149
    v_mul_f32 v150, 0x3e8293ee, v150
    v_mul_f32 v151, 0x3e8293ee, v151
    v_mul_f32 v152, 0x3e8293ee, v152
    v_mul_f32 v153, 0x3e8293ee, v153
    v_mul_f32 v154, 0x3e8293ee, v154
    v_mul_f32 v155, 0x3e8293ee, v155
    v_cvt_pk_bf16_f32 v172, v148, v149
    v_cvt_pk_bf16_f32 v173, v150, v151
    v_cvt_pk_bf16_f32 v174, v152, v153
    v_cvt_pk_bf16_f32 v175, v154, v155
    v_lshlrev_b32 v5, 9, v3
    v_lshl_add_u32 v5, v2, 4, v5
    s_lshl_b32 s42, s61, 8
    s_add_u32 s41, s41, s42
    buffer_store_dwordx4 v[172:175], v5, s[20:23], s41 offen sc1
    s_branch K_pe_93
K_pv_92:
    v_cvt_pk_bf16_f32 v172, v148, v149
    v_cvt_pk_bf16_f32 v173, v150, v151
    v_cvt_pk_bf16_f32 v174, v152, v153
    v_cvt_pk_bf16_f32 v175, v154, v155
    v_lshrrev_b32 v5, 1, v3
    v_lshlrev_b32 v5, 9, v5
    v_lshl_add_u32 v5, v2, 4, v5
    v_and_b32 v6, 1, v3
    v_lshl_add_u32 v5, v6, 3, v5
    s_lshl_b32 s42, s61, 10
    s_add_u32 s41, s41, s42
    buffer_store_dwordx2 v[172:173], v5, s[20:23], s41 offen offset:2048 sc1
    buffer_store_dwordx2 v[174:175], v5, s[20:23], s41 offen offset:2304 sc1
K_pe_93:
    s_add_u32 m0, s52, 1024
    s_nop 0
    buffer_load_dwordx4 v13, s[8:11], s50 offen  lds
    s_add_u32 m0, s51, 1024
    s_movk_i32 s49, 1536
    buffer_load_dwordx4 v9, s[4:7], s49 offen  lds
    s_add_u32 m0, s52, 2048
    s_add_u32 s50, s50, s48
    buffer_load_dwordx4 v12, s[8:11], s50 offen  lds
    s_add_u32 m0, s52, 3072
    s_nop 0
    buffer_load_dwordx4 v13, s[8:11], s50 offen  lds
    s_add_u32 m0, s51, 2048
    s_movk_i32 s49, 1536
    buffer_load_dwordx4 v10, s[4:7], s49 offen  lds
    s_add_u32 m0, s52, 4096
    s_add_u32 s50, s50, s48
    buffer_load_dwordx4 v12, s[8:11], s50 offen  lds
    s_add_u32 m0, s52, 5120
    s_nop 0
    buffer_load_dwordx4 v13, s[8:11], s50 offen  lds
    s_add_u32 m0, s51, 3072
    s_movk_i32 s49, 1536
    buffer_load_dwordx4 v11, s[4:7], s49 offen  lds
    s_add_u32 m0, s52, 6144
    s_add_u32 s50, s50, s48
    buffer_load_dwordx4 v12, s[8:11], s50 offen  lds
    s_add_u32 m0, s52, 7168
    s_nop 0
    buffer_load_dwordx4 v13, s[8:11], s50 offen  lds
    s_waitcnt vmcnt(9)
    s_barrier
    s_cmp_lg_u32 s61, 3
    s_cbranch_scc1 K_nf_96
    s_and_b32 s40, s37, 3
    s_lshl2_add_u32 s40, s36, s40
    s_lshl_b32 s40, s40, 5
    s_lshr_b32 s41, s37, 3
    s_add_u32 s40, s40, s41
    s_lshl_b32 s40, s40, 2
    s_add_u32 s40, s40, 17301504
    s_mov_b64 exec, 1
    buffer_store_dword v240, off, s[20:23], s40 sc1
    s_mov_b64 exec, -1
K_nf_96:
    s_add_u32 m0, s51, 49152
    s_movk_i32 s49, 1664
    buffer_load_dwordx4 v8, s[4:7], s49 offen  lds
    s_add_u32 m0, s52, 49152
    s_add_u32 s50, s50, s48
    buffer_load_dwordx4 v12, s[8:11], s50 offen  lds
    s_add_u32 m0, s52, 50176
    s_nop 0
    buffer_load_dwordx4 v13, s[8:11], s50 offen  lds
    s_add_u32 m0, s51, 50176
    s_movk_i32 s49, 1664
    buffer_load_dwordx4 v9, s[4:7], s49 offen  lds
    s_add_u32 m0, s52, 51200
    s_add_u32 s50, s50, s48
    buffer_load_dwordx4 v12, s[8:11], s50 offen  lds
    s_add_u32 m0, s52, 52224
    s_nop 0
    buffer_load_dwordx4 v13, s[8:11], s50 offen  lds
    s_add_u32 m0, s51, 51200
    s_movk_i32 s49, 1664
    buffer_load_dwordx4 v10, s[4:7], s49 offen  lds
    s_add_u32 m0, s52, 53248
    s_add_u32 s50, s50, s48
    buffer_load_dwordx4 v12, s[8:11], s50 offen  lds
    s_add_u32 m0, s52, 54272
    s_nop 0
    buffer_load_dwordx4 v13, s[8:11], s50 offen  lds
    s_add_u32 m0, s51, 52224
    s_movk_i32 s49, 1664
    buffer_load_dwordx4 v11, s[4:7], s49 offen  lds
    s_add_u32 m0, s52, 55296
    s_add_u32 s50, s50, s48
    buffer_load_dwordx4 v12, s[8:11], s50 offen  lds
    s_add_u32 m0, s52, 56320
    s_nop 0
    buffer_load_dwordx4 v13, s[8:11], s50 offen  lds
    s_waitcnt vmcnt(12)
    s_barrier
    s_add_u32 m0, s51, 98304
    s_movk_i32 s49, 1792
    buffer_load_dwordx4 v8, s[4:7], s49 offen  lds
    s_add_u32 m0, s52, 98304
    s_add_u32 s50, s50, s48
    buffer_load_dwordx4 v12, s[8:11], s50 offen  lds
    s_add_u32 m0, s52, 99328
    s_nop 0
    buffer_load_dwordx4 v13, s[8:11], s50 offen  lds
    s_add_u32 m0, s51, 99328
    s_movk_i32 s49, 1792
    buffer_load_dwordx4 v9, s[4:7], s49 offen  lds
    s_add_u32 m0, s52, 100352
    s_add_u32 s50, s50, s48
    buffer_load_dwordx4 v12, s[8:11], s50 offen  lds
    s_add_u32 m0, s52, 101376
    s_nop 0
    buffer_load_dwordx4 v13, s[8:11], s50 offen  lds
    s_add_u32 m0, s51, 100352
    s_movk_i32 s49, 1792
    buffer_load_dwordx4 v10, s[4:7], s49 offen  lds
    s_add_u32 m0, s52, 102400
    s_add_u32 s50, s50, s48
    buffer_load_dwordx4 v12, s[8:11], s50 offen  lds
    s_add_u32 m0, s52, 103424
    s_nop 0
    buffer_load_dwordx4 v13, s[8:11], s50 offen  lds
    s_add_u32 m0, s51, 101376
    s_movk_i32 s49, 1792
    buffer_load_dwordx4 v11, s[4:7], s49 offen  lds
    s_add_u32 m0, s52, 104448
    s_add_u32 s50, s50, s48
    buffer_load_dwordx4 v12, s[8:11], s50 offen  lds
    s_add_u32 m0, s52, 105472
    s_nop 0
    buffer_load_dwordx4 v13, s[8:11], s50 offen  lds
    s_waitcnt vmcnt(12)
    s_barrier
    s_add_u32 m0, s51, 0
    s_movk_i32 s49, 1920
    buffer_load_dwordx4 v8, s[4:7], s49 offen  lds
    s_add_u32 m0, s52, 0
    s_add_u32 s50, s50, s48
    buffer_load_dwordx4 v12, s[8:11], s50 offen  lds
    s_add_u32 m0, s52, 1024
    s_nop 0
    buffer_load_dwordx4 v13, s[8:11], s50 offen  lds
    s_add_u32 m0, s51, 1024
    s_movk_i32 s49, 1920
    buffer_load_dwordx4 v9, s[4:7], s49 offen  lds
    s_add_u32 m0, s52, 2048
    s_add_u32 s50, s50, s48
    buffer_load_dwordx4 v12, s[8:11], s50 offen  lds
    s_add_u32 m0, s52, 3072
    s_nop 0
    buffer_load_dwordx4 v13, s[8:11], s50 offen  lds
    s_add_u32 m0, s51, 2048
    s_movk_i32 s49, 1920
    buffer_load_dwordx4 v10, s[4:7], s49 offen  lds
    s_add_u32 m0, s52, 4096
    s_add_u32 s50, s50, s48
    buffer_load_dwordx4 v12, s[8:11], s50 offen  lds
    s_add_u32 m0, s52, 5120
    s_nop 0
    buffer_load_dwordx4 v13, s[8:11], s50 offen  lds
    s_add_u32 m0, s51, 3072
    s_movk_i32 s49, 1920
    buffer_load_dwordx4 v11, s[4:7], s49 offen  lds
    s_add_u32 m0, s52, 6144
    s_add_u32 s50, s50, s48
    buffer_load_dwordx4 v12, s[8:11], s50 offen  lds
    s_add_u32 m0, s52, 7168
    s_nop 0
    buffer_load_dwordx4 v13, s[8:11], s50 offen  lds
    s_waitcnt vmcnt(12)
K_phend:
    s_waitcnt lgkmcnt(0)
    s_barrier
    s_mov_b32 s53, 17301504
    v_and_b32 v182, 8, v2
    v_add_lshl_u32 v182, v182, v2, 7
    buffer_load_dwordx2 v[20:21], v182, s[20:23], s53 offen sc1
    v_lshrrev_b32 v7, 5, v1
    v_lshlrev_b32 v7, 4, v7
    v_sub_u32 v7, v249, v7
    s_lshl_b32 s40, s61, 5
    v_subrev_u32 v7, s40, v7
    v_mov_b32 v6, s47
    s_lshl_b32 s40, s61, 10
    s_add_u32 s40, s40, 49152
    v_add_u32 v5, s40, v4
    v_cmp_gt_i32 vcc, 0, v7
    s_nop 1
    v_cndmask_b32 v84, 0, v6, vcc
    v_sub_f32 v88, v6, v84
    v_cmp_gt_i32 vcc, 4, v7
    s_nop 1
    v_cndmask_b32 v85, 0, v6, vcc
    v_sub_f32 v89, v6, v85
    v_cmp_gt_i32 vcc, 8, v7
    s_nop 1
    v_cndmask_b32 v86, 0, v6, vcc
    v_sub_f32 v90, v6, v86
    v_cmp_gt_i32 vcc, 12, v7
    s_nop 1
    v_cndmask_b32 v87, 0, v6, vcc
    v_sub_f32 v91, v6, v87
    ds_write_b128 v5, v[84:87]
    ds_write_b128 v5, v[88:91] offset:4096
    s_waitcnt vmcnt(1)
    s_barrier
    s_waitcnt vmcnt(0)
K_ps_97:
    v_cmp_ne_u32 vcc, s39, v20
    v_cmp_ne_u32 s[42:43], s39, v21
    s_or_b64 vcc, vcc, s[42:43]
    s_cbranch_vccz K_po_98
    s_add_u32 s3, s3, 1
    s_cmp_gt_u32 s3, 1048576
    s_cbranch_scc1 K_po_98
    s_sleep 4
    buffer_load_dwordx2 v[20:21], v182, s[20:23], s53 offen sc1
    s_waitcnt vmcnt(0)
    s_branch K_ps_97
K_po_98:
    s_add_u32 s40, s51, 16777216
    s_add_u32 m0, s51, 98304
    s_add_u32 s41, s40, 16384
    buffer_load_dwordx4 v4, s[20:23], s40 offen offset:0 sc1 lds
    buffer_load_dwordx4 v4, s[20:23], s40 offen offset:1024 sc1 lds
    buffer_load_dwordx4 v4, s[20:23], s40 offen offset:2048 sc1 lds
    buffer_load_dwordx4 v4, s[20:23], s40 offen offset:3072 sc1 lds
    s_add_u32 m0, s51, 114688
    s_nop 0
    buffer_load_dwordx4 v4, s[20:23], s41 offen offset:0 sc1 lds
    buffer_load_dwordx4 v4, s[20:23], s41 offen offset:1024 sc1 lds
    buffer_load_dwordx4 v4, s[20:23], s41 offen offset:2048 sc1 lds
    buffer_load_dwordx4 v4, s[20:23], s41 offen offset:3072 sc1 lds
    s_setprio 0
    s_waitcnt vmcnt(4)
    s_branch K_join
K_codeend:
.section .rodata,"a"
.p2align 6
.amdhsa_kernel gated_mix__grouped_kv_mqa__sliding_block__prompt_kernel
  .amdhsa_next_free_vgpr 256
  .amdhsa_next_free_sgpr 102
  .amdhsa_accum_offset 256
  .amdhsa_group_segment_fixed_size 0
  .amdhsa_kernarg_size 96
  .amdhsa_user_sgpr_count 2
  .amdhsa_user_sgpr_kernarg_segment_ptr 1
  .amdhsa_system_sgpr_workgroup_id_x 1
.end_amdhsa_kernel
```
